```python
import torch

def _softmax(x, axis=-1):
    return torch.softmax(x, dim=axis)
def _gelu(x):
    return torch.nn.functional.gelu(x, approximate="tanh")
def _silu(x):
    return torch.nn.functional.silu(x)
def _sigmoid(x):
    return torch.sigmoid(x)
def _layernorm(x, axis=-1, eps=1e-5):
    m = x.mean(dim=axis, keepdim=True)
    v = x.var(dim=axis, keepdim=True, unbiased=False)
    return (x - m) / torch.sqrt(v + eps)
def _scatter_add(tgt, idx, src, axis=0):
    return tgt.clone().index_add_(axis, idx, src)
def _segment_sum(src, seg, n):
    out = torch.zeros((n,) + src.shape[1:], dtype=src.dtype)
    return out.index_add_(0, seg, src)
def _pad(x, pw):
    flat = tuple(v for pair in reversed(pw) for v in pair)
    return torch.nn.functional.pad(x, flat)

kernel_name = 'parallel_sum__linear_kernel_hedgehog__glu_gated_reglu__prompt'

def setup_inputs():

    _w = (lambda a: (lambda t: t.to(torch.bfloat16) if t.is_floating_point() else t)(torch.as_tensor(a)))
    def _A_setup():
        B, S, D, H = 1, 2048, 1024, 32
        Dh = D // H
        return {
            "x": _w((lambda *s: torch.randn(*s, dtype=torch.bfloat16) * 0.05)(B, S, D)),
            "wqkv": _w((lambda *s: torch.randn(*s, dtype=torch.bfloat16) * 0.2)(D, 3 * D)),
            "w_phi": _w((lambda *s: torch.randn(*s, dtype=torch.bfloat16) * 0.2)(H, Dh, Dh) * (Dh ** -0.5)),
            "wo": _w((lambda *s: torch.randn(*s, dtype=torch.bfloat16) * 0.05)(D, D)),
        }
    _A_in = _A_setup()

    def _B_setup():
        B, S, D, F = 1, 2048, 1024, 3584
        return {
            "x": _w((lambda *s: torch.randn(*s, dtype=torch.bfloat16) * 0.05)(B, S, D)),
            "W_gate": _w((lambda *s: torch.randn(*s, dtype=torch.bfloat16) * 0.4)(D, F) * (2.0 / D) ** 0.5),
            "W_up": _w((lambda *s: torch.randn(*s, dtype=torch.bfloat16) * 0.4)(D, F) * (2.0 / D) ** 0.5),
            "W_down": _w((lambda *s: torch.randn(*s, dtype=torch.bfloat16) * 0.4)(F, D) * (1.0 / F) ** 0.5),
        }
    _B_in = _B_setup()

    return {
        "A_x": _A_in["x"],
        "A_wqkv": _A_in["wqkv"],
        "A_w_phi": _A_in["w_phi"],
        "A_wo": _A_in["wo"],
        "B_x": _B_in["x"],
        "B_W_gate": _B_in["W_gate"],
        "B_W_up": _B_in["W_up"],
        "B_W_down": _B_in["W_down"],
    }

def reference(A_x, A_wqkv, A_w_phi, A_wo, B_x, B_W_gate, B_W_up, B_W_down):
    def _A_ref(x, wqkv, w_phi, wo):
        B, S, D = x.shape
        H = 32; Dh = D // H
        qkv = (lambda x, *d: x.permute(*d))((x @ wqkv).reshape(B, S, 3, H, Dh), 2, 0, 3, 1, 4)
        q, k, v = qkv[0], qkv[1], qkv[2]
        pq = torch.einsum("bhsd,hdf->bhsf", q, w_phi)
        pk = torch.einsum("bhsd,hdf->bhsf", k, w_phi)
        phi_q = torch.concatenate([_softmax(pq, axis=-1), _softmax(-pq, axis=-1)], axis=-1)
        phi_k = torch.concatenate([_softmax(pk, axis=-1), _softmax(-pk, axis=-1)], axis=-1)
        kv = torch.einsum("bhsf,bhsd->bhfd", phi_k, v)
        z  = torch.einsum("bhsf->bhf", phi_k)
        num = torch.einsum("bhqf,bhfd->bhqd", phi_q, kv)
        den = torch.einsum("bhqf,bhf->bhq", phi_q, z)[..., None] + 1e-6
        o = num / den
        return (lambda x, *d: x.permute(*d))(o, 0, 2, 1, 3).reshape(B, S, D) @ wo

    def _B_ref(x, W_gate, W_up, W_down):
        gate = torch.einsum("bsd,df->bsf", x, W_gate)
        up = torch.einsum("bsd,df->bsf", x, W_up)
        gate = gate * (lambda x, dt: x.to(dt))(gate > 0, gate.dtype)
        h = gate * up
        return torch.einsum("bsf,fd->bsd", h, W_down)

    x = A_x
    xn = _layernorm(x, axis=-1)
    return x + _A_ref(xn, A_wqkv, A_w_phi, A_wo) + _B_ref(xn, B_W_gate, B_W_up, B_W_down)
```

```asm
; @launch grid=(256,1,1) block=(256,1,1) lds=161792
.amdgcn_target "amdgcn-amd-amdhsa--gfx950"
.text
.globl parallel_sum__linear_kernel_hedgehog__glu_gated_reglu__prompt_kernel
.p2align 8
.type parallel_sum__linear_kernel_hedgehog__glu_gated_reglu__prompt_kernel,@function
parallel_sum__linear_kernel_hedgehog__glu_gated_reglu__prompt_kernel:
  s_cmp_ge_u32 s2, 256
  s_cbranch_scc1 L_parallel_sum__linear_kernel_hedgehog__glu_gated_reglu__prompt_kernel_done
  s_load_dwordx16 s[40:55], s[0:1], 0
  s_load_dwordx4 s[56:59], s[0:1], 64
  s_load_dwordx2 s[60:61], s[0:1], 80
  v_lshrrev_b32 v16, 6, v0
  v_and_b32 v1, 63, v0
  v_readfirstlane_b32 s3, v16
  s_lshr_b32 s4, s2, 3
  s_and_b32 s4, s4, 7
  s_and_b32 s5, s2, 7
  s_lshl_b32 s5, s5, 2
  s_lshr_b32 s7, s2, 6
  s_add_u32 s5, s5, s7
  s_and_b32 s7, s5, 1
  v_and_b32 v40, 7, v1
  v_lshrrev_b32 v41, 3, v1
  v_lshlrev_b32 v42, 11, v40
  v_lshrrev_b32 v43, 1, v41
  v_lshl_add_u32 v42, v43, 6, v42
  v_and_b32 v44, 1, v41
  v_lshl_add_u32 v42, v44, 4, v42
  s_lshl_b32 s82, s4, 8
  s_lshl_b32 s83, s5, 3
  s_add_u32 s82, s82, s83
  s_lshl_b32 s82, s82, 11
  s_lshl_b32 s83, s3, 9
  s_add_u32 s82, s82, s83
  s_waitcnt lgkmcnt(0)
  s_mov_b32 s24, s40
  s_and_b32 s25, s41, 0xffff
  s_mov_b32 s26, 0x400000
  s_mov_b32 s27, 0x20000
  buffer_load_dwordx4 v[80:83], v42, s[24:27], s82 offen offset:0
  buffer_load_dwordx4 v[84:87], v42, s[24:27], s82 offen offset:32
  buffer_load_dwordx4 v[88:91], v42, s[24:27], s82 offen offset:256
  buffer_load_dwordx4 v[92:95], v42, s[24:27], s82 offen offset:288
  s_add_u32 s20, s60, 0x3000000
  s_addc_u32 s21, s61, 0
  s_and_b32 s21, s21, 0xffff
  s_mov_b32 s22, 0xc000
  s_mov_b32 s23, 0x20000
  s_cmp_ge_u32 s3, 2
  s_cbranch_scc1 L_parallel_sum__linear_kernel_hedgehog__glu_gated_reglu__prompt_kernel_nz
  v_lshlrev_b32 v45, 2, v1
  v_mov_b32 v46, 0
  s_lshl_b32 s83, s3, 8
  s_add_u32 s83, s83, s2
  s_lshl_b32 s83, s83, 7
  v_cmp_gt_u32 vcc, 32, v1
  s_nop 3
  s_and_saveexec_b64 s[90:91], vcc
  buffer_store_dword v46, v45, s[20:23], s83 offen sc1
  s_mov_b64 exec, s[90:91]
L_parallel_sum__linear_kernel_hedgehog__glu_gated_reglu__prompt_kernel_nz:
  s_mov_b32 s85, 0
  s_add_u32 s20, s60, 0x3000000
  s_addc_u32 s21, s61, 0
  s_and_b32 s21, s21, 0xffff
  s_mov_b32 s22, 0xc400
  s_mov_b32 s23, 0x20000
  s_cmp_eq_u32 s3, 2
  s_cbranch_scc0 L_parallel_sum__linear_kernel_hedgehog__glu_gated_reglu__prompt_kernel_lz
  s_cmp_eq_u32 s5, 0
  s_cbranch_scc0 L_parallel_sum__linear_kernel_hedgehog__glu_gated_reglu__prompt_kernel_lz
  v_mov_b32 v45, 0
  v_mov_b32 v46, 0
  s_lshl_b32 s83, s4, 7
  s_add_u32 s83, s83, 49152
  s_mov_b64 s[90:91], exec
  s_mov_b64 exec, 1
  buffer_store_dword v46, v45, s[20:23], s83 offen sc1
  s_waitcnt vmcnt(0)
  s_mov_b32 s20, s58
  s_and_b32 s21, s59, 0xffff
  s_mov_b32 s22, 0x100
  s_mov_b32 s23, 0x20000
  v_mov_b32 v46, 1
  s_lshl_b32 s83, s4, 5
  buffer_atomic_add v46, v45, s[20:23], s83 offen sc1
  s_mov_b64 exec, s[90:91]
  s_mov_b32 s85, 1
L_parallel_sum__linear_kernel_hedgehog__glu_gated_reglu__prompt_kernel_lz:
  v_lshlrev_b32 v47, 10, v43
  v_lshl_add_u32 v47, v44, 9, v47
  v_lshl_add_u32 v47, v40, 4, v47
  s_cmp_eq_u32 s3, 3
  s_cbranch_scc0 L_parallel_sum__linear_kernel_hedgehog__glu_gated_reglu__prompt_kernel_cpf
  s_getpc_b64 s[86:87]
L_parallel_sum__linear_kernel_hedgehog__glu_gated_reglu__prompt_kernel_cpf_pc:
  s_sub_u32 s86, s86, L_parallel_sum__linear_kernel_hedgehog__glu_gated_reglu__prompt_kernel_cpf_pc - parallel_sum__linear_kernel_hedgehog__glu_gated_reglu__prompt_kernel
  s_subb_u32 s87, s87, 0
  s_lshr_b32 s88, s2, 3
  s_mul_i32 s88, s88, 24*128
  v_lshlrev_b32 v44, 7, v1
  v_add_u32 v44, s88, v44
  v_cmp_gt_u32 vcc, 24, v1
  s_nop 3
  s_and_saveexec_b64 s[88:89], vcc
  v_cmp_gt_u32 vcc, L_parallel_sum__linear_kernel_hedgehog__glu_gated_reglu__prompt_kernel_done - parallel_sum__linear_kernel_hedgehog__glu_gated_reglu__prompt_kernel, v44
  s_nop 3
  s_and_b64 exec, exec, vcc
  s_cbranch_execz L_parallel_sum__linear_kernel_hedgehog__glu_gated_reglu__prompt_kernel_cpf_x
  global_load_dword v45, v44, s[86:87]
L_parallel_sum__linear_kernel_hedgehog__glu_gated_reglu__prompt_kernel_cpf_x:
  s_mov_b64 exec, s[88:89]
L_parallel_sum__linear_kernel_hedgehog__glu_gated_reglu__prompt_kernel_cpf:
  v_lshlrev_b32 v2, 4, v1
  v_lshlrev_b32 v3, 4, v1
  v_add_u32 v3, 0x8000, v3
  v_lshlrev_b32 v4, 4, v1
  v_add_u32 v4, 0x10000, v4
  v_lshlrev_b32 v5, 4, v1
  v_add_u32 v5, 0x18000, v5
  s_lshr_b32 s6, s3, 1
  s_lshl_b32 s82, s4, 4
  s_lshl_b32 s83, s3, 2
  s_add_u32 s82, s82, s83
  s_lshl_b32 s28, s82, 15
  s_lshl_b32 s81, s3, 12
  v_lshrrev_b32 v16, 4, v1
  v_bfe_u32 v18, v1, 2, 2
  v_and_b32 v19, 3, v1
  v_lshl_add_u32 v20, v16, 2, v18
  v_mul_u32_u24 v21, 224, v20
  v_lshl_add_u32 v21, v19, 3, v21
  v_add_u32 v21, 22528, v21
  s_lshl_b32 s82, s7, 5
  v_add_u32 v12, s82, v21
  s_cmp_eq_u32 s7, 0
  s_cselect_b32 s82, 192, 0
  v_add_u32 v13, s82, v21
  v_mul_u32_u24 v21, 192, v20
  v_lshl_add_u32 v21, v19, 3, v21
  v_add_u32 v21, 16384, v21
  v_and_b32 v22, 1, v16
  v_lshl_add_u32 v14, v22, 5, v21
  v_xor_b32 v22, 1, v22
  v_lshl_add_u32 v15, v22, 5, v21
  s_lshl_b32 s82, s6, 13
  v_add_u32 v11, s82, v2
  s_mov_b32 s8, s60
  s_and_b32 s9, s61, 0xffff
  s_mov_b32 s10, 0x400000
  s_mov_b32 s11, 0x20000
  s_bitcmp1_b32 s3, 0
  s_cbranch_scc1 L_parallel_sum__linear_kernel_hedgehog__glu_gated_reglu__prompt_kernel_var1
  s_cmp_ge_u32 s3, 2
  s_cbranch_scc1 L_parallel_sum__linear_kernel_hedgehog__glu_gated_reglu__prompt_kernel_v0_th1
  s_mov_b32 s12, s50
  s_and_b32 s13, s51, 0xffff
  s_mov_b32 s14, 0x700000
  s_mov_b32 s15, 0x20000
  s_mov_b32 s32, 229376
  s_mov_b32 s29, 0
  s_mov_b32 s76, 22528
  v_add_u32 v24, 0, v1
  v_mul_u32_u24 v25, 4682, v24
  v_lshrrev_b32 v25, 16, v25
  v_mul_u32_u24 v26, 14, v25
  v_sub_u32 v26, v24, v26
  v_mul_u32_u24 v25, 7168, v25
  v_lshl_add_u32 v25, v26, 4, v25
  s_mul_i32 s83, s5, 224
  v_add_u32 v6, s83, v25
  s_mov_b32 s16, s50
  s_and_b32 s17, s51, 0xffff
  s_mov_b32 s18, 0x700000
  s_mov_b32 s19, 0x20000
  s_mov_b32 s33, 229376
  s_mov_b32 s30, 0
  s_mov_b32 s77, 26624
  v_add_u32 v24, 256, v1
  v_mul_u32_u24 v25, 4682, v24
  v_lshrrev_b32 v25, 16, v25
  v_mul_u32_u24 v26, 14, v25
  v_sub_u32 v26, v24, v26
  v_mul_u32_u24 v25, 7168, v25
  v_lshl_add_u32 v25, v26, 4, v25
  s_mul_i32 s83, s5, 224
  v_add_u32 v7, s83, v25
  s_mov_b32 s20, s52
  s_and_b32 s21, s53, 0xffff
  s_mov_b32 s22, 0x700000
  s_mov_b32 s23, 0x20000
  s_mov_b32 s34, 229376
  s_mov_b32 s31, 0
  s_mov_b32 s78, 30720
  v_add_u32 v24, 64, v1
  v_mul_u32_u24 v25, 4682, v24
  v_lshrrev_b32 v25, 16, v25
  v_mul_u32_u24 v26, 14, v25
  v_sub_u32 v26, v24, v26
  v_mul_u32_u24 v25, 7168, v25
  v_lshl_add_u32 v25, v26, 4, v25
  s_mul_i32 s83, s5, 224
  v_add_u32 v8, s83, v25
  s_mov_b32 s64, s52
  s_and_b32 s65, s53, 0xffff
  s_mov_b32 s66, 0x700000
  s_mov_b32 s67, 0x20000
  s_mov_b32 s74, 229376
  s_mov_b32 s72, 0
  s_mov_b32 s79, 34816
  v_add_u32 v24, 320, v1
  v_mul_u32_u24 v25, 4682, v24
  v_lshrrev_b32 v25, 16, v25
  v_mul_u32_u24 v26, 14, v25
  v_sub_u32 v26, v24, v26
  v_mul_u32_u24 v25, 7168, v25
  v_lshl_add_u32 v25, v26, 4, v25
  s_mul_i32 s83, s5, 224
  v_add_u32 v9, s83, v25
  s_mov_b32 s68, s42
  s_and_b32 s69, s43, 0xffff
  s_mov_b32 s70, 0x600000
  s_mov_b32 s71, 0x20000
  s_mov_b32 s75, 196608
  s_mov_b32 s73, 0
  s_mov_b32 s80, 18432
  v_add_u32 v24, 128, v1
  v_mul_u32_u24 v25, 5462, v24
  v_lshrrev_b32 v25, 16, v25
  v_mul_u32_u24 v26, 12, v25
  v_sub_u32 v26, v24, v26
  v_bfe_u32 v27, v25, 2, 1
  v_lshlrev_b32 v27, 1, v27
  v_xor_b32 v26, v26, v27
  v_mul_u32_u24 v25, 6144, v25
  v_lshrrev_b32 v27, 2, v26
  v_lshlrev_b32 v27, 11, v27
  v_and_b32 v26, 3, v26
  v_lshl_add_u32 v25, v26, 4, v25
  v_add_u32 v25, v27, v25
  s_lshl_b32 s83, s5, 6
  v_add_u32 v10, s83, v25
  s_branch L_parallel_sum__linear_kernel_hedgehog__glu_gated_reglu__prompt_kernel_v0_thx
L_parallel_sum__linear_kernel_hedgehog__glu_gated_reglu__prompt_kernel_v0_th1:
  s_mov_b32 s12, s50
  s_and_b32 s13, s51, 0xffff
  s_mov_b32 s14, 0x700000
  s_mov_b32 s15, 0x20000
  s_mov_b32 s32, 229376
  s_mov_b32 s29, 0
  s_mov_b32 s76, 24576
  v_add_u32 v24, 128, v1
  v_mul_u32_u24 v25, 4682, v24
  v_lshrrev_b32 v25, 16, v25
  v_mul_u32_u24 v26, 14, v25
  v_sub_u32 v26, v24, v26
  v_mul_u32_u24 v25, 7168, v25
  v_lshl_add_u32 v25, v26, 4, v25
  s_mul_i32 s83, s5, 224
  v_add_u32 v6, s83, v25
  s_mov_b32 s16, s50
  s_and_b32 s17, s51, 0xffff
  s_mov_b32 s18, 0x700000
  s_mov_b32 s19, 0x20000
  s_mov_b32 s33, 229376
  s_mov_b32 s30, 0
  s_mov_b32 s77, 28672
  v_add_u32 v24, 384, v1
  v_mul_u32_u24 v25, 4682, v24
  v_lshrrev_b32 v25, 16, v25
  v_mul_u32_u24 v26, 14, v25
  v_sub_u32 v26, v24, v26
  v_mul_u32_u24 v25, 7168, v25
  v_lshl_add_u32 v25, v26, 4, v25
  s_mul_i32 s83, s5, 224
  v_add_u32 v7, s83, v25
  s_mov_b32 s20, s52
  s_and_b32 s21, s53, 0xffff
  s_mov_b32 s22, 0x700000
  s_mov_b32 s23, 0x20000
  s_mov_b32 s34, 229376
  s_mov_b32 s31, 0
  s_mov_b32 s78, 32768
  v_add_u32 v24, 192, v1
  v_mul_u32_u24 v25, 4682, v24
  v_lshrrev_b32 v25, 16, v25
  v_mul_u32_u24 v26, 14, v25
  v_sub_u32 v26, v24, v26
  v_mul_u32_u24 v25, 7168, v25
  v_lshl_add_u32 v25, v26, 4, v25
  s_mul_i32 s83, s5, 224
  v_add_u32 v8, s83, v25
  s_mov_b32 s64, s42
  s_and_b32 s65, s43, 0xffff
  s_mov_b32 s66, 0x600000
  s_mov_b32 s67, 0x20000
  s_mov_b32 s74, 196608
  s_mov_b32 s72, 0
  s_mov_b32 s79, 16384
  v_add_u32 v24, 0, v1
  v_mul_u32_u24 v25, 5462, v24
  v_lshrrev_b32 v25, 16, v25
  v_mul_u32_u24 v26, 12, v25
  v_sub_u32 v26, v24, v26
  v_bfe_u32 v27, v25, 2, 1
  v_lshlrev_b32 v27, 1, v27
  v_xor_b32 v26, v26, v27
  v_mul_u32_u24 v25, 6144, v25
  v_lshrrev_b32 v27, 2, v26
  v_lshlrev_b32 v27, 11, v27
  v_and_b32 v26, 3, v26
  v_lshl_add_u32 v25, v26, 4, v25
  v_add_u32 v25, v27, v25
  s_lshl_b32 s83, s5, 6
  v_add_u32 v9, s83, v25
  s_mov_b32 s68, s42
  s_and_b32 s69, s43, 0xffff
  s_mov_b32 s70, 0x600000
  s_mov_b32 s71, 0x20000
  s_mov_b32 s75, 196608
  s_mov_b32 s73, 0
  s_mov_b32 s80, 20480
  v_add_u32 v24, 256, v1
  v_mul_u32_u24 v25, 5462, v24
  v_lshrrev_b32 v25, 16, v25
  v_mul_u32_u24 v26, 12, v25
  v_sub_u32 v26, v24, v26
  v_bfe_u32 v27, v25, 2, 1
  v_lshlrev_b32 v27, 1, v27
  v_xor_b32 v26, v26, v27
  v_mul_u32_u24 v25, 6144, v25
  v_lshrrev_b32 v27, 2, v26
  v_lshlrev_b32 v27, 11, v27
  v_and_b32 v26, 3, v26
  v_lshl_add_u32 v25, v26, 4, v25
  v_add_u32 v25, v27, v25
  s_lshl_b32 s83, s5, 6
  v_add_u32 v10, s83, v25
L_parallel_sum__linear_kernel_hedgehog__glu_gated_reglu__prompt_kernel_v0_thx:
  s_mov_b32 s24, s44
  s_and_b32 s25, s45, 0xffff
  s_mov_b32 s26, 0x10000
  s_mov_b32 s27, 0x20000
  s_lshl_b32 s82, s5, 11
  s_add_u32 s82, s82, 0
  s_mov_b32 m0, 147456
  s_nop 0
  buffer_load_dwordx4 v2, s[24:27], s82 offen lds
  s_add_u32 m0, s76, 0
  s_nop 0
  buffer_load_dwordx4 v6, s[12:15], s29 offen lds
  s_add_u32 s29, s29, s32
  s_add_u32 m0, s77, 0
  s_nop 0
  buffer_load_dwordx4 v7, s[16:19], s30 offen lds
  s_add_u32 s30, s30, s33
  s_add_u32 m0, s78, 0
  s_nop 0
  buffer_load_dwordx4 v8, s[20:23], s31 offen lds
  s_add_u32 s31, s31, s34
  s_add_u32 m0, s79, 0
  s_nop 0
  buffer_load_dwordx4 v9, s[64:67], s72 offen lds
  s_add_u32 s72, s72, s74
  s_add_u32 m0, s80, 0
  s_nop 0
  buffer_load_dwordx4 v10, s[68:71], s73 offen lds
  s_add_u32 s73, s73, s75
  s_add_u32 m0, s76, 36864
  s_nop 0
  buffer_load_dwordx4 v6, s[12:15], s29 offen lds
  s_add_u32 s29, s29, s32
  s_add_u32 m0, s77, 36864
  s_nop 0
  buffer_load_dwordx4 v7, s[16:19], s30 offen lds
  s_add_u32 s30, s30, s33
  s_add_u32 m0, s78, 36864
  s_nop 0
  buffer_load_dwordx4 v8, s[20:23], s31 offen lds
  s_add_u32 s31, s31, s34
  s_add_u32 m0, s79, 36864
  s_nop 0
  buffer_load_dwordx4 v9, s[64:67], s72 offen lds
  s_add_u32 s72, s72, s74
  s_add_u32 m0, s80, 36864
  s_nop 0
  buffer_load_dwordx4 v10, s[68:71], s73 offen lds
  s_add_u32 s73, s73, s75
  s_cmp_eq_u32 s85, 1
  s_cbranch_scc1 L_parallel_sum__linear_kernel_hedgehog__glu_gated_reglu__prompt_kernel_xw1
  s_waitcnt vmcnt(11)
L_parallel_sum__linear_kernel_hedgehog__glu_gated_reglu__prompt_kernel_xw1:
  v_lshlrev_b32 v96, 16, v80
  v_and_b32 v97, 0xffff0000, v80
  v_lshlrev_b32 v98, 16, v81
  v_and_b32 v99, 0xffff0000, v81
  v_lshlrev_b32 v100, 16, v82
  v_and_b32 v101, 0xffff0000, v82
  v_lshlrev_b32 v102, 16, v83
  v_and_b32 v103, 0xffff0000, v83
  v_lshlrev_b32 v104, 16, v84
  v_and_b32 v105, 0xffff0000, v84
  v_lshlrev_b32 v106, 16, v85
  v_and_b32 v107, 0xffff0000, v85
  v_lshlrev_b32 v108, 16, v86
  v_and_b32 v109, 0xffff0000, v86
  v_lshlrev_b32 v110, 16, v87
  v_and_b32 v111, 0xffff0000, v87
  v_lshlrev_b32 v112, 16, v88
  v_and_b32 v113, 0xffff0000, v88
  v_lshlrev_b32 v114, 16, v89
  v_and_b32 v115, 0xffff0000, v89
  v_lshlrev_b32 v116, 16, v90
  v_and_b32 v117, 0xffff0000, v90
  v_lshlrev_b32 v118, 16, v91
  v_and_b32 v119, 0xffff0000, v91
  v_lshlrev_b32 v120, 16, v92
  v_and_b32 v121, 0xffff0000, v92
  v_lshlrev_b32 v122, 16, v93
  v_and_b32 v123, 0xffff0000, v93
  v_lshlrev_b32 v124, 16, v94
  v_and_b32 v125, 0xffff0000, v94
  v_lshlrev_b32 v126, 16, v95
  v_and_b32 v127, 0xffff0000, v95
  v_pk_add_f32 v[128:129], v[96:97], v[98:99]
  v_pk_add_f32 v[128:129], v[128:129], v[100:101]
  v_pk_add_f32 v[128:129], v[128:129], v[102:103]
  v_pk_add_f32 v[128:129], v[128:129], v[104:105]
  v_pk_add_f32 v[128:129], v[128:129], v[106:107]
  v_pk_add_f32 v[128:129], v[128:129], v[108:109]
  v_pk_add_f32 v[128:129], v[128:129], v[110:111]
  v_pk_add_f32 v[128:129], v[128:129], v[112:113]
  v_pk_add_f32 v[128:129], v[128:129], v[114:115]
  v_pk_add_f32 v[128:129], v[128:129], v[116:117]
  v_pk_add_f32 v[128:129], v[128:129], v[118:119]
  v_pk_add_f32 v[128:129], v[128:129], v[120:121]
  v_pk_add_f32 v[128:129], v[128:129], v[122:123]
  v_pk_add_f32 v[128:129], v[128:129], v[124:125]
  v_pk_add_f32 v[128:129], v[128:129], v[126:127]
  v_add_f32 v128, v128, v129
  s_nop 1
  v_add_f32_dpp v128, v128, v128 row_ror:8 row_mask:0xf bank_mask:0xf
  v_mov_b32 v129, v128
  s_nop 1
  v_permlane16_swap_b32 v128, v129
  v_add_f32 v128, v128, v129
  v_mov_b32 v129, v128
  s_nop 1
  v_permlane32_swap_b32 v128, v129
  v_add_f32 v128, v128, v129
  s_lshl_b32 s83, s3, 5
  v_lshl_add_u32 v130, v40, 2, s83
  v_add_u32 v130, 149504, v130
  ds_write_b32 v130, v128
  v_lshlrev_b32 v131, 2, v40
  v_add_u32 v131, 149504, v131
  s_waitcnt lgkmcnt(0)
  s_barrier
  ds_read_b32 v132, v131 offset:0
  ds_read_b32 v133, v131 offset:32
  ds_read_b32 v134, v131 offset:64
  ds_read_b32 v135, v131 offset:96
  s_waitcnt lgkmcnt(0)
  v_add_f32 v132, v132, v133
  v_add_f32 v134, v134, v135
  v_add_f32 v128, v132, v134
  v_mul_f32 v128, 0x3a800000, v128
  v_mov_b32 v129, v128
  v_pk_add_f32 v[136:137], v[96:97], v[128:129] neg_lo:[0,1] neg_hi:[0,1]
  v_pk_mul_f32 v[138:139], v[136:137], v[136:137]
  v_pk_add_f32 v[136:137], v[98:99], v[128:129] neg_lo:[0,1] neg_hi:[0,1]
  v_pk_fma_f32 v[138:139], v[136:137], v[136:137], v[138:139]
  v_pk_add_f32 v[136:137], v[100:101], v[128:129] neg_lo:[0,1] neg_hi:[0,1]
  v_pk_fma_f32 v[138:139], v[136:137], v[136:137], v[138:139]
  v_pk_add_f32 v[136:137], v[102:103], v[128:129] neg_lo:[0,1] neg_hi:[0,1]
  v_pk_fma_f32 v[138:139], v[136:137], v[136:137], v[138:139]
  v_pk_add_f32 v[136:137], v[104:105], v[128:129] neg_lo:[0,1] neg_hi:[0,1]
  v_pk_fma_f32 v[138:139], v[136:137], v[136:137], v[138:139]
  v_pk_add_f32 v[136:137], v[106:107], v[128:129] neg_lo:[0,1] neg_hi:[0,1]
  v_pk_fma_f32 v[138:139], v[136:137], v[136:137], v[138:139]
  v_pk_add_f32 v[136:137], v[108:109], v[128:129] neg_lo:[0,1] neg_hi:[0,1]
  v_pk_fma_f32 v[138:139], v[136:137], v[136:137], v[138:139]
  v_pk_add_f32 v[136:137], v[110:111], v[128:129] neg_lo:[0,1] neg_hi:[0,1]
  v_pk_fma_f32 v[138:139], v[136:137], v[136:137], v[138:139]
  v_pk_add_f32 v[136:137], v[112:113], v[128:129] neg_lo:[0,1] neg_hi:[0,1]
  v_pk_fma_f32 v[138:139], v[136:137], v[136:137], v[138:139]
  v_pk_add_f32 v[136:137], v[114:115], v[128:129] neg_lo:[0,1] neg_hi:[0,1]
  v_pk_fma_f32 v[138:139], v[136:137], v[136:137], v[138:139]
  v_pk_add_f32 v[136:137], v[116:117], v[128:129] neg_lo:[0,1] neg_hi:[0,1]
  v_pk_fma_f32 v[138:139], v[136:137], v[136:137], v[138:139]
  v_pk_add_f32 v[136:137], v[118:119], v[128:129] neg_lo:[0,1] neg_hi:[0,1]
  v_pk_fma_f32 v[138:139], v[136:137], v[136:137], v[138:139]
  v_pk_add_f32 v[136:137], v[120:121], v[128:129] neg_lo:[0,1] neg_hi:[0,1]
  v_pk_fma_f32 v[138:139], v[136:137], v[136:137], v[138:139]
  v_pk_add_f32 v[136:137], v[122:123], v[128:129] neg_lo:[0,1] neg_hi:[0,1]
  v_pk_fma_f32 v[138:139], v[136:137], v[136:137], v[138:139]
  v_pk_add_f32 v[136:137], v[124:125], v[128:129] neg_lo:[0,1] neg_hi:[0,1]
  v_pk_fma_f32 v[138:139], v[136:137], v[136:137], v[138:139]
  v_pk_add_f32 v[136:137], v[126:127], v[128:129] neg_lo:[0,1] neg_hi:[0,1]
  v_pk_fma_f32 v[138:139], v[136:137], v[136:137], v[138:139]
  v_add_f32 v140, v138, v139
  v_cvt_pk_bf16_f32 v141, v128, v128
  v_and_b32 v141, 0xffff0000, v141
  v_add_f32_dpp v140, v140, v140 row_ror:8 row_mask:0xf bank_mask:0xf
  v_mov_b32 v129, v140
  s_nop 1
  v_permlane16_swap_b32 v140, v129
  v_add_f32 v140, v140, v129
  v_mov_b32 v129, v140
  s_nop 1
  v_permlane32_swap_b32 v140, v129
  v_add_f32 v140, v140, v129
  s_lshl_b32 s83, s3, 5
  v_lshl_add_u32 v130, v40, 2, s83
  v_add_u32 v130, 149632, v130
  ds_write_b32 v130, v140
  v_lshlrev_b32 v131, 2, v40
  v_add_u32 v131, 149632, v131
  s_waitcnt lgkmcnt(0)
  s_barrier
  ds_read_b32 v132, v131 offset:0
  ds_read_b32 v133, v131 offset:32
  ds_read_b32 v134, v131 offset:64
  ds_read_b32 v135, v131 offset:96
  s_waitcnt lgkmcnt(0)
  v_add_f32 v132, v132, v133
  v_add_f32 v134, v134, v135
  v_add_f32 v140, v132, v134
  v_mul_f32 v140, 0x3a800000, v140
  v_cvt_pk_bf16_f32 v140, v140, v140
  v_and_b32 v140, 0xffff0000, v140
  v_add_f32 v140, 0x3727c5ac, v140
  v_cvt_pk_bf16_f32 v140, v140, v140
  v_and_b32 v140, 0xffff0000, v140
  v_sqrt_f32 v140, v140
  s_nop 0
  v_cvt_pk_bf16_f32 v140, v140, v140
  v_and_b32 v140, 0xffff0000, v140
  v_rcp_f32 v142, v140
  s_nop 0
  v_fma_f32 v143, -v140, v142, 1.0
  v_fma_f32 v142, v143, v142, v142
  v_mov_b32 v143, v142
  v_mov_b32 v140, v141
  v_pk_add_f32 v[96:97], v[96:97], v[140:141] neg_lo:[0,1] neg_hi:[0,1]
  v_pk_add_f32 v[98:99], v[98:99], v[140:141] neg_lo:[0,1] neg_hi:[0,1]
  v_pk_add_f32 v[100:101], v[100:101], v[140:141] neg_lo:[0,1] neg_hi:[0,1]
  v_pk_add_f32 v[102:103], v[102:103], v[140:141] neg_lo:[0,1] neg_hi:[0,1]
  v_pk_add_f32 v[104:105], v[104:105], v[140:141] neg_lo:[0,1] neg_hi:[0,1]
  v_pk_add_f32 v[106:107], v[106:107], v[140:141] neg_lo:[0,1] neg_hi:[0,1]
  v_pk_add_f32 v[108:109], v[108:109], v[140:141] neg_lo:[0,1] neg_hi:[0,1]
  v_pk_add_f32 v[110:111], v[110:111], v[140:141] neg_lo:[0,1] neg_hi:[0,1]
  v_pk_add_f32 v[112:113], v[112:113], v[140:141] neg_lo:[0,1] neg_hi:[0,1]
  v_pk_add_f32 v[114:115], v[114:115], v[140:141] neg_lo:[0,1] neg_hi:[0,1]
  v_pk_add_f32 v[116:117], v[116:117], v[140:141] neg_lo:[0,1] neg_hi:[0,1]
  v_pk_add_f32 v[118:119], v[118:119], v[140:141] neg_lo:[0,1] neg_hi:[0,1]
  v_pk_add_f32 v[120:121], v[120:121], v[140:141] neg_lo:[0,1] neg_hi:[0,1]
  v_pk_add_f32 v[122:123], v[122:123], v[140:141] neg_lo:[0,1] neg_hi:[0,1]
  v_pk_add_f32 v[124:125], v[124:125], v[140:141] neg_lo:[0,1] neg_hi:[0,1]
  v_pk_add_f32 v[126:127], v[126:127], v[140:141] neg_lo:[0,1] neg_hi:[0,1]
  v_cvt_pk_bf16_f32 v80, v96, v97
  v_cvt_pk_bf16_f32 v81, v98, v99
  v_cvt_pk_bf16_f32 v82, v100, v101
  v_cvt_pk_bf16_f32 v83, v102, v103
  v_cvt_pk_bf16_f32 v84, v104, v105
  v_cvt_pk_bf16_f32 v85, v106, v107
  v_cvt_pk_bf16_f32 v86, v108, v109
  v_cvt_pk_bf16_f32 v87, v110, v111
  v_cvt_pk_bf16_f32 v88, v112, v113
  v_cvt_pk_bf16_f32 v89, v114, v115
  v_cvt_pk_bf16_f32 v90, v116, v117
  v_cvt_pk_bf16_f32 v91, v118, v119
  v_cvt_pk_bf16_f32 v92, v120, v121
  v_cvt_pk_bf16_f32 v93, v122, v123
  v_cvt_pk_bf16_f32 v94, v124, v125
  v_cvt_pk_bf16_f32 v95, v126, v127
  v_lshlrev_b32 v96, 16, v80
  v_and_b32 v97, 0xffff0000, v80
  v_lshlrev_b32 v98, 16, v81
  v_and_b32 v99, 0xffff0000, v81
  v_lshlrev_b32 v100, 16, v82
  v_and_b32 v101, 0xffff0000, v82
  v_lshlrev_b32 v102, 16, v83
  v_and_b32 v103, 0xffff0000, v83
  v_lshlrev_b32 v104, 16, v84
  v_and_b32 v105, 0xffff0000, v84
  v_lshlrev_b32 v106, 16, v85
  v_and_b32 v107, 0xffff0000, v85
  v_lshlrev_b32 v108, 16, v86
  v_and_b32 v109, 0xffff0000, v86
  v_lshlrev_b32 v110, 16, v87
  v_and_b32 v111, 0xffff0000, v87
  v_lshlrev_b32 v112, 16, v88
  v_and_b32 v113, 0xffff0000, v88
  v_lshlrev_b32 v114, 16, v89
  v_and_b32 v115, 0xffff0000, v89
  v_lshlrev_b32 v116, 16, v90
  v_and_b32 v117, 0xffff0000, v90
  v_lshlrev_b32 v118, 16, v91
  v_and_b32 v119, 0xffff0000, v91
  v_lshlrev_b32 v120, 16, v92
  v_and_b32 v121, 0xffff0000, v92
  v_lshlrev_b32 v122, 16, v93
  v_and_b32 v123, 0xffff0000, v93
  v_lshlrev_b32 v124, 16, v94
  v_and_b32 v125, 0xffff0000, v94
  v_lshlrev_b32 v126, 16, v95
  v_and_b32 v127, 0xffff0000, v95
  v_pk_mul_f32 v[96:97], v[96:97], v[142:143]
  v_pk_mul_f32 v[98:99], v[98:99], v[142:143]
  v_pk_mul_f32 v[100:101], v[100:101], v[142:143]
  v_pk_mul_f32 v[102:103], v[102:103], v[142:143]
  v_pk_mul_f32 v[104:105], v[104:105], v[142:143]
  v_pk_mul_f32 v[106:107], v[106:107], v[142:143]
  v_pk_mul_f32 v[108:109], v[108:109], v[142:143]
  v_pk_mul_f32 v[110:111], v[110:111], v[142:143]
  v_pk_mul_f32 v[112:113], v[112:113], v[142:143]
  v_pk_mul_f32 v[114:115], v[114:115], v[142:143]
  v_pk_mul_f32 v[116:117], v[116:117], v[142:143]
  v_pk_mul_f32 v[118:119], v[118:119], v[142:143]
  v_pk_mul_f32 v[120:121], v[120:121], v[142:143]
  v_pk_mul_f32 v[122:123], v[122:123], v[142:143]
  v_pk_mul_f32 v[124:125], v[124:125], v[142:143]
  v_pk_mul_f32 v[126:127], v[126:127], v[142:143]
  s_lshl_b32 s82, s4, 4
  s_lshr_b32 s83, s5, 1
  s_add_u32 s82, s82, s83
  s_lshl_b32 s82, s82, 15
  s_lshl_b32 s83, s3, 13
  s_add_u32 s82, s82, s83
  s_lshl_b32 s83, s7, 7
  s_add_u32 s82, s82, s83
  v_cvt_pk_bf16_f32 v144, v96, v97
  v_cvt_pk_bf16_f32 v145, v98, v99
  v_cvt_pk_bf16_f32 v146, v104, v105
  v_cvt_pk_bf16_f32 v147, v106, v107
  v_cvt_pk_bf16_f32 v148, v100, v101
  v_cvt_pk_bf16_f32 v149, v102, v103
  v_cvt_pk_bf16_f32 v150, v108, v109
  v_cvt_pk_bf16_f32 v151, v110, v111
  buffer_store_dwordx4 v[144:147], v47, s[8:11], s82 offen sc1
  buffer_store_dwordx4 v[148:151], v47, s[8:11], s82 offen offset:256 sc1
  v_cvt_pk_bf16_f32 v152, v112, v113
  v_cvt_pk_bf16_f32 v153, v114, v115
  v_cvt_pk_bf16_f32 v154, v120, v121
  v_cvt_pk_bf16_f32 v155, v122, v123
  v_cvt_pk_bf16_f32 v156, v116, v117
  v_cvt_pk_bf16_f32 v157, v118, v119
  v_cvt_pk_bf16_f32 v158, v124, v125
  v_cvt_pk_bf16_f32 v159, v126, v127
  s_add_u32 s82, s82, 4096
  buffer_store_dwordx4 v[152:155], v47, s[8:11], s82 offen sc1
  buffer_store_dwordx4 v[156:159], v47, s[8:11], s82 offen offset:256 sc1
  s_mov_b32 s24, s58
  s_and_b32 s25, s59, 0xffff
  s_mov_b32 s26, 0x100
  s_mov_b32 s27, 0x20000
  v_mov_b32 v17, 0
  s_lshl_b32 s82, s4, 5
  buffer_load_dword v18, v17, s[24:27], s82 offen sc1
  s_waitcnt vmcnt(0)
  s_barrier
  v_mov_b32 v16, 1
  v_mov_b32 v17, 0
  s_cmp_eq_u32 s3, 0
  s_cbranch_scc0 L_parallel_sum__linear_kernel_hedgehog__glu_gated_reglu__prompt_kernel_v0_ln_np
  s_mov_b64 s[86:87], exec
  s_mov_b64 exec, 1
  v_readfirstlane_b32 s88, v18
  s_nop 3
  s_cmp_ge_u32 s88, 1
  s_cbranch_scc1 L_parallel_sum__linear_kernel_hedgehog__glu_gated_reglu__prompt_kernel_v0_ln_z_ok
  s_mov_b32 s89, 0
L_parallel_sum__linear_kernel_hedgehog__glu_gated_reglu__prompt_kernel_v0_ln_z:
  buffer_load_dword v18, v17, s[24:27], s82 offen sc1
  s_waitcnt vmcnt(0)
  v_readfirstlane_b32 s88, v18
  s_add_u32 s89, s89, 1
  s_nop 2
  s_cmp_ge_u32 s88, 1
  s_cbranch_scc1 L_parallel_sum__linear_kernel_hedgehog__glu_gated_reglu__prompt_kernel_v0_ln_z_ok
  s_cmp_ge_u32 s89, 1048576
  s_cbranch_scc1 L_parallel_sum__linear_kernel_hedgehog__glu_gated_reglu__prompt_kernel_v0_ln_z_ok
  s_sleep 1
  s_branch L_parallel_sum__linear_kernel_hedgehog__glu_gated_reglu__prompt_kernel_v0_ln_z
L_parallel_sum__linear_kernel_hedgehog__glu_gated_reglu__prompt_kernel_v0_ln_z_ok:
  s_add_u32 s24, s60, 0x3000000
  s_addc_u32 s25, s61, 0
  s_and_b32 s25, s25, 0xffff
  s_mov_b32 s26, 0xc400
  s_mov_b32 s27, 0x20000
  s_lshl_b32 s82, s4, 7
  s_add_u32 s82, s82, 49152
  buffer_atomic_add v16, v17, s[24:27], s82 offen sc1
  s_mov_b64 exec, s[86:87]
L_parallel_sum__linear_kernel_hedgehog__glu_gated_reglu__prompt_kernel_v0_ln_np:
  v_mov_b32 v48, 0
  v_mov_b32 v49, 0
  v_mov_b32 v50, 0
  v_mov_b32 v51, 0
  v_mov_b32 v52, 0
  v_mov_b32 v53, 0
  v_mov_b32 v54, 0
  v_mov_b32 v55, 0
  v_mov_b32 v56, 0
  v_mov_b32 v57, 0
  v_mov_b32 v58, 0
  v_mov_b32 v59, 0
  v_mov_b32 v60, 0
  v_mov_b32 v61, 0
  v_mov_b32 v62, 0
  v_mov_b32 v63, 0
  v_mov_b32 v64, 0
  v_mov_b32 v65, 0
  v_mov_b32 v66, 0
  v_mov_b32 v67, 0
  v_mov_b32 v68, 0
  v_mov_b32 v69, 0
  v_mov_b32 v70, 0
  v_mov_b32 v71, 0
  v_mov_b32 v72, 0
  v_mov_b32 v73, 0
  v_mov_b32 v74, 0
  v_mov_b32 v75, 0
  v_mov_b32 v76, 0
  v_mov_b32 v77, 0
  v_mov_b32 v78, 0
  v_mov_b32 v79, 0
  v_mov_b32 v80, 0
  v_mov_b32 v81, 0
  v_mov_b32 v82, 0
  v_mov_b32 v83, 0
  v_mov_b32 v84, 0
  v_mov_b32 v85, 0
  v_mov_b32 v86, 0
  v_mov_b32 v87, 0
  v_mov_b32 v88, 0
  v_mov_b32 v89, 0
  v_mov_b32 v90, 0
  v_mov_b32 v91, 0
  v_mov_b32 v92, 0
  v_mov_b32 v93, 0
  v_mov_b32 v94, 0
  v_mov_b32 v95, 0
  v_mov_b32 v96, 0
  v_mov_b32 v97, 0
  v_mov_b32 v98, 0
  v_mov_b32 v99, 0
  v_mov_b32 v100, 0
  v_mov_b32 v101, 0
  v_mov_b32 v102, 0
  v_mov_b32 v103, 0
  v_mov_b32 v104, 0
  v_mov_b32 v105, 0
  v_mov_b32 v106, 0
  v_mov_b32 v107, 0
  v_mov_b32 v108, 0
  v_mov_b32 v109, 0
  v_mov_b32 v110, 0
  v_mov_b32 v111, 0
  v_mov_b32 v112, 0
  v_mov_b32 v113, 0
  v_mov_b32 v114, 0
  v_mov_b32 v115, 0
  v_mov_b32 v116, 0
  v_mov_b32 v117, 0
  v_mov_b32 v118, 0
  v_mov_b32 v119, 0
  v_mov_b32 v120, 0
  v_mov_b32 v121, 0
  v_mov_b32 v122, 0
  v_mov_b32 v123, 0
  v_mov_b32 v124, 0
  v_mov_b32 v125, 0
  v_mov_b32 v126, 0
  v_mov_b32 v127, 0
  v_mov_b32 v128, 0
  v_mov_b32 v129, 0
  v_mov_b32 v130, 0
  v_mov_b32 v131, 0
  v_mov_b32 v132, 0
  v_mov_b32 v133, 0
  v_mov_b32 v134, 0
  v_mov_b32 v135, 0
  v_mov_b32 v136, 0
  v_mov_b32 v137, 0
  v_mov_b32 v138, 0
  v_mov_b32 v139, 0
  v_mov_b32 v140, 0
  v_mov_b32 v141, 0
  v_mov_b32 v142, 0
  v_mov_b32 v143, 0
  v_mov_b32 v144, 0
  v_mov_b32 v145, 0
  v_mov_b32 v146, 0
  v_mov_b32 v147, 0
  v_mov_b32 v148, 0
  v_mov_b32 v149, 0
  v_mov_b32 v150, 0
  v_mov_b32 v151, 0
  v_mov_b32 v152, 0
  v_mov_b32 v153, 0
  v_mov_b32 v154, 0
  v_mov_b32 v155, 0
  v_mov_b32 v156, 0
  v_mov_b32 v157, 0
  v_mov_b32 v158, 0
  v_mov_b32 v159, 0
  v_mov_b32 v160, 0
  v_mov_b32 v161, 0
  v_mov_b32 v162, 0
  v_mov_b32 v163, 0
  v_mov_b32 v164, 0
  v_mov_b32 v165, 0
  v_mov_b32 v166, 0
  v_mov_b32 v167, 0
  v_mov_b32 v168, 0
  v_mov_b32 v169, 0
  v_mov_b32 v170, 0
  v_mov_b32 v171, 0
  v_mov_b32 v172, 0
  v_mov_b32 v173, 0
  v_mov_b32 v174, 0
  v_mov_b32 v175, 0
  v_mov_b32 v176, 0
  v_mov_b32 v177, 0
  v_mov_b32 v178, 0
  v_mov_b32 v179, 0
  v_mov_b32 v180, 0
  v_mov_b32 v181, 0
  v_mov_b32 v182, 0
  v_mov_b32 v183, 0
  v_mov_b32 v184, 0
  v_mov_b32 v185, 0
  v_mov_b32 v186, 0
  v_mov_b32 v187, 0
  v_mov_b32 v188, 0
  v_mov_b32 v189, 0
  v_mov_b32 v190, 0
  v_mov_b32 v191, 0
  v_mov_b32 v192, 0
  v_mov_b32 v193, 0
  v_mov_b32 v194, 0
  v_mov_b32 v195, 0
  v_mov_b32 v196, 0
  v_mov_b32 v197, 0
  v_mov_b32 v198, 0
  v_mov_b32 v199, 0
  v_mov_b32 v200, 0
  v_mov_b32 v201, 0
  v_mov_b32 v202, 0
  v_mov_b32 v203, 0
  v_mov_b32 v204, 0
  v_mov_b32 v205, 0
  v_mov_b32 v206, 0
  v_mov_b32 v207, 0
  v_mov_b32 v208, 0
  v_mov_b32 v209, 0
  v_mov_b32 v210, 0
  v_mov_b32 v211, 0
  v_mov_b32 v212, 0
  v_mov_b32 v213, 0
  v_mov_b32 v214, 0
  v_mov_b32 v215, 0
  v_mov_b32 v216, 0
  v_mov_b32 v217, 0
  v_mov_b32 v218, 0
  v_mov_b32 v219, 0
  v_mov_b32 v220, 0
  v_mov_b32 v221, 0
  v_mov_b32 v222, 0
  v_mov_b32 v223, 0
  v_mov_b32 v224, 0
  v_mov_b32 v225, 0
  v_mov_b32 v226, 0
  v_mov_b32 v227, 0
  v_mov_b32 v228, 0
  v_mov_b32 v229, 0
  v_mov_b32 v230, 0
  v_mov_b32 v231, 0
  v_mov_b32 v232, 0
  v_mov_b32 v233, 0
  v_mov_b32 v234, 0
  v_mov_b32 v235, 0
  v_mov_b32 v236, 0
  v_mov_b32 v237, 0
  v_mov_b32 v238, 0
  v_mov_b32 v239, 0
  v_mov_b32 v240, 0
  v_mov_b32 v241, 0
  v_mov_b32 v242, 0
  v_mov_b32 v243, 0
  v_mov_b32 v244, 0
  v_mov_b32 v245, 0
  v_mov_b32 v246, 0
  v_mov_b32 v247, 0
  v_mov_b32 v248, 0
  v_mov_b32 v249, 0
  v_mov_b32 v250, 0
  v_mov_b32 v251, 0
  v_mov_b32 v252, 0
  v_mov_b32 v253, 0
  v_mov_b32 v254, 0
  v_mov_b32 v255, 0
  v_accvgpr_write_b32 a0, 0
  v_accvgpr_write_b32 a1, 0
  v_accvgpr_write_b32 a2, 0
  v_accvgpr_write_b32 a3, 0
  v_accvgpr_write_b32 a4, 0
  v_accvgpr_write_b32 a5, 0
  v_accvgpr_write_b32 a6, 0
  v_accvgpr_write_b32 a7, 0
  v_accvgpr_write_b32 a8, 0
  v_accvgpr_write_b32 a9, 0
  v_accvgpr_write_b32 a10, 0
  v_accvgpr_write_b32 a11, 0
  v_accvgpr_write_b32 a12, 0
  v_accvgpr_write_b32 a13, 0
  v_accvgpr_write_b32 a14, 0
  v_accvgpr_write_b32 a15, 0
  v_accvgpr_write_b32 a16, 0
  v_accvgpr_write_b32 a17, 0
  v_accvgpr_write_b32 a18, 0
  v_accvgpr_write_b32 a19, 0
  v_accvgpr_write_b32 a20, 0
  v_accvgpr_write_b32 a21, 0
  v_accvgpr_write_b32 a22, 0
  v_accvgpr_write_b32 a23, 0
  v_accvgpr_write_b32 a24, 0
  v_accvgpr_write_b32 a25, 0
  v_accvgpr_write_b32 a26, 0
  v_accvgpr_write_b32 a27, 0
  v_accvgpr_write_b32 a28, 0
  v_accvgpr_write_b32 a29, 0
  v_accvgpr_write_b32 a30, 0
  v_accvgpr_write_b32 a31, 0
  v_accvgpr_write_b32 a32, 0
  v_accvgpr_write_b32 a33, 0
  v_accvgpr_write_b32 a34, 0
  v_accvgpr_write_b32 a35, 0
  v_accvgpr_write_b32 a36, 0
  v_accvgpr_write_b32 a37, 0
  v_accvgpr_write_b32 a38, 0
  v_accvgpr_write_b32 a39, 0
  v_accvgpr_write_b32 a40, 0
  v_accvgpr_write_b32 a41, 0
  v_accvgpr_write_b32 a42, 0
  v_accvgpr_write_b32 a43, 0
  v_accvgpr_write_b32 a44, 0
  v_accvgpr_write_b32 a45, 0
  v_accvgpr_write_b32 a46, 0
  v_accvgpr_write_b32 a47, 0
  v_accvgpr_write_b32 a48, 0
  v_accvgpr_write_b32 a49, 0
  v_accvgpr_write_b32 a50, 0
  v_accvgpr_write_b32 a51, 0
  v_accvgpr_write_b32 a52, 0
  v_accvgpr_write_b32 a53, 0
  v_accvgpr_write_b32 a54, 0
  v_accvgpr_write_b32 a55, 0
  v_accvgpr_write_b32 a56, 0
  v_accvgpr_write_b32 a57, 0
  v_accvgpr_write_b32 a58, 0
  v_accvgpr_write_b32 a59, 0
  v_accvgpr_write_b32 a60, 0
  v_accvgpr_write_b32 a61, 0
  v_accvgpr_write_b32 a62, 0
  v_accvgpr_write_b32 a63, 0
  v_accvgpr_write_b32 a64, 0
  v_accvgpr_write_b32 a65, 0
  v_accvgpr_write_b32 a66, 0
  v_accvgpr_write_b32 a67, 0
  v_accvgpr_write_b32 a68, 0
  v_accvgpr_write_b32 a69, 0
  v_accvgpr_write_b32 a70, 0
  v_accvgpr_write_b32 a71, 0
  v_accvgpr_write_b32 a72, 0
  v_accvgpr_write_b32 a73, 0
  v_accvgpr_write_b32 a74, 0
  v_accvgpr_write_b32 a75, 0
  v_accvgpr_write_b32 a76, 0
  v_accvgpr_write_b32 a77, 0
  v_accvgpr_write_b32 a78, 0
  v_accvgpr_write_b32 a79, 0
  v_accvgpr_write_b32 a80, 0
  v_accvgpr_write_b32 a81, 0
  v_accvgpr_write_b32 a82, 0
  v_accvgpr_write_b32 a83, 0
  v_accvgpr_write_b32 a84, 0
  v_accvgpr_write_b32 a85, 0
  v_accvgpr_write_b32 a86, 0
  v_accvgpr_write_b32 a87, 0
  v_accvgpr_write_b32 a88, 0
  v_accvgpr_write_b32 a89, 0
  v_accvgpr_write_b32 a90, 0
  v_accvgpr_write_b32 a91, 0
  v_accvgpr_write_b32 a92, 0
  v_accvgpr_write_b32 a93, 0
  v_accvgpr_write_b32 a94, 0
  v_accvgpr_write_b32 a95, 0
  v_accvgpr_write_b32 a96, 0
  v_accvgpr_write_b32 a97, 0
  v_accvgpr_write_b32 a98, 0
  v_accvgpr_write_b32 a99, 0
  v_accvgpr_write_b32 a100, 0
  v_accvgpr_write_b32 a101, 0
  v_accvgpr_write_b32 a102, 0
  v_accvgpr_write_b32 a103, 0
  v_accvgpr_write_b32 a104, 0
  v_accvgpr_write_b32 a105, 0
  v_accvgpr_write_b32 a106, 0
  v_accvgpr_write_b32 a107, 0
  v_accvgpr_write_b32 a108, 0
  v_accvgpr_write_b32 a109, 0
  v_accvgpr_write_b32 a110, 0
  v_accvgpr_write_b32 a111, 0
  s_cmp_eq_u32 s3, 0
  s_cbranch_scc0 L_parallel_sum__linear_kernel_hedgehog__glu_gated_reglu__prompt_kernel_v0_ln_np1
  s_mov_b64 exec, 1
  s_mov_b32 s89, 0
L_parallel_sum__linear_kernel_hedgehog__glu_gated_reglu__prompt_kernel_v0_ln:
  buffer_load_dword v18, v17, s[24:27], s82 offen sc1
  s_waitcnt vmcnt(0)
  v_readfirstlane_b32 s88, v18
  s_add_u32 s89, s89, 1
  s_nop 2
  s_cmp_ge_u32 s88, 32
  s_cbranch_scc1 L_parallel_sum__linear_kernel_hedgehog__glu_gated_reglu__prompt_kernel_v0_ln_ok
  s_cmp_ge_u32 s89, 1048576
  s_cbranch_scc1 L_parallel_sum__linear_kernel_hedgehog__glu_gated_reglu__prompt_kernel_v0_ln_ok
  s_sleep 1
  s_branch L_parallel_sum__linear_kernel_hedgehog__glu_gated_reglu__prompt_kernel_v0_ln
L_parallel_sum__linear_kernel_hedgehog__glu_gated_reglu__prompt_kernel_v0_ln_ok:
  s_mov_b64 exec, s[86:87]
L_parallel_sum__linear_kernel_hedgehog__glu_gated_reglu__prompt_kernel_v0_ln_np1:
  s_barrier
  s_add_u32 m0, s81, 0
  s_nop 0
  buffer_load_dwordx4 v2, s[8:11], s28 offen sc1 lds
  s_add_u32 m0, s81, 1024
  s_nop 0
  buffer_load_dwordx4 v3, s[8:11], s28 offen sc1 lds
  s_add_u32 m0, s81, 2048
  s_nop 0
  buffer_load_dwordx4 v4, s[8:11], s28 offen sc1 lds
  s_add_u32 m0, s81, 3072
  s_nop 0
  buffer_load_dwordx4 v5, s[8:11], s28 offen sc1 lds
  s_add_u32 s28, s28, 1024
  s_add_u32 m0, s81, 36864
  s_nop 0
  buffer_load_dwordx4 v2, s[8:11], s28 offen sc1 lds
  s_add_u32 m0, s81, 37888
  s_nop 0
  buffer_load_dwordx4 v3, s[8:11], s28 offen sc1 lds
  s_add_u32 m0, s81, 38912
  s_nop 0
  buffer_load_dwordx4 v4, s[8:11], s28 offen sc1 lds
  s_add_u32 m0, s81, 39936
  s_nop 0
  buffer_load_dwordx4 v5, s[8:11], s28 offen sc1 lds
  s_add_u32 s28, s28, 1024
  s_add_u32 m0, s81, 73728
  s_nop 0
  buffer_load_dwordx4 v2, s[8:11], s28 offen sc1 lds
  s_add_u32 m0, s81, 74752
  s_nop 0
  buffer_load_dwordx4 v3, s[8:11], s28 offen sc1 lds
  s_add_u32 m0, s81, 75776
  s_nop 0
  buffer_load_dwordx4 v4, s[8:11], s28 offen sc1 lds
  s_add_u32 m0, s81, 76800
  s_nop 0
  buffer_load_dwordx4 v5, s[8:11], s28 offen sc1 lds
  s_add_u32 s28, s28, 1024
  s_add_u32 m0, s76, 73728
  s_nop 0
  buffer_load_dwordx4 v6, s[12:15], s29 offen lds
  s_add_u32 s29, s29, s32
  s_add_u32 m0, s77, 73728
  s_nop 0
  buffer_load_dwordx4 v7, s[16:19], s30 offen lds
  s_add_u32 s30, s30, s33
  s_add_u32 m0, s78, 73728
  s_nop 0
  buffer_load_dwordx4 v8, s[20:23], s31 offen lds
  s_add_u32 s31, s31, s34
  s_add_u32 m0, s79, 73728
  s_nop 0
  buffer_load_dwordx4 v9, s[64:67], s72 offen lds
  s_add_u32 s72, s72, s74
  s_add_u32 m0, s80, 73728
  s_nop 0
  buffer_load_dwordx4 v10, s[68:71], s73 offen lds
  s_add_u32 s73, s73, s75
  s_add_u32 m0, s81, 110592
  s_nop 0
  buffer_load_dwordx4 v2, s[8:11], s28 offen sc1 lds
  s_add_u32 m0, s81, 111616
  s_nop 0
  buffer_load_dwordx4 v3, s[8:11], s28 offen sc1 lds
  s_add_u32 m0, s81, 112640
  s_nop 0
  buffer_load_dwordx4 v4, s[8:11], s28 offen sc1 lds
  s_add_u32 m0, s81, 113664
  s_nop 0
  buffer_load_dwordx4 v5, s[8:11], s28 offen sc1 lds
  s_add_u32 s28, s28, 1024
  s_add_u32 m0, s76, 110592
  s_nop 0
  buffer_load_dwordx4 v6, s[12:15], s29 offen lds
  s_add_u32 s29, s29, s32
  s_add_u32 m0, s77, 110592
  s_nop 0
  buffer_load_dwordx4 v7, s[16:19], s30 offen lds
  s_add_u32 s30, s30, s33
  s_add_u32 m0, s78, 110592
  s_nop 0
  buffer_load_dwordx4 v8, s[20:23], s31 offen lds
  s_add_u32 s31, s31, s34
  s_add_u32 m0, s79, 110592
  s_nop 0
  buffer_load_dwordx4 v9, s[64:67], s72 offen lds
  s_add_u32 s72, s72, s74
  s_add_u32 m0, s80, 110592
  s_nop 0
  buffer_load_dwordx4 v10, s[68:71], s73 offen lds
  s_add_u32 s73, s73, s75
  s_mov_b32 s36, 0
  s_mov_b32 s39, 0
  s_mov_b32 s62, 36864
  s_mov_b32 s63, 0xfffe5000
  s_waitcnt vmcnt(22)
  s_barrier
  ds_read_b64_tr_b16 a[176:177], v14 offset:64
  ds_read_b64_tr_b16 a[178:179], v14 offset:3136
  ds_read_b128 a[112:115], v11 offset:0
  ds_read_b128 a[116:119], v11 offset:1024
  ds_read_b128 a[120:123], v11 offset:2048
  ds_read_b128 a[124:127], v11 offset:3072
  ds_read_b128 a[128:131], v11 offset:4096
  ds_read_b128 a[132:135], v11 offset:5120
  ds_read_b128 a[136:139], v11 offset:6144
  ds_read_b128 a[140:143], v11 offset:7168
  ds_read_b64_tr_b16 a[180:181], v15 offset:64
  ds_read_b64_tr_b16 a[182:183], v15 offset:3136
  ds_read_b64_tr_b16 a[184:185], v14 offset:128
  ds_read_b64_tr_b16 a[186:187], v14 offset:3200
  ds_read_b64_tr_b16 a[188:189], v15 offset:128
  ds_read_b64_tr_b16 a[190:191], v15 offset:3200
  ds_read_b64_tr_b16 a[192:193], v12 offset:0
  ds_read_b64_tr_b16 a[194:195], v12 offset:3584
  ds_read_b64_tr_b16 a[196:197], v12 offset:7168
  ds_read_b64_tr_b16 a[198:199], v12 offset:10752
  ds_read_b64_tr_b16 a[200:201], v12 offset:32
  ds_read_b64_tr_b16 a[202:203], v12 offset:3616
  ds_read_b64_tr_b16 a[204:205], v12 offset:7200
  ds_read_b64_tr_b16 a[206:207], v12 offset:10784
  ds_read_b64_tr_b16 a[208:209], v13 offset:0
  ds_read_b64_tr_b16 a[210:211], v13 offset:3584
  ds_read_b64_tr_b16 a[212:213], v13 offset:7168
  ds_read_b64_tr_b16 a[214:215], v13 offset:10752
  s_add_u32 s39, s39, 36864
  s_cmp_eq_u32 s39, 147456
  s_cselect_b32 s39, 0, s39
  s_cselect_b32 s37, s63, s62
  v_add_u32 v11, s37, v11
  v_add_u32 v12, s37, v12
  v_add_u32 v14, s37, v14
  v_add_u32 v15, s37, v15
  v_add_u32 v13, s37, v13
  s_mov_b32 s38, 16
.p2align 6
L_parallel_sum__linear_kernel_hedgehog__glu_gated_reglu__prompt_kernel_loop0:
  s_cmp_le_u32 s38, 2
  s_cselect_b32 s28, 0x7f000000, s28
  s_cmp_eq_u32 s38, 2
  s_cbranch_scc0 L_parallel_sum__linear_kernel_hedgehog__glu_gated_reglu__prompt_kernel_c20
  s_cmp_eq_u32 s3, 3
  s_cbranch_scc0 L_parallel_sum__linear_kernel_hedgehog__glu_gated_reglu__prompt_kernel_cq0
  s_getpc_b64 s[86:87]
L_parallel_sum__linear_kernel_hedgehog__glu_gated_reglu__prompt_kernel_cq0_pc:
  s_sub_u32 s86, s86, L_parallel_sum__linear_kernel_hedgehog__glu_gated_reglu__prompt_kernel_cq0_pc - parallel_sum__linear_kernel_hedgehog__glu_gated_reglu__prompt_kernel
  s_subb_u32 s87, s87, 0
  s_lshr_b32 s88, s2, 3
  s_mul_i32 s88, s88, 24*128
  v_lshlrev_b32 v42, 7, v1
  v_add_u32 v42, s88, v42
  v_cmp_gt_u32 vcc, 24, v1
  s_nop 3
  s_and_saveexec_b64 s[88:89], vcc
  v_cmp_gt_u32 vcc, L_parallel_sum__linear_kernel_hedgehog__glu_gated_reglu__prompt_kernel_done - parallel_sum__linear_kernel_hedgehog__glu_gated_reglu__prompt_kernel, v42
  s_nop 3
  s_and_b64 exec, exec, vcc
  s_cbranch_execz L_parallel_sum__linear_kernel_hedgehog__glu_gated_reglu__prompt_kernel_cq0_x
  global_load_dword v43, v42, s[86:87]
L_parallel_sum__linear_kernel_hedgehog__glu_gated_reglu__prompt_kernel_cq0_x:
  s_mov_b64 exec, s[88:89]
L_parallel_sum__linear_kernel_hedgehog__glu_gated_reglu__prompt_kernel_cq0:
L_parallel_sum__linear_kernel_hedgehog__glu_gated_reglu__prompt_kernel_c20:
  s_lshr_b32 s49, s2, 5
  s_sub_u32 s49, 14, s49
  s_cmp_eq_u32 s38, s49
  s_cbranch_scc0 L_parallel_sum__linear_kernel_hedgehog__glu_gated_reglu__prompt_kernel_pf0
  s_mov_b32 s24, s54
  s_and_b32 s25, s55, 0xffff
  s_mov_b32 s26, 0x700000
  s_mov_b32 s27, 0x20000
  v_lshlrev_b32 v46, 7, v1
  v_and_b32 v47, 15, v1
  v_lshlrev_b32 v47, 7, v47
  s_lshl_b32 s90, s2, 2
  s_add_u32 s90, s90, s3
  s_mul_i32 s88, s90, 7168
  s_lshl_b32 s89, s90, 11
  buffer_load_dword v44, v46, s[24:27], s88 offen
  s_mov_b32 s24, s46
  s_and_b32 s25, s47, 0xffff
  s_mov_b32 s26, 0x200000
  s_mov_b32 s27, 0x20000
  buffer_load_dword v45, v47, s[24:27], s89 offen
L_parallel_sum__linear_kernel_hedgehog__glu_gated_reglu__prompt_kernel_pf0:
  s_waitcnt vmcnt(18) lgkmcnt(0)
  s_barrier
  v_mfma_f32_16x16x32_bf16 v[48:51], a[176:179], a[112:115], v[48:51]
  s_add_u32 m0, s36, s81
  v_mfma_f32_16x16x32_bf16 v[52:55], a[176:179], a[116:119], v[52:55]
  ds_read_b64_tr_b16 a[216:217], v14 offset:64
  v_mfma_f32_16x16x32_bf16 v[56:59], a[176:179], a[120:123], v[56:59]
  ds_read_b64_tr_b16 a[218:219], v14 offset:3136
  v_mfma_f32_16x16x32_bf16 v[60:63], a[176:179], a[124:127], v[60:63]
  buffer_load_dwordx4 v2, s[8:11], s28 offen sc1 lds
  v_mfma_f32_16x16x32_bf16 v[64:67], a[176:179], a[128:131], v[64:67]
  ds_read_b128 a[144:147], v11 offset:0
  v_mfma_f32_16x16x32_bf16 v[68:71], a[176:179], a[132:135], v[68:71]
  s_add_u32 m0, m0, 1024
  v_mfma_f32_16x16x32_bf16 v[72:75], a[176:179], a[136:139], v[72:75]
  ds_read_b128 a[148:151], v11 offset:1024
  v_mfma_f32_16x16x32_bf16 v[76:79], a[176:179], a[140:143], v[76:79]
  ds_read_b128 a[152:155], v11 offset:2048
  v_mfma_f32_16x16x32_bf16 v[108:111], a[180:183], a[140:143], v[108:111]
  v_mfma_f32_16x16x32_bf16 v[104:107], a[180:183], a[136:139], v[104:107]
  buffer_load_dwordx4 v3, s[8:11], s28 offen sc1 lds
  v_mfma_f32_16x16x32_bf16 v[100:103], a[180:183], a[132:135], v[100:103]
  ds_read_b128 a[156:159], v11 offset:3072
  v_mfma_f32_16x16x32_bf16 v[96:99], a[180:183], a[128:131], v[96:99]
  s_add_u32 m0, m0, 1024
  v_mfma_f32_16x16x32_bf16 v[92:95], a[180:183], a[124:127], v[92:95]
  ds_read_b128 a[160:163], v11 offset:4096
  v_mfma_f32_16x16x32_bf16 v[88:91], a[180:183], a[120:123], v[88:91]
  buffer_load_dwordx4 v4, s[8:11], s28 offen sc1 lds
  v_mfma_f32_16x16x32_bf16 v[84:87], a[180:183], a[116:119], v[84:87]
  ds_read_b128 a[164:167], v11 offset:5120
  v_mfma_f32_16x16x32_bf16 v[80:83], a[180:183], a[112:115], v[80:83]
  ds_read_b128 a[168:171], v11 offset:6144
  v_mfma_f32_16x16x32_bf16 v[112:115], a[112:115], a[184:187], v[112:115]
  s_add_u32 m0, m0, 1024
  v_mfma_f32_16x16x32_bf16 v[116:119], a[116:119], a[184:187], v[116:119]
  v_mfma_f32_16x16x32_bf16 v[120:123], a[120:123], a[184:187], v[120:123]
  ds_read_b128 a[172:175], v11 offset:7168
  v_mfma_f32_16x16x32_bf16 v[124:127], a[124:127], a[184:187], v[124:127]
  buffer_load_dwordx4 v5, s[8:11], s28 offen sc1 lds
  v_mfma_f32_16x16x32_bf16 v[128:131], a[128:131], a[184:187], v[128:131]
  ds_read_b64_tr_b16 a[220:221], v15 offset:64
  v_mfma_f32_16x16x32_bf16 v[132:135], a[132:135], a[184:187], v[132:135]
  s_add_u32 s28, s28, 1024
  v_mfma_f32_16x16x32_bf16 v[136:139], a[136:139], a[184:187], v[136:139]
  ds_read_b64_tr_b16 a[222:223], v15 offset:3136
  v_mfma_f32_16x16x32_bf16 v[140:143], a[140:143], a[184:187], v[140:143]
  ds_read_b64_tr_b16 a[224:225], v14 offset:128
  v_mfma_f32_16x16x32_bf16 v[172:175], a[140:143], a[188:191], v[172:175]
  s_add_u32 m0, s36, s76
  v_mfma_f32_16x16x32_bf16 v[168:171], a[136:139], a[188:191], v[168:171]
  ds_read_b64_tr_b16 a[226:227], v14 offset:3200
  v_mfma_f32_16x16x32_bf16 v[164:167], a[132:135], a[188:191], v[164:167]
  v_mfma_f32_16x16x32_bf16 v[160:163], a[128:131], a[188:191], v[160:163]
  buffer_load_dwordx4 v6, s[12:15], s29 offen lds
  v_mfma_f32_16x16x32_bf16 v[156:159], a[124:127], a[188:191], v[156:159]
  ds_read_b64_tr_b16 a[228:229], v15 offset:128
  v_mfma_f32_16x16x32_bf16 v[152:155], a[120:123], a[188:191], v[152:155]
  s_add_u32 s29, s29, s32
  v_mfma_f32_16x16x32_bf16 v[148:151], a[116:119], a[188:191], v[148:151]
  ds_read_b64_tr_b16 a[230:231], v15 offset:3200
  v_mfma_f32_16x16x32_bf16 v[144:147], a[112:115], a[188:191], v[144:147]
  ds_read_b64_tr_b16 a[232:233], v12 offset:0
  v_mfma_f32_16x16x32_bf16 v[176:179], a[192:195], a[112:115], v[176:179]
  s_add_u32 m0, s36, s77
  v_mfma_f32_16x16x32_bf16 v[180:183], a[192:195], a[116:119], v[180:183]
  ds_read_b64_tr_b16 a[234:235], v12 offset:3584
  v_mfma_f32_16x16x32_bf16 v[184:187], a[192:195], a[120:123], v[184:187]
  buffer_load_dwordx4 v7, s[16:19], s30 offen lds
  v_mfma_f32_16x16x32_bf16 v[188:191], a[192:195], a[124:127], v[188:191]
  v_mfma_f32_16x16x32_bf16 v[192:195], a[192:195], a[128:131], v[192:195]
  ds_read_b64_tr_b16 a[236:237], v12 offset:7168
  v_mfma_f32_16x16x32_bf16 v[196:199], a[192:195], a[132:135], v[196:199]
  ds_read_b64_tr_b16 a[238:239], v12 offset:10752
  v_mfma_f32_16x16x32_bf16 v[200:203], a[192:195], a[136:139], v[200:203]
  s_add_u32 s30, s30, s33
  v_mfma_f32_16x16x32_bf16 v[204:207], a[192:195], a[140:143], v[204:207]
  ds_read_b64_tr_b16 a[240:241], v12 offset:32
  v_mfma_f32_16x16x32_bf16 v[236:239], a[196:199], a[140:143], v[236:239]
  s_add_u32 m0, s36, s78
  v_mfma_f32_16x16x32_bf16 v[232:235], a[196:199], a[136:139], v[232:235]
  ds_read_b64_tr_b16 a[242:243], v12 offset:3616
  v_mfma_f32_16x16x32_bf16 v[228:231], a[196:199], a[132:135], v[228:231]
  buffer_load_dwordx4 v8, s[20:23], s31 offen lds
  v_mfma_f32_16x16x32_bf16 v[224:227], a[196:199], a[128:131], v[224:227]
  ds_read_b64_tr_b16 a[244:245], v12 offset:7200
  v_mfma_f32_16x16x32_bf16 v[220:223], a[196:199], a[124:127], v[220:223]
  v_mfma_f32_16x16x32_bf16 v[216:219], a[196:199], a[120:123], v[216:219]
  ds_read_b64_tr_b16 a[246:247], v12 offset:10784
  v_mfma_f32_16x16x32_bf16 v[212:215], a[196:199], a[116:119], v[212:215]
  s_add_u32 s31, s31, s34
  v_mfma_f32_16x16x32_bf16 v[208:211], a[196:199], a[112:115], v[208:211]
  ds_read_b64_tr_b16 a[248:249], v13 offset:0
  v_mfma_f32_16x16x32_bf16 v[240:243], a[200:203], a[112:115], v[240:243]
  s_add_u32 m0, s36, s79
  v_mfma_f32_16x16x32_bf16 v[244:247], a[200:203], a[116:119], v[244:247]
  ds_read_b64_tr_b16 a[250:251], v13 offset:3584
  v_mfma_f32_16x16x32_bf16 v[248:251], a[200:203], a[120:123], v[248:251]
  buffer_load_dwordx4 v9, s[64:67], s72 offen lds
  v_mfma_f32_16x16x32_bf16 v[252:255], a[200:203], a[124:127], v[252:255]
  ds_read_b64_tr_b16 a[252:253], v13 offset:7168
  v_mfma_f32_16x16x32_bf16 a[0:3], a[200:203], a[128:131], a[0:3]
  ds_read_b64_tr_b16 a[254:255], v13 offset:10752
  v_mfma_f32_16x16x32_bf16 a[4:7], a[200:203], a[132:135], a[4:7]
  v_mfma_f32_16x16x32_bf16 a[8:11], a[200:203], a[136:139], a[8:11]
  s_add_u32 s72, s72, s74
  v_mfma_f32_16x16x32_bf16 a[12:15], a[200:203], a[140:143], a[12:15]
  s_add_u32 s39, s39, 36864
  v_mfma_f32_16x16x32_bf16 a[44:47], a[204:207], a[140:143], a[44:47]
  s_cmp_eq_u32 s39, 147456
  v_mfma_f32_16x16x32_bf16 a[40:43], a[204:207], a[136:139], a[40:43]
  s_cselect_b32 s39, 0, s39
  v_mfma_f32_16x16x32_bf16 a[36:39], a[204:207], a[132:135], a[36:39]
  s_cselect_b32 s37, s63, s62
  v_mfma_f32_16x16x32_bf16 a[32:35], a[204:207], a[128:131], a[32:35]
  s_add_u32 m0, s36, s80
  v_mfma_f32_16x16x32_bf16 a[28:31], a[204:207], a[124:127], a[28:31]
  v_add_u32 v11, s37, v11
  v_mfma_f32_16x16x32_bf16 a[24:27], a[204:207], a[120:123], a[24:27]
  buffer_load_dwordx4 v10, s[68:71], s73 offen lds
  v_mfma_f32_16x16x32_bf16 a[20:23], a[204:207], a[116:119], a[20:23]
  v_mfma_f32_16x16x32_bf16 a[16:19], a[204:207], a[112:115], a[16:19]
  v_add_u32 v12, s37, v12
  v_mfma_f32_16x16x32_bf16 a[48:51], a[208:211], a[112:115], a[48:51]
  v_add_u32 v14, s37, v14
  v_mfma_f32_16x16x32_bf16 a[52:55], a[208:211], a[116:119], a[52:55]
  s_add_u32 s73, s73, s75
  v_mfma_f32_16x16x32_bf16 a[56:59], a[208:211], a[120:123], a[56:59]
  v_add_u32 v15, s37, v15
  v_mfma_f32_16x16x32_bf16 a[60:63], a[208:211], a[124:127], a[60:63]
  s_add_u32 s36, s36, 36864
  v_mfma_f32_16x16x32_bf16 a[64:67], a[208:211], a[128:131], a[64:67]
  s_cmp_eq_u32 s36, 147456
  v_mfma_f32_16x16x32_bf16 a[68:71], a[208:211], a[132:135], a[68:71]
  s_cselect_b32 s36, 0, s36
  v_mfma_f32_16x16x32_bf16 a[72:75], a[208:211], a[136:139], a[72:75]
  v_add_u32 v13, s37, v13
  v_mfma_f32_16x16x32_bf16 a[76:79], a[208:211], a[140:143], a[76:79]
  v_mfma_f32_16x16x32_bf16 a[108:111], a[212:215], a[140:143], a[108:111]
  v_mfma_f32_16x16x32_bf16 a[104:107], a[212:215], a[136:139], a[104:107]
  v_mfma_f32_16x16x32_bf16 a[100:103], a[212:215], a[132:135], a[100:103]
  v_mfma_f32_16x16x32_bf16 a[96:99], a[212:215], a[128:131], a[96:99]
  v_mfma_f32_16x16x32_bf16 a[92:95], a[212:215], a[124:127], a[92:95]
  v_mfma_f32_16x16x32_bf16 a[88:91], a[212:215], a[120:123], a[88:91]
  v_mfma_f32_16x16x32_bf16 a[84:87], a[212:215], a[116:119], a[84:87]
  v_mfma_f32_16x16x32_bf16 a[80:83], a[212:215], a[112:115], a[80:83]
  s_waitcnt vmcnt(18) lgkmcnt(0)
  s_barrier
  v_mfma_f32_16x16x32_bf16 v[48:51], a[216:219], a[144:147], v[48:51]
  s_add_u32 m0, s36, s81
  v_mfma_f32_16x16x32_bf16 v[52:55], a[216:219], a[148:151], v[52:55]
  ds_read_b64_tr_b16 a[176:177], v14 offset:64
  v_mfma_f32_16x16x32_bf16 v[56:59], a[216:219], a[152:155], v[56:59]
  ds_read_b64_tr_b16 a[178:179], v14 offset:3136
  v_mfma_f32_16x16x32_bf16 v[60:63], a[216:219], a[156:159], v[60:63]
  buffer_load_dwordx4 v2, s[8:11], s28 offen sc1 lds
  v_mfma_f32_16x16x32_bf16 v[64:67], a[216:219], a[160:163], v[64:67]
  ds_read_b128 a[112:115], v11 offset:0
  v_mfma_f32_16x16x32_bf16 v[68:71], a[216:219], a[164:167], v[68:71]
  s_add_u32 m0, m0, 1024
  v_mfma_f32_16x16x32_bf16 v[72:75], a[216:219], a[168:171], v[72:75]
  ds_read_b128 a[116:119], v11 offset:1024
  v_mfma_f32_16x16x32_bf16 v[76:79], a[216:219], a[172:175], v[76:79]
  ds_read_b128 a[120:123], v11 offset:2048
  v_mfma_f32_16x16x32_bf16 v[108:111], a[220:223], a[172:175], v[108:111]
  buffer_load_dwordx4 v3, s[8:11], s28 offen sc1 lds
  v_mfma_f32_16x16x32_bf16 v[104:107], a[220:223], a[168:171], v[104:107]
  ds_read_b128 a[124:127], v11 offset:3072
  v_mfma_f32_16x16x32_bf16 v[100:103], a[220:223], a[164:167], v[100:103]
  s_add_u32 m0, m0, 1024
  v_mfma_f32_16x16x32_bf16 v[96:99], a[220:223], a[160:163], v[96:99]
  v_mfma_f32_16x16x32_bf16 v[92:95], a[220:223], a[156:159], v[92:95]
  ds_read_b128 a[128:131], v11 offset:4096
  v_mfma_f32_16x16x32_bf16 v[88:91], a[220:223], a[152:155], v[88:91]
  buffer_load_dwordx4 v4, s[8:11], s28 offen sc1 lds
  v_mfma_f32_16x16x32_bf16 v[84:87], a[220:223], a[148:151], v[84:87]
  ds_read_b128 a[132:135], v11 offset:5120
  v_mfma_f32_16x16x32_bf16 v[80:83], a[220:223], a[144:147], v[80:83]
  ds_read_b128 a[136:139], v11 offset:6144
  v_mfma_f32_16x16x32_bf16 v[112:115], a[144:147], a[224:227], v[112:115]
  s_add_u32 m0, m0, 1024
  v_mfma_f32_16x16x32_bf16 v[116:119], a[148:151], a[224:227], v[116:119]
  ds_read_b128 a[140:143], v11 offset:7168
  v_mfma_f32_16x16x32_bf16 v[120:123], a[152:155], a[224:227], v[120:123]
  buffer_load_dwordx4 v5, s[8:11], s28 offen sc1 lds
  v_mfma_f32_16x16x32_bf16 v[124:127], a[156:159], a[224:227], v[124:127]
  ds_read_b64_tr_b16 a[180:181], v15 offset:64
  v_mfma_f32_16x16x32_bf16 v[128:131], a[160:163], a[224:227], v[128:131]
  s_add_u32 s28, s28, 1024
  v_mfma_f32_16x16x32_bf16 v[132:135], a[164:167], a[224:227], v[132:135]
  ds_read_b64_tr_b16 a[182:183], v15 offset:3136
  v_mfma_f32_16x16x32_bf16 v[136:139], a[168:171], a[224:227], v[136:139]
  ds_read_b64_tr_b16 a[184:185], v14 offset:128
  v_mfma_f32_16x16x32_bf16 v[140:143], a[172:175], a[224:227], v[140:143]
  v_mfma_f32_16x16x32_bf16 v[172:175], a[172:175], a[228:231], v[172:175]
  s_add_u32 m0, s36, s76
  v_mfma_f32_16x16x32_bf16 v[168:171], a[168:171], a[228:231], v[168:171]
  ds_read_b64_tr_b16 a[186:187], v14 offset:3200
  v_mfma_f32_16x16x32_bf16 v[164:167], a[164:167], a[228:231], v[164:167]
  buffer_load_dwordx4 v6, s[12:15], s29 offen lds
  v_mfma_f32_16x16x32_bf16 v[160:163], a[160:163], a[228:231], v[160:163]
  ds_read_b64_tr_b16 a[188:189], v15 offset:128
  v_mfma_f32_16x16x32_bf16 v[156:159], a[156:159], a[228:231], v[156:159]
  s_add_u32 s29, s29, s32
  v_mfma_f32_16x16x32_bf16 v[152:155], a[152:155], a[228:231], v[152:155]
  ds_read_b64_tr_b16 a[190:191], v15 offset:3200
  v_mfma_f32_16x16x32_bf16 v[148:151], a[148:151], a[228:231], v[148:151]
  ds_read_b64_tr_b16 a[192:193], v12 offset:0
  v_mfma_f32_16x16x32_bf16 v[144:147], a[144:147], a[228:231], v[144:147]
  s_add_u32 m0, s36, s77
  v_mfma_f32_16x16x32_bf16 v[176:179], a[232:235], a[144:147], v[176:179]
  ds_read_b64_tr_b16 a[194:195], v12 offset:3584
  v_mfma_f32_16x16x32_bf16 v[180:183], a[232:235], a[148:151], v[180:183]
  buffer_load_dwordx4 v7, s[16:19], s30 offen lds
  v_mfma_f32_16x16x32_bf16 v[184:187], a[232:235], a[152:155], v[184:187]
  ds_read_b64_tr_b16 a[196:197], v12 offset:7168
  v_mfma_f32_16x16x32_bf16 v[188:191], a[232:235], a[156:159], v[188:191]
  v_mfma_f32_16x16x32_bf16 v[192:195], a[232:235], a[160:163], v[192:195]
  ds_read_b64_tr_b16 a[198:199], v12 offset:10752
  v_mfma_f32_16x16x32_bf16 v[196:199], a[232:235], a[164:167], v[196:199]
  s_add_u32 s30, s30, s33
  v_mfma_f32_16x16x32_bf16 v[200:203], a[232:235], a[168:171], v[200:203]
  ds_read_b64_tr_b16 a[200:201], v12 offset:32
  v_mfma_f32_16x16x32_bf16 v[204:207], a[232:235], a[172:175], v[204:207]
  s_add_u32 m0, s36, s78
  v_mfma_f32_16x16x32_bf16 v[236:239], a[236:239], a[172:175], v[236:239]
  ds_read_b64_tr_b16 a[202:203], v12 offset:3616
  v_mfma_f32_16x16x32_bf16 v[232:235], a[236:239], a[168:171], v[232:235]
  buffer_load_dwordx4 v8, s[20:23], s31 offen lds
  v_mfma_f32_16x16x32_bf16 v[228:231], a[236:239], a[164:167], v[228:231]
  ds_read_b64_tr_b16 a[204:205], v12 offset:7200
  v_mfma_f32_16x16x32_bf16 v[224:227], a[236:239], a[160:163], v[224:227]
  ds_read_b64_tr_b16 a[206:207], v12 offset:10784
  v_mfma_f32_16x16x32_bf16 v[220:223], a[236:239], a[156:159], v[220:223]
  s_add_u32 s31, s31, s34
  v_mfma_f32_16x16x32_bf16 v[216:219], a[236:239], a[152:155], v[216:219]
  ds_read_b64_tr_b16 a[208:209], v13 offset:0
  v_mfma_f32_16x16x32_bf16 v[212:215], a[236:239], a[148:151], v[212:215]
  s_add_u32 m0, s36, s79
  v_mfma_f32_16x16x32_bf16 v[208:211], a[236:239], a[144:147], v[208:211]
  v_mfma_f32_16x16x32_bf16 v[240:243], a[240:243], a[144:147], v[240:243]
  ds_read_b64_tr_b16 a[210:211], v13 offset:3584
  v_mfma_f32_16x16x32_bf16 v[244:247], a[240:243], a[148:151], v[244:247]
  buffer_load_dwordx4 v9, s[64:67], s72 offen lds
  v_mfma_f32_16x16x32_bf16 v[248:251], a[240:243], a[152:155], v[248:251]
  ds_read_b64_tr_b16 a[212:213], v13 offset:7168
  v_mfma_f32_16x16x32_bf16 v[252:255], a[240:243], a[156:159], v[252:255]
  ds_read_b64_tr_b16 a[214:215], v13 offset:10752
  v_mfma_f32_16x16x32_bf16 a[0:3], a[240:243], a[160:163], a[0:3]
  s_add_u32 s72, s72, s74
  v_mfma_f32_16x16x32_bf16 a[4:7], a[240:243], a[164:167], a[4:7]
  s_add_u32 s39, s39, 36864
  v_mfma_f32_16x16x32_bf16 a[8:11], a[240:243], a[168:171], a[8:11]
  s_cmp_eq_u32 s39, 147456
  v_mfma_f32_16x16x32_bf16 a[12:15], a[240:243], a[172:175], a[12:15]
  s_cselect_b32 s39, 0, s39
  v_mfma_f32_16x16x32_bf16 a[44:47], a[244:247], a[172:175], a[44:47]
  s_cselect_b32 s37, s63, s62
  v_mfma_f32_16x16x32_bf16 a[40:43], a[244:247], a[168:171], a[40:43]
  s_add_u32 m0, s36, s80
  v_mfma_f32_16x16x32_bf16 a[36:39], a[244:247], a[164:167], a[36:39]
  v_add_u32 v11, s37, v11
  v_mfma_f32_16x16x32_bf16 a[32:35], a[244:247], a[160:163], a[32:35]
  v_mfma_f32_16x16x32_bf16 a[28:31], a[244:247], a[156:159], a[28:31]
  buffer_load_dwordx4 v10, s[68:71], s73 offen lds
  v_mfma_f32_16x16x32_bf16 a[24:27], a[244:247], a[152:155], a[24:27]
  v_add_u32 v12, s37, v12
  v_mfma_f32_16x16x32_bf16 a[20:23], a[244:247], a[148:151], a[20:23]
  v_add_u32 v14, s37, v14
  v_mfma_f32_16x16x32_bf16 a[16:19], a[244:247], a[144:147], a[16:19]
  s_add_u32 s73, s73, s75
  v_mfma_f32_16x16x32_bf16 a[48:51], a[248:251], a[144:147], a[48:51]
  v_add_u32 v15, s37, v15
  v_mfma_f32_16x16x32_bf16 a[52:55], a[248:251], a[148:151], a[52:55]
  s_add_u32 s36, s36, 36864
  v_mfma_f32_16x16x32_bf16 a[56:59], a[248:251], a[152:155], a[56:59]
  s_cmp_eq_u32 s36, 147456
  v_mfma_f32_16x16x32_bf16 a[60:63], a[248:251], a[156:159], a[60:63]
  s_cselect_b32 s36, 0, s36
  v_mfma_f32_16x16x32_bf16 a[64:67], a[248:251], a[160:163], a[64:67]
  v_add_u32 v13, s37, v13
  v_mfma_f32_16x16x32_bf16 a[68:71], a[248:251], a[164:167], a[68:71]
  s_sub_u32 s38, s38, 1
  v_mfma_f32_16x16x32_bf16 a[72:75], a[248:251], a[168:171], a[72:75]
  s_cmp_lg_u32 s38, 0
  v_mfma_f32_16x16x32_bf16 a[76:79], a[248:251], a[172:175], a[76:79]
  v_mfma_f32_16x16x32_bf16 a[108:111], a[252:255], a[172:175], a[108:111]
  v_mfma_f32_16x16x32_bf16 a[104:107], a[252:255], a[168:171], a[104:107]
  v_mfma_f32_16x16x32_bf16 a[100:103], a[252:255], a[164:167], a[100:103]
  v_mfma_f32_16x16x32_bf16 a[96:99], a[252:255], a[160:163], a[96:99]
  v_mfma_f32_16x16x32_bf16 a[92:95], a[252:255], a[156:159], a[92:95]
  v_mfma_f32_16x16x32_bf16 a[88:91], a[252:255], a[152:155], a[88:91]
  v_mfma_f32_16x16x32_bf16 a[84:87], a[252:255], a[148:151], a[84:87]
  v_mfma_f32_16x16x32_bf16 a[80:83], a[252:255], a[144:147], a[80:83]
  s_cbranch_scc1 L_parallel_sum__linear_kernel_hedgehog__glu_gated_reglu__prompt_kernel_loop0
  s_waitcnt vmcnt(0) lgkmcnt(0)
  s_nop 7
  s_add_u32 s24, s60, 0x3000000
  s_addc_u32 s25, s61, 0
  s_and_b32 s25, s25, 0xffff
  s_mov_b32 s26, 0xc000
  s_mov_b32 s27, 0x20000
  s_cmp_eq_u32 s3, 0
  s_cbranch_scc0 L_parallel_sum__linear_kernel_hedgehog__glu_gated_reglu__prompt_kernel_e0_a0
  s_add_u32 s16, s60, 0x300c000
  s_addc_u32 s17, s61, 0
  s_and_b32 s17, s17, 0xffff
  s_mov_b32 s18, 0x400
  s_mov_b32 s19, 0x20000
  v_lshlrev_b32 v11, 7, v1
  s_mov_b64 s[86:87], exec
  s_mov_b64 exec, 0xff
  buffer_load_dword v12, v11, s[16:19], 0 offen sc1
  s_mov_b64 exec, s[86:87]
L_parallel_sum__linear_kernel_hedgehog__glu_gated_reglu__prompt_kernel_e0_a0:
  s_mov_b32 s72, 0x3fb8aa3b
  s_mov_b32 s73, 0x3fb8aa3b
  s_mov_b32 s62, 0xbfb8aa3b
  s_mov_b32 s63, 0xbfb8aa3b
  s_add_u32 s8, s60, 0x400000
  s_addc_u32 s9, s61, 0
  s_and_b32 s9, s9, 0xffff
  s_mov_b32 s10, 0x1200000
  s_mov_b32 s11, 0x20000
  v_lshrrev_b32 v3, 4, v1
  v_bfe_u32 v4, v1, 2, 2
  v_lshl_add_u32 v4, v3, 2, v4
  v_and_b32 v5, 3, v1
  v_lshlrev_b32 v4, 6, v4
  v_lshl_add_u32 v4, v5, 3, v4
  v_add_u32 v4, 147456, v4
  ds_read_b64_tr_b16 a[112:113], v4 offset:0
  ds_read_b64_tr_b16 a[114:115], v4 offset:1024
  ds_read_b64_tr_b16 a[116:117], v4 offset:32
  ds_read_b64_tr_b16 a[118:119], v4 offset:1056
  s_lshl_b32 s82, s4, 4
  s_lshl_b32 s83, s6, 3
  s_add_u32 s82, s82, s83
  s_mul_i32 s37, s82, 147456
  s_mov_b32 s48, s4
  s_mov_b32 s49, s5
  s_lshl_b32 s74, s5, 7
  s_add_u32 s74, s74, 0
  s_mul_i32 s75, s5, 98304
  s_mul_i32 s83, s3, 2048
  s_add_u32 s75, s75, s83
  s_add_u32 s76, s5, 112
  s_lshl_b32 s76, s76, 10
  s_add_u32 s76, s76, s37
  s_lshl_b32 s85, s4, 2
  s_lshr_b32 s83, s5, 3
  s_add_u32 s85, s85, s83
  s_lshl_b32 s85, s85, 7
  s_add_u32 s85, s85, 8192
  s_lshr_b32 s83, s5, 1
  s_mul_i32 s83, s83, 7
  s_lshl_b32 s84, s7, 2
  s_add_u32 s84, s84, s83
  s_add_u32 s36, s84, 0
  s_lshl_b32 s36, s36, 10
  s_add_u32 s36, s36, s37
  v_max_f32 v176, 0, v176
  v_max_f32 v180, 0, v180
  v_max_f32 v177, 0, v177
  v_max_f32 v181, 0, v181
  v_max_f32 v178, 0, v178
  v_max_f32 v182, 0, v182
  v_max_f32 v179, 0, v179
  v_max_f32 v183, 0, v183
  v_pk_mul_f32 v[176:177], v[176:177], v[208:209]
  v_pk_mul_f32 v[180:181], v[180:181], v[212:213]
  v_pk_mul_f32 v[178:179], v[178:179], v[210:211]
  v_pk_mul_f32 v[182:183], v[182:183], v[214:215]
  v_accvgpr_read_b32 v28, a16
  v_accvgpr_read_b32 v44, a20
  v_accvgpr_read_b32 v29, a17
  v_accvgpr_read_b32 v45, a21
  v_accvgpr_read_b32 v30, a18
  v_accvgpr_read_b32 v46, a22
  v_accvgpr_read_b32 v31, a19
  v_accvgpr_read_b32 v47, a23
  v_max_f32 v240, 0, v240
  v_max_f32 v244, 0, v244
  v_max_f32 v241, 0, v241
  v_max_f32 v245, 0, v245
  v_max_f32 v242, 0, v242
  v_max_f32 v246, 0, v246
  v_max_f32 v243, 0, v243
  v_max_f32 v247, 0, v247
  v_pk_mul_f32 v[240:241], v[240:241], v[28:29]
  v_pk_mul_f32 v[244:245], v[244:245], v[44:45]
  v_pk_mul_f32 v[242:243], v[242:243], v[30:31]
  v_pk_mul_f32 v[246:247], v[246:247], v[46:47]
  v_cvt_pk_bf16_f32 v176, v176, v177
  v_cvt_pk_bf16_f32 v180, v180, v181
  v_cvt_pk_bf16_f32 v177, v178, v179
  v_cvt_pk_bf16_f32 v181, v182, v183
  v_cvt_pk_bf16_f32 v178, v240, v241
  v_cvt_pk_bf16_f32 v182, v244, v245
  v_cvt_pk_bf16_f32 v179, v242, v243
  v_cvt_pk_bf16_f32 v183, v246, v247
  buffer_store_dwordx4 v[176:179], v2, s[8:11], s36 offen sc1
  s_add_u32 s36, s36, 147456
  buffer_store_dwordx4 v[180:183], v2, s[8:11], s36 offen sc1
  s_add_u32 s36, s36, 147456
  v_max_f32 v184, 0, v184
  v_max_f32 v188, 0, v188
  v_max_f32 v185, 0, v185
  v_max_f32 v189, 0, v189
  v_max_f32 v186, 0, v186
  v_max_f32 v190, 0, v190
  v_max_f32 v187, 0, v187
  v_max_f32 v191, 0, v191
  v_pk_mul_f32 v[184:185], v[184:185], v[216:217]
  v_pk_mul_f32 v[188:189], v[188:189], v[220:221]
  v_pk_mul_f32 v[186:187], v[186:187], v[218:219]
  v_pk_mul_f32 v[190:191], v[190:191], v[222:223]
  v_accvgpr_read_b32 v28, a24
  v_accvgpr_read_b32 v44, a28
  v_accvgpr_read_b32 v29, a25
  v_accvgpr_read_b32 v45, a29
  v_accvgpr_read_b32 v30, a26
  v_accvgpr_read_b32 v46, a30
  v_accvgpr_read_b32 v31, a27
  v_accvgpr_read_b32 v47, a31
  v_max_f32 v248, 0, v248
  v_max_f32 v252, 0, v252
  v_max_f32 v249, 0, v249
  v_max_f32 v253, 0, v253
  v_max_f32 v250, 0, v250
  v_max_f32 v254, 0, v254
  v_max_f32 v251, 0, v251
  v_max_f32 v255, 0, v255
  v_pk_mul_f32 v[248:249], v[248:249], v[28:29]
  v_pk_mul_f32 v[252:253], v[252:253], v[44:45]
  v_pk_mul_f32 v[250:251], v[250:251], v[30:31]
  v_pk_mul_f32 v[254:255], v[254:255], v[46:47]
  v_cvt_pk_bf16_f32 v184, v184, v185
  v_cvt_pk_bf16_f32 v188, v188, v189
  v_cvt_pk_bf16_f32 v185, v186, v187
  v_cvt_pk_bf16_f32 v189, v190, v191
  v_cvt_pk_bf16_f32 v186, v248, v249
  v_cvt_pk_bf16_f32 v190, v252, v253
  v_cvt_pk_bf16_f32 v187, v250, v251
  v_cvt_pk_bf16_f32 v191, v254, v255
  buffer_store_dwordx4 v[184:187], v2, s[8:11], s36 offen sc1
  s_add_u32 s36, s36, 147456
  buffer_store_dwordx4 v[188:191], v2, s[8:11], s36 offen sc1
  s_add_u32 s36, s36, 147456
  v_max_f32 v192, 0, v192
  v_max_f32 v196, 0, v196
  v_max_f32 v193, 0, v193
  v_max_f32 v197, 0, v197
  v_max_f32 v194, 0, v194
  v_max_f32 v198, 0, v198
  v_max_f32 v195, 0, v195
  v_max_f32 v199, 0, v199
  v_pk_mul_f32 v[192:193], v[192:193], v[224:225]
  v_pk_mul_f32 v[196:197], v[196:197], v[228:229]
  v_pk_mul_f32 v[194:195], v[194:195], v[226:227]
  v_pk_mul_f32 v[198:199], v[198:199], v[230:231]
  v_accvgpr_read_b32 v24, a0
  v_accvgpr_read_b32 v40, a4
  v_accvgpr_read_b32 v25, a1
  v_accvgpr_read_b32 v41, a5
  v_accvgpr_read_b32 v26, a2
  v_accvgpr_read_b32 v42, a6
  v_accvgpr_read_b32 v27, a3
  v_accvgpr_read_b32 v43, a7
  v_accvgpr_read_b32 v28, a32
  v_accvgpr_read_b32 v44, a36
  v_accvgpr_read_b32 v29, a33
  v_accvgpr_read_b32 v45, a37
  v_accvgpr_read_b32 v30, a34
  v_accvgpr_read_b32 v46, a38
  v_accvgpr_read_b32 v31, a35
  v_accvgpr_read_b32 v47, a39
  v_max_f32 v24, 0, v24
  v_max_f32 v40, 0, v40
  v_max_f32 v25, 0, v25
  v_max_f32 v41, 0, v41
  v_max_f32 v26, 0, v26
  v_max_f32 v42, 0, v42
  v_max_f32 v27, 0, v27
  v_max_f32 v43, 0, v43
  v_pk_mul_f32 v[24:25], v[24:25], v[28:29]
  v_pk_mul_f32 v[40:41], v[40:41], v[44:45]
  v_pk_mul_f32 v[26:27], v[26:27], v[30:31]
  v_pk_mul_f32 v[42:43], v[42:43], v[46:47]
  v_cvt_pk_bf16_f32 v192, v192, v193
  v_cvt_pk_bf16_f32 v196, v196, v197
  v_cvt_pk_bf16_f32 v193, v194, v195
  v_cvt_pk_bf16_f32 v197, v198, v199
  v_cvt_pk_bf16_f32 v194, v24, v25
  v_cvt_pk_bf16_f32 v198, v40, v41
  v_cvt_pk_bf16_f32 v195, v26, v27
  v_cvt_pk_bf16_f32 v199, v42, v43
  buffer_store_dwordx4 v[192:195], v2, s[8:11], s36 offen sc1
  s_add_u32 s36, s36, 147456
  buffer_store_dwordx4 v[196:199], v2, s[8:11], s36 offen sc1
  s_add_u32 s36, s36, 147456
  v_max_f32 v200, 0, v200
  v_max_f32 v204, 0, v204
  v_max_f32 v201, 0, v201
  v_max_f32 v205, 0, v205
  v_max_f32 v202, 0, v202
  v_max_f32 v206, 0, v206
  v_max_f32 v203, 0, v203
  v_max_f32 v207, 0, v207
  v_pk_mul_f32 v[200:201], v[200:201], v[232:233]
  v_pk_mul_f32 v[204:205], v[204:205], v[236:237]
  v_pk_mul_f32 v[202:203], v[202:203], v[234:235]
  v_pk_mul_f32 v[206:207], v[206:207], v[238:239]
  v_accvgpr_read_b32 v24, a8
  v_accvgpr_read_b32 v40, a12
  v_accvgpr_read_b32 v25, a9
  v_accvgpr_read_b32 v41, a13
  v_accvgpr_read_b32 v26, a10
  v_accvgpr_read_b32 v42, a14
  v_accvgpr_read_b32 v27, a11
  v_accvgpr_read_b32 v43, a15
  v_accvgpr_read_b32 v28, a40
  v_accvgpr_read_b32 v44, a44
  v_accvgpr_read_b32 v29, a41
  v_accvgpr_read_b32 v45, a45
  v_accvgpr_read_b32 v30, a42
  v_accvgpr_read_b32 v46, a46
  v_accvgpr_read_b32 v31, a43
  v_accvgpr_read_b32 v47, a47
  v_max_f32 v24, 0, v24
  v_max_f32 v40, 0, v40
  v_max_f32 v25, 0, v25
  v_max_f32 v41, 0, v41
  v_max_f32 v26, 0, v26
  v_max_f32 v42, 0, v42
  v_max_f32 v27, 0, v27
  v_max_f32 v43, 0, v43
  v_pk_mul_f32 v[24:25], v[24:25], v[28:29]
  v_pk_mul_f32 v[40:41], v[40:41], v[44:45]
  v_pk_mul_f32 v[26:27], v[26:27], v[30:31]
  v_pk_mul_f32 v[42:43], v[42:43], v[46:47]
  v_cvt_pk_bf16_f32 v200, v200, v201
  v_cvt_pk_bf16_f32 v204, v204, v205
  v_cvt_pk_bf16_f32 v201, v202, v203
  v_cvt_pk_bf16_f32 v205, v206, v207
  v_cvt_pk_bf16_f32 v202, v24, v25
  v_cvt_pk_bf16_f32 v206, v40, v41
  v_cvt_pk_bf16_f32 v203, v26, v27
  v_cvt_pk_bf16_f32 v207, v42, v43
  buffer_store_dwordx4 v[200:203], v2, s[8:11], s36 offen sc1
  s_add_u32 s36, s36, 147456
  buffer_store_dwordx4 v[204:207], v2, s[8:11], s36 offen sc1
  s_add_u32 s36, s36, 147456
  s_add_u32 s36, s83, 3
  s_lshl_b32 s36, s36, 10
  s_add_u32 s36, s36, s37
  s_lshl_b32 s83, s7, 3
  s_add_u32 s36, s36, s83
  v_accvgpr_read_b32 v16, a48
  v_accvgpr_read_b32 v24, a52
  v_accvgpr_read_b32 v32, a56
  v_accvgpr_read_b32 v40, a60
  v_accvgpr_read_b32 v17, a49
  v_accvgpr_read_b32 v25, a53
  v_accvgpr_read_b32 v33, a57
  v_accvgpr_read_b32 v41, a61
  v_accvgpr_read_b32 v18, a50
  v_accvgpr_read_b32 v26, a54
  v_accvgpr_read_b32 v34, a58
  v_accvgpr_read_b32 v42, a62
  v_accvgpr_read_b32 v19, a51
  v_accvgpr_read_b32 v27, a55
  v_accvgpr_read_b32 v35, a59
  v_accvgpr_read_b32 v43, a63
  v_accvgpr_read_b32 v20, a80
  v_accvgpr_read_b32 v28, a84
  v_accvgpr_read_b32 v36, a88
  v_accvgpr_read_b32 v44, a92
  v_accvgpr_read_b32 v21, a81
  v_accvgpr_read_b32 v29, a85
  v_accvgpr_read_b32 v37, a89
  v_accvgpr_read_b32 v45, a93
  v_accvgpr_read_b32 v22, a82
  v_accvgpr_read_b32 v30, a86
  v_accvgpr_read_b32 v38, a90
  v_accvgpr_read_b32 v46, a94
  v_accvgpr_read_b32 v23, a83
  v_accvgpr_read_b32 v31, a87
  v_accvgpr_read_b32 v39, a91
  v_accvgpr_read_b32 v47, a95
  v_max_f32 v16, 0, v16
  v_max_f32 v24, 0, v24
  v_max_f32 v32, 0, v32
  v_max_f32 v40, 0, v40
  v_max_f32 v17, 0, v17
  v_max_f32 v25, 0, v25
  v_max_f32 v33, 0, v33
  v_max_f32 v41, 0, v41
  v_max_f32 v18, 0, v18
  v_max_f32 v26, 0, v26
  v_max_f32 v34, 0, v34
  v_max_f32 v42, 0, v42
  v_max_f32 v19, 0, v19
  v_max_f32 v27, 0, v27
  v_max_f32 v35, 0, v35
  v_max_f32 v43, 0, v43
  v_pk_mul_f32 v[16:17], v[16:17], v[20:21]
  v_pk_mul_f32 v[24:25], v[24:25], v[28:29]
  v_pk_mul_f32 v[32:33], v[32:33], v[36:37]
  v_pk_mul_f32 v[40:41], v[40:41], v[44:45]
  v_pk_mul_f32 v[18:19], v[18:19], v[22:23]
  v_pk_mul_f32 v[26:27], v[26:27], v[30:31]
  v_pk_mul_f32 v[34:35], v[34:35], v[38:39]
  v_pk_mul_f32 v[42:43], v[42:43], v[46:47]
  v_cvt_pk_bf16_f32 v16, v16, v17
  v_cvt_pk_bf16_f32 v24, v24, v25
  v_cvt_pk_bf16_f32 v32, v32, v33
  v_cvt_pk_bf16_f32 v40, v40, v41
  v_cvt_pk_bf16_f32 v17, v18, v19
  v_cvt_pk_bf16_f32 v25, v26, v27
  v_cvt_pk_bf16_f32 v33, v34, v35
  v_cvt_pk_bf16_f32 v41, v42, v43
  buffer_store_dwordx2 v[16:17], v2, s[8:11], s36 offen sc1
  s_add_u32 s36, s36, 147456
  buffer_store_dwordx2 v[24:25], v2, s[8:11], s36 offen sc1
  s_add_u32 s36, s36, 147456
  buffer_store_dwordx2 v[32:33], v2, s[8:11], s36 offen sc1
  s_add_u32 s36, s36, 147456
  buffer_store_dwordx2 v[40:41], v2, s[8:11], s36 offen sc1
  s_add_u32 s36, s36, 147456
  v_accvgpr_read_b32 v16, a64
  v_accvgpr_read_b32 v24, a68
  v_accvgpr_read_b32 v32, a72
  v_accvgpr_read_b32 v40, a76
  v_accvgpr_read_b32 v17, a65
  v_accvgpr_read_b32 v25, a69
  v_accvgpr_read_b32 v33, a73
  v_accvgpr_read_b32 v41, a77
  v_accvgpr_read_b32 v18, a66
  v_accvgpr_read_b32 v26, a70
  v_accvgpr_read_b32 v34, a74
  v_accvgpr_read_b32 v42, a78
  v_accvgpr_read_b32 v19, a67
  v_accvgpr_read_b32 v27, a71
  v_accvgpr_read_b32 v35, a75
  v_accvgpr_read_b32 v43, a79
  v_accvgpr_read_b32 v20, a96
  v_accvgpr_read_b32 v28, a100
  v_accvgpr_read_b32 v36, a104
  v_accvgpr_read_b32 v44, a108
  v_accvgpr_read_b32 v21, a97
  v_accvgpr_read_b32 v29, a101
  v_accvgpr_read_b32 v37, a105
  v_accvgpr_read_b32 v45, a109
  v_accvgpr_read_b32 v22, a98
  v_accvgpr_read_b32 v30, a102
  v_accvgpr_read_b32 v38, a106
  v_accvgpr_read_b32 v46, a110
  v_accvgpr_read_b32 v23, a99
  v_accvgpr_read_b32 v31, a103
  v_accvgpr_read_b32 v39, a107
  v_accvgpr_read_b32 v47, a111
  v_max_f32 v16, 0, v16
  v_max_f32 v24, 0, v24
  v_max_f32 v32, 0, v32
  v_max_f32 v40, 0, v40
  v_max_f32 v17, 0, v17
  v_max_f32 v25, 0, v25
  v_max_f32 v33, 0, v33
  v_max_f32 v41, 0, v41
  v_max_f32 v18, 0, v18
  v_max_f32 v26, 0, v26
  v_max_f32 v34, 0, v34
  v_max_f32 v42, 0, v42
  v_max_f32 v19, 0, v19
  v_max_f32 v27, 0, v27
  v_max_f32 v35, 0, v35
  v_max_f32 v43, 0, v43
  v_pk_mul_f32 v[16:17], v[16:17], v[20:21]
  v_pk_mul_f32 v[24:25], v[24:25], v[28:29]
  v_pk_mul_f32 v[32:33], v[32:33], v[36:37]
  v_pk_mul_f32 v[40:41], v[40:41], v[44:45]
  v_pk_mul_f32 v[18:19], v[18:19], v[22:23]
  v_pk_mul_f32 v[26:27], v[26:27], v[30:31]
  v_pk_mul_f32 v[34:35], v[34:35], v[38:39]
  v_pk_mul_f32 v[42:43], v[42:43], v[46:47]
  v_cvt_pk_bf16_f32 v16, v16, v17
  v_cvt_pk_bf16_f32 v24, v24, v25
  v_cvt_pk_bf16_f32 v32, v32, v33
  v_cvt_pk_bf16_f32 v40, v40, v41
  v_cvt_pk_bf16_f32 v17, v18, v19
  v_cvt_pk_bf16_f32 v25, v26, v27
  v_cvt_pk_bf16_f32 v33, v34, v35
  v_cvt_pk_bf16_f32 v41, v42, v43
  buffer_store_dwordx2 v[16:17], v2, s[8:11], s36 offen sc1
  s_add_u32 s36, s36, 147456
  buffer_store_dwordx2 v[24:25], v2, s[8:11], s36 offen sc1
  s_add_u32 s36, s36, 147456
  buffer_store_dwordx2 v[32:33], v2, s[8:11], s36 offen sc1
  s_add_u32 s36, s36, 147456
  buffer_store_dwordx2 v[40:41], v2, s[8:11], s36 offen sc1
  s_add_u32 s36, s36, 147456
  s_waitcnt lgkmcnt(0)
  v_cvt_pk_bf16_f32 v48, v48, v49
  v_cvt_pk_bf16_f32 v49, v50, v51
  v_cvt_pk_bf16_f32 v50, v80, v81
  v_cvt_pk_bf16_f32 v51, v82, v83
  v_cvt_pk_bf16_f32 v52, v52, v53
  v_cvt_pk_bf16_f32 v53, v54, v55
  v_cvt_pk_bf16_f32 v54, v84, v85
  v_cvt_pk_bf16_f32 v55, v86, v87
  v_cvt_pk_bf16_f32 v56, v56, v57
  v_cvt_pk_bf16_f32 v57, v58, v59
  v_cvt_pk_bf16_f32 v58, v88, v89
  v_cvt_pk_bf16_f32 v59, v90, v91
  v_cvt_pk_bf16_f32 v60, v60, v61
  v_cvt_pk_bf16_f32 v61, v62, v63
  v_cvt_pk_bf16_f32 v62, v92, v93
  v_cvt_pk_bf16_f32 v63, v94, v95
  v_cvt_pk_bf16_f32 v64, v64, v65
  v_cvt_pk_bf16_f32 v65, v66, v67
  v_cvt_pk_bf16_f32 v66, v96, v97
  v_cvt_pk_bf16_f32 v67, v98, v99
  v_cvt_pk_bf16_f32 v68, v68, v69
  v_cvt_pk_bf16_f32 v69, v70, v71
  v_cvt_pk_bf16_f32 v70, v100, v101
  v_cvt_pk_bf16_f32 v71, v102, v103
  v_cvt_pk_bf16_f32 v72, v72, v73
  v_cvt_pk_bf16_f32 v73, v74, v75
  v_cvt_pk_bf16_f32 v74, v104, v105
  v_cvt_pk_bf16_f32 v75, v106, v107
  v_cvt_pk_bf16_f32 v76, v76, v77
  v_cvt_pk_bf16_f32 v77, v78, v79
  v_cvt_pk_bf16_f32 v78, v108, v109
  v_cvt_pk_bf16_f32 v79, v110, v111
  v_mfma_f32_16x16x32_bf16 v[80:83], a[112:115], v[48:51], 0
  v_mfma_f32_16x16x32_bf16 v[48:51], a[116:119], v[48:51], 0
  v_mfma_f32_16x16x32_bf16 v[84:87], a[112:115], v[52:55], 0
  v_mfma_f32_16x16x32_bf16 v[52:55], a[116:119], v[52:55], 0
  v_mfma_f32_16x16x32_bf16 v[88:91], a[112:115], v[56:59], 0
  v_mfma_f32_16x16x32_bf16 v[56:59], a[116:119], v[56:59], 0
  v_mfma_f32_16x16x32_bf16 v[92:95], a[112:115], v[60:63], 0
  v_mfma_f32_16x16x32_bf16 v[60:63], a[116:119], v[60:63], 0
  v_mfma_f32_16x16x32_bf16 v[96:99], a[112:115], v[64:67], 0
  v_mfma_f32_16x16x32_bf16 v[64:67], a[116:119], v[64:67], 0
  v_mfma_f32_16x16x32_bf16 v[100:103], a[112:115], v[68:71], 0
  v_mfma_f32_16x16x32_bf16 v[68:71], a[116:119], v[68:71], 0
  v_mfma_f32_16x16x32_bf16 v[104:107], a[112:115], v[72:75], 0
  v_mfma_f32_16x16x32_bf16 v[72:75], a[116:119], v[72:75], 0
  v_mfma_f32_16x16x32_bf16 v[108:111], a[112:115], v[76:79], 0
  v_mfma_f32_16x16x32_bf16 v[76:79], a[116:119], v[76:79], 0
  v_lshrrev_b32 v3, 4, v1
  v_and_b32 v4, 15, v1
  v_lshlrev_b32 v3, 2, v3
  v_sub_u32 v3, v4, v3
  v_mov_b32 v5, 0x3f80
  v_mov_b32 v6, 0x3f800000
  v_mov_b32 v7, 0
  v_cmp_eq_u32 vcc, 0, v3
  s_nop 1
  v_cndmask_b32 v8, v7, v5, vcc
  v_cmp_eq_u32 vcc, 1, v3
  s_nop 1
  v_cndmask_b32 v8, v8, v6, vcc
  v_cmp_eq_u32 vcc, 2, v3
  s_nop 1
  v_cndmask_b32 v9, v7, v5, vcc
  v_cmp_eq_u32 vcc, 3, v3
  s_nop 1
  v_cndmask_b32 v9, v9, v6, vcc
  v_accvgpr_write_b32 a120, v7
  v_accvgpr_write_b32 a121, v7
  v_accvgpr_write_b32 a122, v8
  v_accvgpr_write_b32 a123, v9
  v_accvgpr_write_b32 a124, v7
  v_accvgpr_write_b32 a125, v7
  v_mov_b32 v5, 0x3f803f80
  v_accvgpr_write_b32 a126, v5
  v_accvgpr_write_b32 a127, v5
  v_accvgpr_write_b32 a128, v5
  v_accvgpr_write_b32 a129, v5
  v_max3_f32 v16, v80, v81, v82
  v_max3_f32 v20, v84, v85, v86
  v_max3_f32 v24, v88, v89, v90
  v_max3_f32 v28, v92, v93, v94
  v_max3_f32 v32, v96, v97, v98
  v_max3_f32 v36, v100, v101, v102
  v_max3_f32 v40, v104, v105, v106
  v_max3_f32 v44, v108, v109, v110
  v_max3_f32 v17, -v80, -v81, -v82
  v_max3_f32 v21, -v84, -v85, -v86
  v_max3_f32 v25, -v88, -v89, -v90
  v_max3_f32 v29, -v92, -v93, -v94
  v_max3_f32 v33, -v96, -v97, -v98
  v_max3_f32 v37, -v100, -v101, -v102
  v_max3_f32 v41, -v104, -v105, -v106
  v_max3_f32 v45, -v108, -v109, -v110
  v_max3_f32 v16, v16, v83, v48
  v_max3_f32 v20, v20, v87, v52
  v_max3_f32 v24, v24, v91, v56
  v_max3_f32 v28, v28, v95, v60
  v_max3_f32 v32, v32, v99, v64
  v_max3_f32 v36, v36, v103, v68
  v_max3_f32 v40, v40, v107, v72
  v_max3_f32 v44, v44, v111, v76
  v_max3_f32 v17, v17, -v83, -v48
  v_max3_f32 v21, v21, -v87, -v52
  v_max3_f32 v25, v25, -v91, -v56
  v_max3_f32 v29, v29, -v95, -v60
  v_max3_f32 v33, v33, -v99, -v64
  v_max3_f32 v37, v37, -v103, -v68
  v_max3_f32 v41, v41, -v107, -v72
  v_max3_f32 v45, v45, -v111, -v76
  v_max3_f32 v16, v16, v49, v50
  v_max3_f32 v20, v20, v53, v54
  v_max3_f32 v24, v24, v57, v58
  v_max3_f32 v28, v28, v61, v62
  v_max3_f32 v32, v32, v65, v66
  v_max3_f32 v36, v36, v69, v70
  v_max3_f32 v40, v40, v73, v74
  v_max3_f32 v44, v44, v77, v78
  v_max3_f32 v17, v17, -v49, -v50
  v_max3_f32 v21, v21, -v53, -v54
  v_max3_f32 v25, v25, -v57, -v58
  v_max3_f32 v29, v29, -v61, -v62
  v_max3_f32 v33, v33, -v65, -v66
  v_max3_f32 v37, v37, -v69, -v70
  v_max3_f32 v41, v41, -v73, -v74
  v_max3_f32 v45, v45, -v77, -v78
  v_max_f32 v16, v16, v51
  v_max_f32 v20, v20, v55
  v_max_f32 v24, v24, v59
  v_max_f32 v28, v28, v63
  v_max_f32 v32, v32, v67
  v_max_f32 v36, v36, v71
  v_max_f32 v40, v40, v75
  v_max_f32 v44, v44, v79
  v_max_f32_e64 v17, v17, -v51
  v_max_f32_e64 v21, v21, -v55
  v_max_f32_e64 v25, v25, -v59
  v_max_f32_e64 v29, v29, -v63
  v_max_f32_e64 v33, v33, -v67
  v_max_f32_e64 v37, v37, -v71
  v_max_f32_e64 v41, v41, -v75
  v_max_f32_e64 v45, v45, -v79
  v_permlane16_swap_b32 v16, v17
  v_permlane16_swap_b32 v20, v21
  v_permlane16_swap_b32 v24, v25
  v_permlane16_swap_b32 v28, v29
  v_permlane16_swap_b32 v32, v33
  v_permlane16_swap_b32 v36, v37
  v_permlane16_swap_b32 v40, v41
  v_permlane16_swap_b32 v44, v45
  v_max_f32 v16, v16, v17
  v_max_f32 v20, v20, v21
  v_max_f32 v24, v24, v25
  v_max_f32 v28, v28, v29
  v_max_f32 v32, v32, v33
  v_max_f32 v36, v36, v37
  v_max_f32 v40, v40, v41
  v_max_f32 v44, v44, v45
  v_mov_b32 v17, v16
  v_mov_b32 v21, v20
  v_mov_b32 v25, v24
  v_mov_b32 v29, v28
  v_mov_b32 v33, v32
  v_mov_b32 v37, v36
  v_mov_b32 v41, v40
  v_mov_b32 v45, v44
  v_permlane32_swap_b32 v16, v17
  v_permlane32_swap_b32 v20, v21
  v_permlane32_swap_b32 v24, v25
  v_permlane32_swap_b32 v28, v29
  v_permlane32_swap_b32 v32, v33
  v_permlane32_swap_b32 v36, v37
  v_permlane32_swap_b32 v40, v41
  v_permlane32_swap_b32 v44, v45
  v_max_f32 v16, v16, v17
  v_max_f32 v20, v20, v21
  v_max_f32 v24, v24, v25
  v_max_f32 v28, v28, v29
  v_max_f32 v32, v32, v33
  v_max_f32 v36, v36, v37
  v_max_f32 v40, v40, v41
  v_max_f32 v44, v44, v45
  v_mul_f32 v16, s72, v16
  v_mul_f32 v20, s72, v20
  v_mul_f32 v24, s72, v24
  v_mul_f32 v28, s72, v28
  v_mul_f32 v32, s72, v32
  v_mul_f32 v36, s72, v36
  v_mul_f32 v40, s72, v40
  v_mul_f32 v44, s72, v44
  v_mov_b32 v17, v16
  v_mov_b32 v21, v20
  v_mov_b32 v25, v24
  v_mov_b32 v29, v28
  v_mov_b32 v33, v32
  v_mov_b32 v37, v36
  v_mov_b32 v41, v40
  v_mov_b32 v45, v44
  v_permlane16_swap_b32 v16, v17
  v_permlane16_swap_b32 v20, v21
  v_permlane16_swap_b32 v24, v25
  v_permlane16_swap_b32 v28, v29
  v_permlane16_swap_b32 v32, v33
  v_permlane16_swap_b32 v36, v37
  v_permlane16_swap_b32 v40, v41
  v_permlane16_swap_b32 v44, v45
  v_pk_fma_f32 v[176:177], v[80:81], s[72:73], v[16:17] op_sel_hi:[1,1,0] neg_lo:[0,0,1] neg_hi:[0,0,1]
  v_pk_fma_f32 v[184:185], v[84:85], s[72:73], v[20:21] op_sel_hi:[1,1,0] neg_lo:[0,0,1] neg_hi:[0,0,1]
  v_pk_fma_f32 v[192:193], v[88:89], s[72:73], v[24:25] op_sel_hi:[1,1,0] neg_lo:[0,0,1] neg_hi:[0,0,1]
  v_pk_fma_f32 v[200:201], v[92:93], s[72:73], v[28:29] op_sel_hi:[1,1,0] neg_lo:[0,0,1] neg_hi:[0,0,1]
  v_pk_fma_f32 v[208:209], v[96:97], s[72:73], v[32:33] op_sel_hi:[1,1,0] neg_lo:[0,0,1] neg_hi:[0,0,1]
  v_pk_fma_f32 v[216:217], v[100:101], s[72:73], v[36:37] op_sel_hi:[1,1,0] neg_lo:[0,0,1] neg_hi:[0,0,1]
  v_pk_fma_f32 v[224:225], v[104:105], s[72:73], v[40:41] op_sel_hi:[1,1,0] neg_lo:[0,0,1] neg_hi:[0,0,1]
  v_pk_fma_f32 v[232:233], v[108:109], s[72:73], v[44:45] op_sel_hi:[1,1,0] neg_lo:[0,0,1] neg_hi:[0,0,1]
  v_pk_fma_f32 v[178:179], v[82:83], s[72:73], v[16:17] op_sel_hi:[1,1,0] neg_lo:[0,0,1] neg_hi:[0,0,1]
  v_pk_fma_f32 v[186:187], v[86:87], s[72:73], v[20:21] op_sel_hi:[1,1,0] neg_lo:[0,0,1] neg_hi:[0,0,1]
  v_pk_fma_f32 v[194:195], v[90:91], s[72:73], v[24:25] op_sel_hi:[1,1,0] neg_lo:[0,0,1] neg_hi:[0,0,1]
  v_pk_fma_f32 v[202:203], v[94:95], s[72:73], v[28:29] op_sel_hi:[1,1,0] neg_lo:[0,0,1] neg_hi:[0,0,1]
  v_pk_fma_f32 v[210:211], v[98:99], s[72:73], v[32:33] op_sel_hi:[1,1,0] neg_lo:[0,0,1] neg_hi:[0,0,1]
  v_pk_fma_f32 v[218:219], v[102:103], s[72:73], v[36:37] op_sel_hi:[1,1,0] neg_lo:[0,0,1] neg_hi:[0,0,1]
  v_pk_fma_f32 v[226:227], v[106:107], s[72:73], v[40:41] op_sel_hi:[1,1,0] neg_lo:[0,0,1] neg_hi:[0,0,1]
  v_pk_fma_f32 v[234:235], v[110:111], s[72:73], v[44:45] op_sel_hi:[1,1,0] neg_lo:[0,0,1] neg_hi:[0,0,1]
  v_pk_fma_f32 v[180:181], v[48:49], s[72:73], v[16:17] op_sel_hi:[1,1,0] neg_lo:[0,0,1] neg_hi:[0,0,1]
  v_pk_fma_f32 v[188:189], v[52:53], s[72:73], v[20:21] op_sel_hi:[1,1,0] neg_lo:[0,0,1] neg_hi:[0,0,1]
  v_pk_fma_f32 v[196:197], v[56:57], s[72:73], v[24:25] op_sel_hi:[1,1,0] neg_lo:[0,0,1] neg_hi:[0,0,1]
  v_pk_fma_f32 v[204:205], v[60:61], s[72:73], v[28:29] op_sel_hi:[1,1,0] neg_lo:[0,0,1] neg_hi:[0,0,1]
  v_pk_fma_f32 v[212:213], v[64:65], s[72:73], v[32:33] op_sel_hi:[1,1,0] neg_lo:[0,0,1] neg_hi:[0,0,1]
  v_pk_fma_f32 v[220:221], v[68:69], s[72:73], v[36:37] op_sel_hi:[1,1,0] neg_lo:[0,0,1] neg_hi:[0,0,1]
  v_pk_fma_f32 v[228:229], v[72:73], s[72:73], v[40:41] op_sel_hi:[1,1,0] neg_lo:[0,0,1] neg_hi:[0,0,1]
  v_pk_fma_f32 v[236:237], v[76:77], s[72:73], v[44:45] op_sel_hi:[1,1,0] neg_lo:[0,0,1] neg_hi:[0,0,1]
  v_pk_fma_f32 v[182:183], v[50:51], s[72:73], v[16:17] op_sel_hi:[1,1,0] neg_lo:[0,0,1] neg_hi:[0,0,1]
  v_pk_fma_f32 v[190:191], v[54:55], s[72:73], v[20:21] op_sel_hi:[1,1,0] neg_lo:[0,0,1] neg_hi:[0,0,1]
  v_pk_fma_f32 v[198:199], v[58:59], s[72:73], v[24:25] op_sel_hi:[1,1,0] neg_lo:[0,0,1] neg_hi:[0,0,1]
  v_pk_fma_f32 v[206:207], v[62:63], s[72:73], v[28:29] op_sel_hi:[1,1,0] neg_lo:[0,0,1] neg_hi:[0,0,1]
  v_pk_fma_f32 v[214:215], v[66:67], s[72:73], v[32:33] op_sel_hi:[1,1,0] neg_lo:[0,0,1] neg_hi:[0,0,1]
  v_pk_fma_f32 v[222:223], v[70:71], s[72:73], v[36:37] op_sel_hi:[1,1,0] neg_lo:[0,0,1] neg_hi:[0,0,1]
  v_pk_fma_f32 v[230:231], v[74:75], s[72:73], v[40:41] op_sel_hi:[1,1,0] neg_lo:[0,0,1] neg_hi:[0,0,1]
  v_pk_fma_f32 v[238:239], v[78:79], s[72:73], v[44:45] op_sel_hi:[1,1,0] neg_lo:[0,0,1] neg_hi:[0,0,1]
  v_pk_fma_f32 v[80:81], v[80:81], s[62:63], v[16:17] op_sel:[0,0,1] op_sel_hi:[1,1,1] neg_lo:[0,0,1] neg_hi:[0,0,1]
  v_pk_fma_f32 v[84:85], v[84:85], s[62:63], v[20:21] op_sel:[0,0,1] op_sel_hi:[1,1,1] neg_lo:[0,0,1] neg_hi:[0,0,1]
  v_pk_fma_f32 v[88:89], v[88:89], s[62:63], v[24:25] op_sel:[0,0,1] op_sel_hi:[1,1,1] neg_lo:[0,0,1] neg_hi:[0,0,1]
  v_pk_fma_f32 v[92:93], v[92:93], s[62:63], v[28:29] op_sel:[0,0,1] op_sel_hi:[1,1,1] neg_lo:[0,0,1] neg_hi:[0,0,1]
  v_pk_fma_f32 v[96:97], v[96:97], s[62:63], v[32:33] op_sel:[0,0,1] op_sel_hi:[1,1,1] neg_lo:[0,0,1] neg_hi:[0,0,1]
  v_pk_fma_f32 v[100:101], v[100:101], s[62:63], v[36:37] op_sel:[0,0,1] op_sel_hi:[1,1,1] neg_lo:[0,0,1] neg_hi:[0,0,1]
  v_pk_fma_f32 v[104:105], v[104:105], s[62:63], v[40:41] op_sel:[0,0,1] op_sel_hi:[1,1,1] neg_lo:[0,0,1] neg_hi:[0,0,1]
  v_pk_fma_f32 v[108:109], v[108:109], s[62:63], v[44:45] op_sel:[0,0,1] op_sel_hi:[1,1,1] neg_lo:[0,0,1] neg_hi:[0,0,1]
  v_pk_fma_f32 v[82:83], v[82:83], s[62:63], v[16:17] op_sel:[0,0,1] op_sel_hi:[1,1,1] neg_lo:[0,0,1] neg_hi:[0,0,1]
  v_pk_fma_f32 v[86:87], v[86:87], s[62:63], v[20:21] op_sel:[0,0,1] op_sel_hi:[1,1,1] neg_lo:[0,0,1] neg_hi:[0,0,1]
  v_pk_fma_f32 v[90:91], v[90:91], s[62:63], v[24:25] op_sel:[0,0,1] op_sel_hi:[1,1,1] neg_lo:[0,0,1] neg_hi:[0,0,1]
  v_pk_fma_f32 v[94:95], v[94:95], s[62:63], v[28:29] op_sel:[0,0,1] op_sel_hi:[1,1,1] neg_lo:[0,0,1] neg_hi:[0,0,1]
  v_pk_fma_f32 v[98:99], v[98:99], s[62:63], v[32:33] op_sel:[0,0,1] op_sel_hi:[1,1,1] neg_lo:[0,0,1] neg_hi:[0,0,1]
  v_pk_fma_f32 v[102:103], v[102:103], s[62:63], v[36:37] op_sel:[0,0,1] op_sel_hi:[1,1,1] neg_lo:[0,0,1] neg_hi:[0,0,1]
  v_pk_fma_f32 v[106:107], v[106:107], s[62:63], v[40:41] op_sel:[0,0,1] op_sel_hi:[1,1,1] neg_lo:[0,0,1] neg_hi:[0,0,1]
  v_pk_fma_f32 v[110:111], v[110:111], s[62:63], v[44:45] op_sel:[0,0,1] op_sel_hi:[1,1,1] neg_lo:[0,0,1] neg_hi:[0,0,1]
  v_pk_fma_f32 v[48:49], v[48:49], s[62:63], v[16:17] op_sel:[0,0,1] op_sel_hi:[1,1,1] neg_lo:[0,0,1] neg_hi:[0,0,1]
  v_pk_fma_f32 v[52:53], v[52:53], s[62:63], v[20:21] op_sel:[0,0,1] op_sel_hi:[1,1,1] neg_lo:[0,0,1] neg_hi:[0,0,1]
  v_pk_fma_f32 v[56:57], v[56:57], s[62:63], v[24:25] op_sel:[0,0,1] op_sel_hi:[1,1,1] neg_lo:[0,0,1] neg_hi:[0,0,1]
  v_pk_fma_f32 v[60:61], v[60:61], s[62:63], v[28:29] op_sel:[0,0,1] op_sel_hi:[1,1,1] neg_lo:[0,0,1] neg_hi:[0,0,1]
  v_pk_fma_f32 v[64:65], v[64:65], s[62:63], v[32:33] op_sel:[0,0,1] op_sel_hi:[1,1,1] neg_lo:[0,0,1] neg_hi:[0,0,1]
  v_pk_fma_f32 v[68:69], v[68:69], s[62:63], v[36:37] op_sel:[0,0,1] op_sel_hi:[1,1,1] neg_lo:[0,0,1] neg_hi:[0,0,1]
  v_pk_fma_f32 v[72:73], v[72:73], s[62:63], v[40:41] op_sel:[0,0,1] op_sel_hi:[1,1,1] neg_lo:[0,0,1] neg_hi:[0,0,1]
  v_pk_fma_f32 v[76:77], v[76:77], s[62:63], v[44:45] op_sel:[0,0,1] op_sel_hi:[1,1,1] neg_lo:[0,0,1] neg_hi:[0,0,1]
  v_pk_fma_f32 v[50:51], v[50:51], s[62:63], v[16:17] op_sel:[0,0,1] op_sel_hi:[1,1,1] neg_lo:[0,0,1] neg_hi:[0,0,1]
  v_pk_fma_f32 v[54:55], v[54:55], s[62:63], v[20:21] op_sel:[0,0,1] op_sel_hi:[1,1,1] neg_lo:[0,0,1] neg_hi:[0,0,1]
  v_pk_fma_f32 v[58:59], v[58:59], s[62:63], v[24:25] op_sel:[0,0,1] op_sel_hi:[1,1,1] neg_lo:[0,0,1] neg_hi:[0,0,1]
  v_pk_fma_f32 v[62:63], v[62:63], s[62:63], v[28:29] op_sel:[0,0,1] op_sel_hi:[1,1,1] neg_lo:[0,0,1] neg_hi:[0,0,1]
  v_pk_fma_f32 v[66:67], v[66:67], s[62:63], v[32:33] op_sel:[0,0,1] op_sel_hi:[1,1,1] neg_lo:[0,0,1] neg_hi:[0,0,1]
  v_pk_fma_f32 v[70:71], v[70:71], s[62:63], v[36:37] op_sel:[0,0,1] op_sel_hi:[1,1,1] neg_lo:[0,0,1] neg_hi:[0,0,1]
  v_pk_fma_f32 v[74:75], v[74:75], s[62:63], v[40:41] op_sel:[0,0,1] op_sel_hi:[1,1,1] neg_lo:[0,0,1] neg_hi:[0,0,1]
  v_pk_fma_f32 v[78:79], v[78:79], s[62:63], v[44:45] op_sel:[0,0,1] op_sel_hi:[1,1,1] neg_lo:[0,0,1] neg_hi:[0,0,1]
  v_exp_f32 v176, v176
  v_exp_f32 v184, v184
  v_exp_f32 v192, v192
  v_exp_f32 v200, v200
  v_exp_f32 v208, v208
  v_exp_f32 v216, v216
  v_exp_f32 v224, v224
  v_exp_f32 v232, v232
  v_exp_f32 v177, v177
  v_exp_f32 v185, v185
  v_exp_f32 v193, v193
  v_exp_f32 v201, v201
  v_exp_f32 v209, v209
  v_exp_f32 v217, v217
  v_exp_f32 v225, v225
  v_exp_f32 v233, v233
  v_exp_f32 v178, v178
  v_exp_f32 v186, v186
  v_exp_f32 v194, v194
  v_exp_f32 v202, v202
  v_exp_f32 v210, v210
  v_exp_f32 v218, v218
  v_exp_f32 v226, v226
  v_exp_f32 v234, v234
  v_exp_f32 v179, v179
  v_exp_f32 v187, v187
  v_exp_f32 v195, v195
  v_exp_f32 v203, v203
  v_exp_f32 v211, v211
  v_exp_f32 v219, v219
  v_exp_f32 v227, v227
  v_exp_f32 v235, v235
  v_exp_f32 v180, v180
  v_exp_f32 v188, v188
  v_exp_f32 v196, v196
  v_exp_f32 v204, v204
  v_exp_f32 v212, v212
  v_exp_f32 v220, v220
  v_exp_f32 v228, v228
  v_exp_f32 v236, v236
  v_exp_f32 v181, v181
  v_exp_f32 v189, v189
  v_exp_f32 v197, v197
  v_exp_f32 v205, v205
  v_exp_f32 v213, v213
  v_exp_f32 v221, v221
  v_exp_f32 v229, v229
  v_exp_f32 v237, v237
  v_exp_f32 v182, v182
  v_exp_f32 v190, v190
  v_exp_f32 v198, v198
  v_exp_f32 v206, v206
  v_exp_f32 v214, v214
  v_exp_f32 v222, v222
  v_exp_f32 v230, v230
  v_exp_f32 v238, v238
  v_exp_f32 v183, v183
  v_exp_f32 v191, v191
  v_exp_f32 v199, v199
  v_exp_f32 v207, v207
  v_exp_f32 v215, v215
  v_exp_f32 v223, v223
  v_exp_f32 v231, v231
  v_exp_f32 v239, v239
  v_exp_f32 v80, v80
  v_exp_f32 v84, v84
  v_exp_f32 v88, v88
  v_exp_f32 v92, v92
  v_exp_f32 v96, v96
  v_exp_f32 v100, v100
  v_exp_f32 v104, v104
  v_exp_f32 v108, v108
  v_exp_f32 v81, v81
  v_exp_f32 v85, v85
  v_exp_f32 v89, v89
  v_exp_f32 v93, v93
  v_exp_f32 v97, v97
  v_exp_f32 v101, v101
  v_exp_f32 v105, v105
  v_exp_f32 v109, v109
  v_exp_f32 v82, v82
  v_exp_f32 v86, v86
  v_exp_f32 v90, v90
  v_exp_f32 v94, v94
  v_exp_f32 v98, v98
  v_exp_f32 v102, v102
  v_exp_f32 v106, v106
  v_exp_f32 v110, v110
  v_exp_f32 v83, v83
  v_exp_f32 v87, v87
  v_exp_f32 v91, v91
  v_exp_f32 v95, v95
  v_exp_f32 v99, v99
  v_exp_f32 v103, v103
  v_exp_f32 v107, v107
  v_exp_f32 v111, v111
  s_waitcnt vmcnt(0)
  s_cmp_eq_u32 s3, 0
  s_cbranch_scc0 L_parallel_sum__linear_kernel_hedgehog__glu_gated_reglu__prompt_kernel_e0_ac
  s_mov_b64 s[86:87], exec
  s_mov_b64 exec, 0xff
  s_mov_b32 s89, 0
L_parallel_sum__linear_kernel_hedgehog__glu_gated_reglu__prompt_kernel_e0_all:
  v_cmp_le_u32 vcc, 32, v12
  s_add_u32 s89, s89, 1
  s_nop 2
  s_cmp_eq_u64 vcc, exec
  s_cbranch_scc1 L_parallel_sum__linear_kernel_hedgehog__glu_gated_reglu__prompt_kernel_e0_allok
  s_cmp_ge_u32 s89, 1048576
  s_cbranch_scc1 L_parallel_sum__linear_kernel_hedgehog__glu_gated_reglu__prompt_kernel_e0_allok
  s_sleep 1
  buffer_load_dword v12, v11, s[16:19], 0 offen sc1
  s_waitcnt vmcnt(0)
  s_branch L_parallel_sum__linear_kernel_hedgehog__glu_gated_reglu__prompt_kernel_e0_all
L_parallel_sum__linear_kernel_hedgehog__glu_gated_reglu__prompt_kernel_e0_allok:
  s_mov_b64 exec, s[86:87]
L_parallel_sum__linear_kernel_hedgehog__glu_gated_reglu__prompt_kernel_e0_ac:
  s_barrier
  s_cmp_eq_u32 s3, 0
  s_cbranch_scc0 L_parallel_sum__linear_kernel_hedgehog__glu_gated_reglu__prompt_kernel_e0_hp
  s_mov_b64 s[86:87], exec
  s_mov_b64 exec, 1
  v_mov_b32 v11, 1
  v_mov_b32 v12, 0
  s_sub_u32 s88, s85, 4096
  buffer_atomic_add v11, v12, s[24:27], s88 offen sc1
  s_mov_b64 exec, s[86:87]
L_parallel_sum__linear_kernel_hedgehog__glu_gated_reglu__prompt_kernel_e0_hp:
  v_exp_f32 v48, v48
  v_exp_f32 v52, v52
  v_exp_f32 v56, v56
  v_exp_f32 v60, v60
  v_exp_f32 v64, v64
  v_exp_f32 v68, v68
  v_exp_f32 v72, v72
  v_exp_f32 v76, v76
  v_exp_f32 v49, v49
  v_exp_f32 v53, v53
  v_exp_f32 v57, v57
  v_exp_f32 v61, v61
  v_exp_f32 v65, v65
  v_exp_f32 v69, v69
  v_exp_f32 v73, v73
  v_exp_f32 v77, v77
  v_exp_f32 v50, v50
  v_exp_f32 v54, v54
  v_exp_f32 v58, v58
  v_exp_f32 v62, v62
  v_exp_f32 v66, v66
  v_exp_f32 v70, v70
  v_exp_f32 v74, v74
  v_exp_f32 v78, v78
  v_exp_f32 v51, v51
  v_exp_f32 v55, v55
  v_exp_f32 v59, v59
  v_exp_f32 v63, v63
  v_exp_f32 v67, v67
  v_exp_f32 v71, v71
  v_exp_f32 v75, v75
  v_exp_f32 v79, v79
  v_pk_add_f32 v[16:17], v[176:177], v[178:179]
  v_pk_add_f32 v[20:21], v[184:185], v[186:187]
  v_pk_add_f32 v[24:25], v[192:193], v[194:195]
  v_pk_add_f32 v[28:29], v[200:201], v[202:203]
  v_pk_add_f32 v[32:33], v[208:209], v[210:211]
  v_pk_add_f32 v[36:37], v[216:217], v[218:219]
  v_pk_add_f32 v[40:41], v[224:225], v[226:227]
  v_pk_add_f32 v[44:45], v[232:233], v[234:235]
  v_pk_add_f32 v[18:19], v[80:81], v[82:83]
  v_pk_add_f32 v[22:23], v[84:85], v[86:87]
  v_pk_add_f32 v[26:27], v[88:89], v[90:91]
  v_pk_add_f32 v[30:31], v[92:93], v[94:95]
  v_pk_add_f32 v[34:35], v[96:97], v[98:99]
  v_pk_add_f32 v[38:39], v[100:101], v[102:103]
  v_pk_add_f32 v[42:43], v[104:105], v[106:107]
  v_pk_add_f32 v[46:47], v[108:109], v[110:111]
  v_pk_add_f32 v[16:17], v[16:17], v[180:181]
  v_pk_add_f32 v[20:21], v[20:21], v[188:189]
  v_pk_add_f32 v[24:25], v[24:25], v[196:197]
  v_pk_add_f32 v[28:29], v[28:29], v[204:205]
  v_pk_add_f32 v[32:33], v[32:33], v[212:213]
  v_pk_add_f32 v[36:37], v[36:37], v[220:221]
  v_pk_add_f32 v[40:41], v[40:41], v[228:229]
  v_pk_add_f32 v[44:45], v[44:45], v[236:237]
  v_pk_add_f32 v[18:19], v[18:19], v[48:49]
  v_pk_add_f32 v[22:23], v[22:23], v[52:53]
  v_pk_add_f32 v[26:27], v[26:27], v[56:57]
  v_pk_add_f32 v[30:31], v[30:31], v[60:61]
  v_pk_add_f32 v[34:35], v[34:35], v[64:65]
  v_pk_add_f32 v[38:39], v[38:39], v[68:69]
  v_pk_add_f32 v[42:43], v[42:43], v[72:73]
  v_pk_add_f32 v[46:47], v[46:47], v[76:77]
  v_pk_add_f32 v[16:17], v[16:17], v[182:183]
  v_pk_add_f32 v[20:21], v[20:21], v[190:191]
  v_pk_add_f32 v[24:25], v[24:25], v[198:199]
  v_pk_add_f32 v[28:29], v[28:29], v[206:207]
  v_pk_add_f32 v[32:33], v[32:33], v[214:215]
  v_pk_add_f32 v[36:37], v[36:37], v[222:223]
  v_pk_add_f32 v[40:41], v[40:41], v[230:231]
  v_pk_add_f32 v[44:45], v[44:45], v[238:239]
  v_pk_add_f32 v[18:19], v[18:19], v[50:51]
  v_pk_add_f32 v[22:23], v[22:23], v[54:55]
  v_pk_add_f32 v[26:27], v[26:27], v[58:59]
  v_pk_add_f32 v[30:31], v[30:31], v[62:63]
  v_pk_add_f32 v[34:35], v[34:35], v[66:67]
  v_pk_add_f32 v[38:39], v[38:39], v[70:71]
  v_pk_add_f32 v[42:43], v[42:43], v[74:75]
  v_pk_add_f32 v[46:47], v[46:47], v[78:79]
  v_add_f32 v16, v16, v17
  v_add_f32 v20, v20, v21
  v_add_f32 v24, v24, v25
  v_add_f32 v28, v28, v29
  v_add_f32 v32, v32, v33
  v_add_f32 v36, v36, v37
  v_add_f32 v40, v40, v41
  v_add_f32 v44, v44, v45
  v_add_f32 v17, v18, v19
  v_add_f32 v21, v22, v23
  v_add_f32 v25, v26, v27
  v_add_f32 v29, v30, v31
  v_add_f32 v33, v34, v35
  v_add_f32 v37, v38, v39
  v_add_f32 v41, v42, v43
  v_add_f32 v45, v46, v47
  v_permlane16_swap_b32 v16, v17
  v_permlane16_swap_b32 v20, v21
  v_permlane16_swap_b32 v24, v25
  v_permlane16_swap_b32 v28, v29
  v_permlane16_swap_b32 v32, v33
  v_permlane16_swap_b32 v36, v37
  v_permlane16_swap_b32 v40, v41
  v_permlane16_swap_b32 v44, v45
  v_add_f32 v16, v16, v17
  v_add_f32 v20, v20, v21
  v_add_f32 v24, v24, v25
  v_add_f32 v28, v28, v29
  v_add_f32 v32, v32, v33
  v_add_f32 v36, v36, v37
  v_add_f32 v40, v40, v41
  v_add_f32 v44, v44, v45
  v_mov_b32 v17, v16
  v_mov_b32 v21, v20
  v_mov_b32 v25, v24
  v_mov_b32 v29, v28
  v_mov_b32 v33, v32
  v_mov_b32 v37, v36
  v_mov_b32 v41, v40
  v_mov_b32 v45, v44
  v_permlane32_swap_b32 v16, v17
  v_permlane32_swap_b32 v20, v21
  v_permlane32_swap_b32 v24, v25
  v_permlane32_swap_b32 v28, v29
  v_permlane32_swap_b32 v32, v33
  v_permlane32_swap_b32 v36, v37
  v_permlane32_swap_b32 v40, v41
  v_permlane32_swap_b32 v44, v45
  v_add_f32 v16, v16, v17
  v_add_f32 v20, v20, v21
  v_add_f32 v24, v24, v25
  v_add_f32 v28, v28, v29
  v_add_f32 v32, v32, v33
  v_add_f32 v36, v36, v37
  v_add_f32 v40, v40, v41
  v_add_f32 v44, v44, v45
  v_rcp_f32 v16, v16
  v_rcp_f32 v20, v20
  v_rcp_f32 v24, v24
  v_rcp_f32 v28, v28
  v_rcp_f32 v32, v32
  v_rcp_f32 v36, v36
  v_rcp_f32 v40, v40
  v_rcp_f32 v44, v44
  v_mov_b32 v17, v16
  v_mov_b32 v21, v20
  v_mov_b32 v25, v24
  v_mov_b32 v29, v28
  v_mov_b32 v33, v32
  v_mov_b32 v37, v36
  v_mov_b32 v41, v40
  v_mov_b32 v45, v44
  v_permlane16_swap_b32 v16, v17
  v_permlane16_swap_b32 v20, v21
  v_permlane16_swap_b32 v24, v25
  v_permlane16_swap_b32 v28, v29
  v_permlane16_swap_b32 v32, v33
  v_permlane16_swap_b32 v36, v37
  v_permlane16_swap_b32 v40, v41
  v_permlane16_swap_b32 v44, v45
  v_pk_mul_f32 v[176:177], v[176:177], v[16:17] op_sel_hi:[1,0]
  v_pk_mul_f32 v[184:185], v[184:185], v[20:21] op_sel_hi:[1,0]
  v_pk_mul_f32 v[192:193], v[192:193], v[24:25] op_sel_hi:[1,0]
  v_pk_mul_f32 v[200:201], v[200:201], v[28:29] op_sel_hi:[1,0]
  v_pk_mul_f32 v[208:209], v[208:209], v[32:33] op_sel_hi:[1,0]
  v_pk_mul_f32 v[216:217], v[216:217], v[36:37] op_sel_hi:[1,0]
  v_pk_mul_f32 v[224:225], v[224:225], v[40:41] op_sel_hi:[1,0]
  v_pk_mul_f32 v[232:233], v[232:233], v[44:45] op_sel_hi:[1,0]
  v_pk_mul_f32 v[178:179], v[178:179], v[16:17] op_sel_hi:[1,0]
  v_pk_mul_f32 v[186:187], v[186:187], v[20:21] op_sel_hi:[1,0]
  v_pk_mul_f32 v[194:195], v[194:195], v[24:25] op_sel_hi:[1,0]
  v_pk_mul_f32 v[202:203], v[202:203], v[28:29] op_sel_hi:[1,0]
  v_pk_mul_f32 v[210:211], v[210:211], v[32:33] op_sel_hi:[1,0]
  v_pk_mul_f32 v[218:219], v[218:219], v[36:37] op_sel_hi:[1,0]
  v_pk_mul_f32 v[226:227], v[226:227], v[40:41] op_sel_hi:[1,0]
  v_pk_mul_f32 v[234:235], v[234:235], v[44:45] op_sel_hi:[1,0]
  v_pk_mul_f32 v[180:181], v[180:181], v[16:17] op_sel_hi:[1,0]
  v_pk_mul_f32 v[188:189], v[188:189], v[20:21] op_sel_hi:[1,0]
  v_pk_mul_f32 v[196:197], v[196:197], v[24:25] op_sel_hi:[1,0]
  v_pk_mul_f32 v[204:205], v[204:205], v[28:29] op_sel_hi:[1,0]
  v_pk_mul_f32 v[212:213], v[212:213], v[32:33] op_sel_hi:[1,0]
  v_pk_mul_f32 v[220:221], v[220:221], v[36:37] op_sel_hi:[1,0]
  v_pk_mul_f32 v[228:229], v[228:229], v[40:41] op_sel_hi:[1,0]
  v_pk_mul_f32 v[236:237], v[236:237], v[44:45] op_sel_hi:[1,0]
  v_pk_mul_f32 v[182:183], v[182:183], v[16:17] op_sel_hi:[1,0]
  v_pk_mul_f32 v[190:191], v[190:191], v[20:21] op_sel_hi:[1,0]
  v_pk_mul_f32 v[198:199], v[198:199], v[24:25] op_sel_hi:[1,0]
  v_pk_mul_f32 v[206:207], v[206:207], v[28:29] op_sel_hi:[1,0]
  v_pk_mul_f32 v[214:215], v[214:215], v[32:33] op_sel_hi:[1,0]
  v_pk_mul_f32 v[222:223], v[222:223], v[36:37] op_sel_hi:[1,0]
  v_pk_mul_f32 v[230:231], v[230:231], v[40:41] op_sel_hi:[1,0]
  v_pk_mul_f32 v[238:239], v[238:239], v[44:45] op_sel_hi:[1,0]
  v_pk_mul_f32 v[80:81], v[80:81], v[16:17] op_sel:[0,1] op_sel_hi:[1,1]
  v_pk_mul_f32 v[84:85], v[84:85], v[20:21] op_sel:[0,1] op_sel_hi:[1,1]
  v_pk_mul_f32 v[88:89], v[88:89], v[24:25] op_sel:[0,1] op_sel_hi:[1,1]
  v_pk_mul_f32 v[92:93], v[92:93], v[28:29] op_sel:[0,1] op_sel_hi:[1,1]
  v_pk_mul_f32 v[96:97], v[96:97], v[32:33] op_sel:[0,1] op_sel_hi:[1,1]
  v_pk_mul_f32 v[100:101], v[100:101], v[36:37] op_sel:[0,1] op_sel_hi:[1,1]
  v_pk_mul_f32 v[104:105], v[104:105], v[40:41] op_sel:[0,1] op_sel_hi:[1,1]
  v_pk_mul_f32 v[108:109], v[108:109], v[44:45] op_sel:[0,1] op_sel_hi:[1,1]
  v_pk_mul_f32 v[82:83], v[82:83], v[16:17] op_sel:[0,1] op_sel_hi:[1,1]
  v_pk_mul_f32 v[86:87], v[86:87], v[20:21] op_sel:[0,1] op_sel_hi:[1,1]
  v_pk_mul_f32 v[90:91], v[90:91], v[24:25] op_sel:[0,1] op_sel_hi:[1,1]
  v_pk_mul_f32 v[94:95], v[94:95], v[28:29] op_sel:[0,1] op_sel_hi:[1,1]
  v_pk_mul_f32 v[98:99], v[98:99], v[32:33] op_sel:[0,1] op_sel_hi:[1,1]
  v_pk_mul_f32 v[102:103], v[102:103], v[36:37] op_sel:[0,1] op_sel_hi:[1,1]
  v_pk_mul_f32 v[106:107], v[106:107], v[40:41] op_sel:[0,1] op_sel_hi:[1,1]
  v_pk_mul_f32 v[110:111], v[110:111], v[44:45] op_sel:[0,1] op_sel_hi:[1,1]
  v_pk_mul_f32 v[48:49], v[48:49], v[16:17] op_sel:[0,1] op_sel_hi:[1,1]
  v_pk_mul_f32 v[52:53], v[52:53], v[20:21] op_sel:[0,1] op_sel_hi:[1,1]
  v_pk_mul_f32 v[56:57], v[56:57], v[24:25] op_sel:[0,1] op_sel_hi:[1,1]
  v_pk_mul_f32 v[60:61], v[60:61], v[28:29] op_sel:[0,1] op_sel_hi:[1,1]
  v_pk_mul_f32 v[64:65], v[64:65], v[32:33] op_sel:[0,1] op_sel_hi:[1,1]
  v_pk_mul_f32 v[68:69], v[68:69], v[36:37] op_sel:[0,1] op_sel_hi:[1,1]
  v_pk_mul_f32 v[72:73], v[72:73], v[40:41] op_sel:[0,1] op_sel_hi:[1,1]
  v_pk_mul_f32 v[76:77], v[76:77], v[44:45] op_sel:[0,1] op_sel_hi:[1,1]
  v_pk_mul_f32 v[50:51], v[50:51], v[16:17] op_sel:[0,1] op_sel_hi:[1,1]
  v_pk_mul_f32 v[54:55], v[54:55], v[20:21] op_sel:[0,1] op_sel_hi:[1,1]
  v_pk_mul_f32 v[58:59], v[58:59], v[24:25] op_sel:[0,1] op_sel_hi:[1,1]
  v_pk_mul_f32 v[62:63], v[62:63], v[28:29] op_sel:[0,1] op_sel_hi:[1,1]
  v_pk_mul_f32 v[66:67], v[66:67], v[32:33] op_sel:[0,1] op_sel_hi:[1,1]
  v_pk_mul_f32 v[70:71], v[70:71], v[36:37] op_sel:[0,1] op_sel_hi:[1,1]
  v_pk_mul_f32 v[74:75], v[74:75], v[40:41] op_sel:[0,1] op_sel_hi:[1,1]
  v_pk_mul_f32 v[78:79], v[78:79], v[44:45] op_sel:[0,1] op_sel_hi:[1,1]
  v_cvt_pk_bf16_f32 v176, v176, v177
  v_cvt_pk_bf16_f32 v184, v184, v185
  v_cvt_pk_bf16_f32 v192, v192, v193
  v_cvt_pk_bf16_f32 v200, v200, v201
  v_cvt_pk_bf16_f32 v208, v208, v209
  v_cvt_pk_bf16_f32 v216, v216, v217
  v_cvt_pk_bf16_f32 v224, v224, v225
  v_cvt_pk_bf16_f32 v232, v232, v233
  v_cvt_pk_bf16_f32 v177, v178, v179
  v_cvt_pk_bf16_f32 v185, v186, v187
  v_cvt_pk_bf16_f32 v193, v194, v195
  v_cvt_pk_bf16_f32 v201, v202, v203
  v_cvt_pk_bf16_f32 v209, v210, v211
  v_cvt_pk_bf16_f32 v217, v218, v219
  v_cvt_pk_bf16_f32 v225, v226, v227
  v_cvt_pk_bf16_f32 v233, v234, v235
  v_cvt_pk_bf16_f32 v178, v180, v181
  v_cvt_pk_bf16_f32 v186, v188, v189
  v_cvt_pk_bf16_f32 v194, v196, v197
  v_cvt_pk_bf16_f32 v202, v204, v205
  v_cvt_pk_bf16_f32 v210, v212, v213
  v_cvt_pk_bf16_f32 v218, v220, v221
  v_cvt_pk_bf16_f32 v226, v228, v229
  v_cvt_pk_bf16_f32 v234, v236, v237
  v_cvt_pk_bf16_f32 v179, v182, v183
  v_cvt_pk_bf16_f32 v187, v190, v191
  v_cvt_pk_bf16_f32 v195, v198, v199
  v_cvt_pk_bf16_f32 v203, v206, v207
  v_cvt_pk_bf16_f32 v211, v214, v215
  v_cvt_pk_bf16_f32 v219, v222, v223
  v_cvt_pk_bf16_f32 v227, v230, v231
  v_cvt_pk_bf16_f32 v235, v238, v239
  v_cvt_pk_bf16_f32 v80, v80, v81
  v_cvt_pk_bf16_f32 v84, v84, v85
  v_cvt_pk_bf16_f32 v88, v88, v89
  v_cvt_pk_bf16_f32 v92, v92, v93
  v_cvt_pk_bf16_f32 v96, v96, v97
  v_cvt_pk_bf16_f32 v100, v100, v101
  v_cvt_pk_bf16_f32 v104, v104, v105
  v_cvt_pk_bf16_f32 v108, v108, v109
  v_cvt_pk_bf16_f32 v81, v82, v83
  v_cvt_pk_bf16_f32 v85, v86, v87
  v_cvt_pk_bf16_f32 v89, v90, v91
  v_cvt_pk_bf16_f32 v93, v94, v95
  v_cvt_pk_bf16_f32 v97, v98, v99
  v_cvt_pk_bf16_f32 v101, v102, v103
  v_cvt_pk_bf16_f32 v105, v106, v107
  v_cvt_pk_bf16_f32 v109, v110, v111
  v_cvt_pk_bf16_f32 v82, v48, v49
  v_cvt_pk_bf16_f32 v86, v52, v53
  v_cvt_pk_bf16_f32 v90, v56, v57
  v_cvt_pk_bf16_f32 v94, v60, v61
  v_cvt_pk_bf16_f32 v98, v64, v65
  v_cvt_pk_bf16_f32 v102, v68, v69
  v_cvt_pk_bf16_f32 v106, v72, v73
  v_cvt_pk_bf16_f32 v110, v76, v77
  v_cvt_pk_bf16_f32 v83, v50, v51
  v_cvt_pk_bf16_f32 v87, v54, v55
  v_cvt_pk_bf16_f32 v91, v58, v59
  v_cvt_pk_bf16_f32 v95, v62, v63
  v_cvt_pk_bf16_f32 v99, v66, v67
  v_cvt_pk_bf16_f32 v103, v70, v71
  v_cvt_pk_bf16_f32 v107, v74, v75
  v_cvt_pk_bf16_f32 v111, v78, v79
  s_and_b32 s70, s2, 3
  s_lshr_b32 s71, s2, 5
  v_lshrrev_b32 v6, 4, v1
  s_and_b32 s64, s3, 1
  s_lshl_b32 s64, s64, 2
  v_add_u32 v5, s64, v6
  v_bfe_u32 v7, v1, 1, 3
  v_xor_b32 v7, v7, v5
  v_and_b32 v8, 1, v1
  v_lshl_add_u32 v7, v7, 1, v8
  v_lshlrev_b32 v7, 4, v7
  v_lshl_add_u32 v7, v6, 11, v7
  s_lshl_b32 s64, s71, 8
  v_add_u32 v10, s64, v7
  s_mov_b32 s12, s54
  s_and_b32 s13, s55, 0xffff
  s_mov_b32 s14, 0x700000
  s_mov_b32 s15, 0x20000
  s_lshl_b32 s64, s3, 13
  s_mul_i32 s69, s70, 1835008
  s_add_u32 s29, s69, s64
  s_mul_i32 s69, s70, 524288
  s_add_u32 s65, s69, s64
  s_and_b32 s66, s47, 0xffff
  s_mov_b32 s67, 2097152
  s_lshl_b32 s68, s3, 10
  s_mov_b32 s30, 0
  s_add_u32 s29, s29, 393216
  s_add_u32 s20, s60, 0x1e00000
  s_addc_u32 s21, s61, 0
  s_and_b32 s21, s21, 0xffff
  s_mov_b32 s22, 0x300000
  s_mov_b32 s23, 0x20000
  s_lshl_b32 s36, s5, 3
  s_add_u32 s36, s36, s4
  s_mul_i32 s36, s36, 12288
  s_mov_b32 s89, s6
  s_bfe_u32 s88, s2, 0x10002
  s_lshl_b32 s88, s88, 2
  s_bfe_u32 s70, s2, 0x20003
  s_add_u32 s88, s88, s70
  s_lshl_b32 s88, s88, 2
  s_and_b32 s70, s2, 3
  s_add_u32 s88, s88, s70
  s_lshl_b32 s88, s88, 7
  s_add_u32 s88, s88, 4096
  v_mov_b32 v11, 0
  buffer_load_dword v12, v11, s[24:27], s88 offen sc1
  v_mfma_f32_16x16x32_bf16 v[48:51], v[176:179], a[122:125], 0
  v_cvt_pk_bf16_f32 v112, v112, v113
  v_mfma_f32_16x16x32_bf16 v[176:179], v[176:179], a[120:123], 0
  v_cvt_pk_bf16_f32 v113, v114, v115
  v_mfma_f32_16x16x32_bf16 v[180:183], v[80:83], a[122:125], 0
  v_cvt_pk_bf16_f32 v114, v116, v117
  v_mfma_f32_16x16x32_bf16 v[80:83], v[80:83], a[120:123], 0
  v_cvt_pk_bf16_f32 v115, v118, v119
  v_mfma_f32_16x16x32_bf16 v[52:55], v[184:187], a[122:125], 0
  v_cvt_pk_bf16_f32 v144, v144, v145
  v_mfma_f32_16x16x32_bf16 v[184:187], v[184:187], a[120:123], 0
  v_cvt_pk_bf16_f32 v145, v146, v147
  v_mfma_f32_16x16x32_bf16 v[188:191], v[84:87], a[122:125], 0
  v_cvt_pk_bf16_f32 v146, v148, v149
  v_mfma_f32_16x16x32_bf16 v[84:87], v[84:87], a[120:123], 0
  v_cvt_pk_bf16_f32 v147, v150, v151
  v_mfma_f32_16x16x32_bf16 v[56:59], v[192:195], a[122:125], 0
  v_cvt_pk_bf16_f32 v120, v120, v121
  v_mfma_f32_16x16x32_bf16 v[192:195], v[192:195], a[120:123], 0
  v_cvt_pk_bf16_f32 v121, v122, v123
  v_mfma_f32_16x16x32_bf16 v[196:199], v[88:91], a[122:125], 0
  v_cvt_pk_bf16_f32 v122, v124, v125
  v_mfma_f32_16x16x32_bf16 v[88:91], v[88:91], a[120:123], 0
  v_cvt_pk_bf16_f32 v123, v126, v127
  v_mfma_f32_16x16x32_bf16 v[60:63], v[200:203], a[122:125], 0
  v_cvt_pk_bf16_f32 v152, v152, v153
  v_mfma_f32_16x16x32_bf16 v[200:203], v[200:203], a[120:123], 0
  v_cvt_pk_bf16_f32 v153, v154, v155
  v_mfma_f32_16x16x32_bf16 v[204:207], v[92:95], a[122:125], 0
  v_cvt_pk_bf16_f32 v154, v156, v157
  v_mfma_f32_16x16x32_bf16 v[92:95], v[92:95], a[120:123], 0
  v_cvt_pk_bf16_f32 v155, v158, v159
  v_mfma_f32_16x16x32_bf16 v[64:67], v[208:211], a[122:125], 0
  v_cvt_pk_bf16_f32 v128, v128, v129
  v_mfma_f32_16x16x32_bf16 v[208:211], v[208:211], a[120:123], 0
  v_cvt_pk_bf16_f32 v129, v130, v131
  v_mfma_f32_16x16x32_bf16 v[212:215], v[96:99], a[122:125], 0
  v_cvt_pk_bf16_f32 v130, v132, v133
  v_mfma_f32_16x16x32_bf16 v[96:99], v[96:99], a[120:123], 0
  v_cvt_pk_bf16_f32 v131, v134, v135
  v_mfma_f32_16x16x32_bf16 v[68:71], v[216:219], a[122:125], 0
  v_cvt_pk_bf16_f32 v160, v160, v161
  v_mfma_f32_16x16x32_bf16 v[216:219], v[216:219], a[120:123], 0
  v_cvt_pk_bf16_f32 v161, v162, v163
  v_mfma_f32_16x16x32_bf16 v[220:223], v[100:103], a[122:125], 0
  v_cvt_pk_bf16_f32 v162, v164, v165
  v_mfma_f32_16x16x32_bf16 v[100:103], v[100:103], a[120:123], 0
  v_cvt_pk_bf16_f32 v163, v166, v167
  v_mfma_f32_16x16x32_bf16 v[72:75], v[224:227], a[122:125], 0
  v_cvt_pk_bf16_f32 v136, v136, v137
  v_mfma_f32_16x16x32_bf16 v[224:227], v[224:227], a[120:123], 0
  v_cvt_pk_bf16_f32 v137, v138, v139
  v_mfma_f32_16x16x32_bf16 v[228:231], v[104:107], a[122:125], 0
  v_cvt_pk_bf16_f32 v138, v140, v141
  v_mfma_f32_16x16x32_bf16 v[104:107], v[104:107], a[120:123], 0
  v_cvt_pk_bf16_f32 v139, v142, v143
  v_mfma_f32_16x16x32_bf16 v[76:79], v[232:235], a[122:125], 0
  v_cvt_pk_bf16_f32 v168, v168, v169
  v_mfma_f32_16x16x32_bf16 v[232:235], v[232:235], a[120:123], 0
  v_cvt_pk_bf16_f32 v169, v170, v171
  v_mfma_f32_16x16x32_bf16 v[236:239], v[108:111], a[122:125], 0
  v_cvt_pk_bf16_f32 v170, v172, v173
  v_mfma_f32_16x16x32_bf16 v[108:111], v[108:111], a[120:123], 0
  v_cvt_pk_bf16_f32 v171, v174, v175
  s_waitcnt vmcnt(0)
  v_readfirstlane_b32 s70, v12
  s_mov_b32 s84, 0
  s_nop 2
  s_cmp_ge_u32 s70, 8
  s_cbranch_scc0 L_parallel_sum__linear_kernel_hedgehog__glu_gated_reglu__prompt_kernel_e0_nx
  s_and_b32 s6, s2, 3
  s_bfe_u32 s4, s2, 0x10002
  s_lshl_b32 s4, s4, 2
  s_bfe_u32 s7, s2, 0x20003
  s_add_u32 s4, s4, s7
  s_lshr_b32 s5, s2, 5
  v_lshlrev_b32 v2, 4, v1
  v_add_u32 v3, 0x24000, v2
  v_add_u32 v4, 0x48000, v2
  v_add_u32 v5, 0x6c000, v2
  v_mov_b32 v0, 0
  s_lshl_b32 s7, s4, 4
  s_lshl_b32 s64, s3, 2
  s_add_u32 s7, s7, s64
  s_mul_i32 s7, s7, 144
  s_mul_i32 s64, s6, 28
  s_add_u32 s7, s7, s64
  s_lshl_b32 s28, s7, 10
  s_mul_i32 s64, s6, 20
  s_sub_u32 s34, 84, s64
  s_lshl_b32 s34, s34, 10
  s_lshl_b32 s7, s4, 2
  s_add_u32 s7, s7, s6
  s_lshl_b32 s7, s7, 7
  s_add_u32 s35, s7, 8192
  buffer_load_dwordx4 a[192:195], v2, s[8:11], s28 offen sc1
  buffer_load_dwordx4 a[196:199], v3, s[8:11], s28 offen sc1
  buffer_load_dwordx4 a[200:203], v4, s[8:11], s28 offen sc1
  buffer_load_dwordx4 a[204:207], v5, s[8:11], s28 offen sc1
  s_add_u32 s28, s28, 1024
  buffer_load_dwordx4 a[208:211], v2, s[8:11], s28 offen sc1
  buffer_load_dwordx4 a[212:215], v3, s[8:11], s28 offen sc1
  buffer_load_dwordx4 a[216:219], v4, s[8:11], s28 offen sc1
  buffer_load_dwordx4 a[220:223], v5, s[8:11], s28 offen sc1
  s_add_u32 s28, s28, 1024
  buffer_load_dwordx4 a[224:227], v2, s[8:11], s28 offen sc1
  buffer_load_dwordx4 a[228:231], v3, s[8:11], s28 offen sc1
  buffer_load_dwordx4 a[232:235], v4, s[8:11], s28 offen sc1
  buffer_load_dwordx4 a[236:239], v5, s[8:11], s28 offen sc1
  s_add_u32 s28, s28, 1024
  s_mov_b32 s84, 2
L_parallel_sum__linear_kernel_hedgehog__glu_gated_reglu__prompt_kernel_e0_nx:
  v_cvt_pk_bf16_f32 v48, v48, v49
  v_cvt_pk_bf16_f32 v49, v50, v51
  v_cvt_pk_bf16_f32 v50, v52, v53
  v_cvt_pk_bf16_f32 v51, v54, v55
  v_cvt_pk_bf16_f32 v176, v176, v177
  v_cvt_pk_bf16_f32 v177, v178, v179
  v_cvt_pk_bf16_f32 v178, v184, v185
  v_cvt_pk_bf16_f32 v179, v186, v187
  v_cvt_pk_bf16_f32 v180, v180, v181
  v_cvt_pk_bf16_f32 v181, v182, v183
  v_cvt_pk_bf16_f32 v182, v188, v189
  v_cvt_pk_bf16_f32 v183, v190, v191
  v_cvt_pk_bf16_f32 v80, v80, v81
  v_cvt_pk_bf16_f32 v81, v82, v83
  v_cvt_pk_bf16_f32 v82, v84, v85
  v_cvt_pk_bf16_f32 v83, v86, v87
  v_mfma_f32_16x16x32_bf16 a[0:3], v[48:51], v[112:115], 0
  v_cvt_pk_bf16_f32 v56, v56, v57
  v_cvt_pk_bf16_f32 v57, v58, v59
  v_mfma_f32_16x16x32_bf16 a[4:7], v[48:51], v[144:147], 0
  v_cvt_pk_bf16_f32 v58, v60, v61
  v_mfma_f32_16x16x32_bf16 a[32:35], v[48:51], a[126:129], 0
  v_cvt_pk_bf16_f32 v59, v62, v63
  v_mfma_f32_16x16x32_bf16 a[8:11], v[176:179], v[112:115], 0
  v_cvt_pk_bf16_f32 v192, v192, v193
  v_cvt_pk_bf16_f32 v193, v194, v195
  v_mfma_f32_16x16x32_bf16 a[12:15], v[176:179], v[144:147], 0
  v_cvt_pk_bf16_f32 v194, v200, v201
  v_mfma_f32_16x16x32_bf16 a[36:39], v[176:179], a[126:129], 0
  v_cvt_pk_bf16_f32 v195, v202, v203
  v_mfma_f32_16x16x32_bf16 a[16:19], v[180:183], v[112:115], 0
  v_cvt_pk_bf16_f32 v196, v196, v197
  v_cvt_pk_bf16_f32 v197, v198, v199
  v_mfma_f32_16x16x32_bf16 a[20:23], v[180:183], v[144:147], 0
  v_cvt_pk_bf16_f32 v198, v204, v205
  v_mfma_f32_16x16x32_bf16 a[40:43], v[180:183], a[126:129], 0
  v_cvt_pk_bf16_f32 v199, v206, v207
  v_mfma_f32_16x16x32_bf16 a[24:27], v[80:83], v[112:115], 0
  v_cvt_pk_bf16_f32 v88, v88, v89
  v_cvt_pk_bf16_f32 v89, v90, v91
  v_mfma_f32_16x16x32_bf16 a[28:31], v[80:83], v[144:147], 0
  v_cvt_pk_bf16_f32 v90, v92, v93
  v_mfma_f32_16x16x32_bf16 a[44:47], v[80:83], a[126:129], 0
  v_cvt_pk_bf16_f32 v91, v94, v95
  v_mfma_f32_16x16x32_bf16 a[0:3], v[56:59], v[120:123], a[0:3]
  v_cvt_pk_bf16_f32 v64, v64, v65
  v_cvt_pk_bf16_f32 v65, v66, v67
  v_mfma_f32_16x16x32_bf16 a[4:7], v[56:59], v[152:155], a[4:7]
  v_cvt_pk_bf16_f32 v66, v68, v69
  v_mfma_f32_16x16x32_bf16 a[32:35], v[56:59], a[126:129], a[32:35]
  v_cvt_pk_bf16_f32 v67, v70, v71
  v_mfma_f32_16x16x32_bf16 a[8:11], v[192:195], v[120:123], a[8:11]
  v_cvt_pk_bf16_f32 v208, v208, v209
  v_cvt_pk_bf16_f32 v209, v210, v211
  v_mfma_f32_16x16x32_bf16 a[12:15], v[192:195], v[152:155], a[12:15]
  v_cvt_pk_bf16_f32 v210, v216, v217
  v_mfma_f32_16x16x32_bf16 a[36:39], v[192:195], a[126:129], a[36:39]
  v_cvt_pk_bf16_f32 v211, v218, v219
  v_mfma_f32_16x16x32_bf16 a[16:19], v[196:199], v[120:123], a[16:19]
  v_cvt_pk_bf16_f32 v212, v212, v213
  v_cvt_pk_bf16_f32 v213, v214, v215
  v_mfma_f32_16x16x32_bf16 a[20:23], v[196:199], v[152:155], a[20:23]
  v_cvt_pk_bf16_f32 v214, v220, v221
  v_mfma_f32_16x16x32_bf16 a[40:43], v[196:199], a[126:129], a[40:43]
  v_cvt_pk_bf16_f32 v215, v222, v223
  v_mfma_f32_16x16x32_bf16 a[24:27], v[88:91], v[120:123], a[24:27]
  v_cvt_pk_bf16_f32 v96, v96, v97
  v_cvt_pk_bf16_f32 v97, v98, v99
  v_mfma_f32_16x16x32_bf16 a[28:31], v[88:91], v[152:155], a[28:31]
  v_cvt_pk_bf16_f32 v98, v100, v101
  v_mfma_f32_16x16x32_bf16 a[44:47], v[88:91], a[126:129], a[44:47]
  v_cvt_pk_bf16_f32 v99, v102, v103
  v_mfma_f32_16x16x32_bf16 a[0:3], v[64:67], v[128:131], a[0:3]
  v_cvt_pk_bf16_f32 v72, v72, v73
  v_cvt_pk_bf16_f32 v73, v74, v75
  v_mfma_f32_16x16x32_bf16 a[4:7], v[64:67], v[160:163], a[4:7]
  v_cvt_pk_bf16_f32 v74, v76, v77
  v_mfma_f32_16x16x32_bf16 a[32:35], v[64:67], a[126:129], a[32:35]
  v_cvt_pk_bf16_f32 v75, v78, v79
  v_mfma_f32_16x16x32_bf16 a[8:11], v[208:211], v[128:131], a[8:11]
  v_cvt_pk_bf16_f32 v224, v224, v225
  v_cvt_pk_bf16_f32 v225, v226, v227
  v_mfma_f32_16x16x32_bf16 a[12:15], v[208:211], v[160:163], a[12:15]
  v_cvt_pk_bf16_f32 v226, v232, v233
  v_mfma_f32_16x16x32_bf16 a[36:39], v[208:211], a[126:129], a[36:39]
  v_cvt_pk_bf16_f32 v227, v234, v235
  v_mfma_f32_16x16x32_bf16 a[16:19], v[212:215], v[128:131], a[16:19]
  v_cvt_pk_bf16_f32 v228, v228, v229
  v_cvt_pk_bf16_f32 v229, v230, v231
  v_mfma_f32_16x16x32_bf16 a[20:23], v[212:215], v[160:163], a[20:23]
  v_cvt_pk_bf16_f32 v230, v236, v237
  v_mfma_f32_16x16x32_bf16 a[40:43], v[212:215], a[126:129], a[40:43]
  v_cvt_pk_bf16_f32 v231, v238, v239
  v_mfma_f32_16x16x32_bf16 a[24:27], v[96:99], v[128:131], a[24:27]
  v_cvt_pk_bf16_f32 v104, v104, v105
  v_cvt_pk_bf16_f32 v105, v106, v107
  v_mfma_f32_16x16x32_bf16 a[28:31], v[96:99], v[160:163], a[28:31]
  v_cvt_pk_bf16_f32 v106, v108, v109
  v_mfma_f32_16x16x32_bf16 a[44:47], v[96:99], a[126:129], a[44:47]
  v_cvt_pk_bf16_f32 v107, v110, v111
  v_mfma_f32_16x16x32_bf16 a[0:3], v[72:75], v[136:139], a[0:3]
  v_mfma_f32_16x16x32_bf16 a[4:7], v[72:75], v[168:171], a[4:7]
  v_mfma_f32_16x16x32_bf16 a[32:35], v[72:75], a[126:129], a[32:35]
  v_mfma_f32_16x16x32_bf16 a[8:11], v[224:227], v[136:139], a[8:11]
  v_mfma_f32_16x16x32_bf16 a[12:15], v[224:227], v[168:171], a[12:15]
  v_mfma_f32_16x16x32_bf16 a[36:39], v[224:227], a[126:129], a[36:39]
  v_mfma_f32_16x16x32_bf16 a[16:19], v[228:231], v[136:139], a[16:19]
  v_mfma_f32_16x16x32_bf16 a[20:23], v[228:231], v[168:171], a[20:23]
  v_mfma_f32_16x16x32_bf16 a[40:43], v[228:231], a[126:129], a[40:43]
  v_mfma_f32_16x16x32_bf16 a[24:27], v[104:107], v[136:139], a[24:27]
  v_mfma_f32_16x16x32_bf16 a[28:31], v[104:107], v[168:171], a[28:31]
  v_mfma_f32_16x16x32_bf16 a[44:47], v[104:107], a[126:129], a[44:47]
  s_mul_i32 s83, s89, 6144
  v_add_u32 v7, 149504, v2
  v_add_u32 v8, s83, v7
  s_xor_b32 s83, s83, 6144
  v_add_u32 v9, s83, v7
  s_cmp_eq_u32 s89, 0
  s_cbranch_scc0 L_parallel_sum__linear_kernel_hedgehog__glu_gated_reglu__prompt_kernel_xch1
  ds_write_b128 v8, a[24:27] offset:0
  ds_write_b128 v8, a[28:31] offset:1024
  ds_write_b128 v8, a[32:35] offset:2048
  ds_write_b128 v8, a[36:39] offset:3072
  ds_write_b128 v8, a[40:43] offset:4096
  ds_write_b128 v8, a[44:47] offset:5120
  v_accvgpr_read_b32 v48, a0
  v_accvgpr_read_b32 v49, a1
  v_accvgpr_read_b32 v50, a2
  v_accvgpr_read_b32 v51, a3
  v_accvgpr_read_b32 v52, a4
  v_accvgpr_read_b32 v53, a5
  v_accvgpr_read_b32 v54, a6
  v_accvgpr_read_b32 v55, a7
  v_accvgpr_read_b32 v56, a8
  v_accvgpr_read_b32 v57, a9
  v_accvgpr_read_b32 v58, a10
  v_accvgpr_read_b32 v59, a11
  v_accvgpr_read_b32 v60, a12
  v_accvgpr_read_b32 v61, a13
  v_accvgpr_read_b32 v62, a14
  v_accvgpr_read_b32 v63, a15
  v_accvgpr_read_b32 v64, a16
  v_accvgpr_read_b32 v65, a17
  v_accvgpr_read_b32 v66, a18
  v_accvgpr_read_b32 v67, a19
  v_accvgpr_read_b32 v68, a20
  v_accvgpr_read_b32 v69, a21
  v_accvgpr_read_b32 v70, a22
  v_accvgpr_read_b32 v71, a23
  s_waitcnt lgkmcnt(0)
  s_barrier
  ds_read_b128 v[80:83], v9 offset:0
  ds_read_b128 v[84:87], v9 offset:1024
  ds_read_b128 v[88:91], v9 offset:2048
  ds_read_b128 v[92:95], v9 offset:3072
  ds_read_b128 v[96:99], v9 offset:4096
  ds_read_b128 v[100:103], v9 offset:5120
  s_add_u32 s36, s36, 0
  s_waitcnt lgkmcnt(0)
  v_pk_add_f32 v[48:49], v[48:49], v[80:81]
  v_pk_add_f32 v[50:51], v[50:51], v[82:83]
  v_pk_add_f32 v[52:53], v[52:53], v[84:85]
  v_pk_add_f32 v[54:55], v[54:55], v[86:87]
  v_pk_add_f32 v[56:57], v[56:57], v[88:89]
  v_pk_add_f32 v[58:59], v[58:59], v[90:91]
  v_pk_add_f32 v[60:61], v[60:61], v[92:93]
  v_pk_add_f32 v[62:63], v[62:63], v[94:95]
  v_pk_add_f32 v[64:65], v[64:65], v[96:97]
  v_pk_add_f32 v[66:67], v[66:67], v[98:99]
  v_pk_add_f32 v[68:69], v[68:69], v[100:101]
  v_pk_add_f32 v[70:71], v[70:71], v[102:103]
  buffer_store_dwordx4 v[48:51], v2, s[20:23], s36 offen offset:0 sc1
  buffer_store_dwordx4 v[52:55], v2, s[20:23], s36 offen offset:1024 sc1
  buffer_store_dwordx4 v[56:59], v2, s[20:23], s36 offen offset:2048 sc1
  buffer_store_dwordx4 v[60:63], v2, s[20:23], s36 offen offset:3072 sc1
  s_add_u32 s36, s36, 4096
  buffer_store_dwordx4 v[64:67], v2, s[20:23], s36 offen offset:0 sc1
  buffer_store_dwordx4 v[68:71], v2, s[20:23], s36 offen offset:1024 sc1
  s_branch L_parallel_sum__linear_kernel_hedgehog__glu_gated_reglu__prompt_kernel_xchd
L_parallel_sum__linear_kernel_hedgehog__glu_gated_reglu__prompt_kernel_xch1:
  ds_write_b128 v8, a[0:3] offset:0
  ds_write_b128 v8, a[4:7] offset:1024
  ds_write_b128 v8, a[8:11] offset:2048
  ds_write_b128 v8, a[12:15] offset:3072
  ds_write_b128 v8, a[16:19] offset:4096
  ds_write_b128 v8, a[20:23] offset:5120
  v_accvgpr_read_b32 v48, a24
  v_accvgpr_read_b32 v49, a25
  v_accvgpr_read_b32 v50, a26
  v_accvgpr_read_b32 v51, a27
  v_accvgpr_read_b32 v52, a28
  v_accvgpr_read_b32 v53, a29
  v_accvgpr_read_b32 v54, a30
  v_accvgpr_read_b32 v55, a31
  v_accvgpr_read_b32 v56, a32
  v_accvgpr_read_b32 v57, a33
  v_accvgpr_read_b32 v58, a34
  v_accvgpr_read_b32 v59, a35
  v_accvgpr_read_b32 v60, a36
  v_accvgpr_read_b32 v61, a37
  v_accvgpr_read_b32 v62, a38
  v_accvgpr_read_b32 v63, a39
  v_accvgpr_read_b32 v64, a40
  v_accvgpr_read_b32 v65, a41
  v_accvgpr_read_b32 v66, a42
  v_accvgpr_read_b32 v67, a43
  v_accvgpr_read_b32 v68, a44
  v_accvgpr_read_b32 v69, a45
  v_accvgpr_read_b32 v70, a46
  v_accvgpr_read_b32 v71, a47
  s_waitcnt lgkmcnt(0)
  s_barrier
  ds_read_b128 v[80:83], v9 offset:0
  ds_read_b128 v[84:87], v9 offset:1024
  ds_read_b128 v[88:91], v9 offset:2048
  ds_read_b128 v[92:95], v9 offset:3072
  ds_read_b128 v[96:99], v9 offset:4096
  ds_read_b128 v[100:103], v9 offset:5120
  s_add_u32 s36, s36, 6144
  s_waitcnt lgkmcnt(0)
  v_pk_add_f32 v[48:49], v[48:49], v[80:81]
  v_pk_add_f32 v[50:51], v[50:51], v[82:83]
  v_pk_add_f32 v[52:53], v[52:53], v[84:85]
  v_pk_add_f32 v[54:55], v[54:55], v[86:87]
  v_pk_add_f32 v[56:57], v[56:57], v[88:89]
  v_pk_add_f32 v[58:59], v[58:59], v[90:91]
  v_pk_add_f32 v[60:61], v[60:61], v[92:93]
  v_pk_add_f32 v[62:63], v[62:63], v[94:95]
  v_pk_add_f32 v[64:65], v[64:65], v[96:97]
  v_pk_add_f32 v[66:67], v[66:67], v[98:99]
  v_pk_add_f32 v[68:69], v[68:69], v[100:101]
  v_pk_add_f32 v[70:71], v[70:71], v[102:103]
  buffer_store_dwordx4 v[48:51], v2, s[20:23], s36 offen offset:0 sc1
  buffer_store_dwordx4 v[52:55], v2, s[20:23], s36 offen offset:1024 sc1
  buffer_store_dwordx4 v[56:59], v2, s[20:23], s36 offen offset:2048 sc1
  buffer_store_dwordx4 v[60:63], v2, s[20:23], s36 offen offset:3072 sc1
  s_add_u32 s36, s36, 4096
  buffer_store_dwordx4 v[64:67], v2, s[20:23], s36 offen offset:0 sc1
  buffer_store_dwordx4 v[68:71], v2, s[20:23], s36 offen offset:1024 sc1
L_parallel_sum__linear_kernel_hedgehog__glu_gated_reglu__prompt_kernel_xchd:
  s_branch L_parallel_sum__linear_kernel_hedgehog__glu_gated_reglu__prompt_kernel_g2
L_parallel_sum__linear_kernel_hedgehog__glu_gated_reglu__prompt_kernel_var1:
  s_cmp_ge_u32 s3, 2
  s_cbranch_scc1 L_parallel_sum__linear_kernel_hedgehog__glu_gated_reglu__prompt_kernel_v1_th1
  s_mov_b32 s12, s50
  s_and_b32 s13, s51, 0xffff
  s_mov_b32 s14, 0x700000
  s_mov_b32 s15, 0x20000
  s_mov_b32 s32, 229376
  s_mov_b32 s29, 0
  s_mov_b32 s76, 23552
  v_add_u32 v24, 64, v1
  v_mul_u32_u24 v25, 4682, v24
  v_lshrrev_b32 v25, 16, v25
  v_mul_u32_u24 v26, 14, v25
  v_sub_u32 v26, v24, v26
  v_mul_u32_u24 v25, 7168, v25
  v_lshl_add_u32 v25, v26, 4, v25
  s_mul_i32 s83, s5, 224
  v_add_u32 v6, s83, v25
  s_mov_b32 s16, s50
  s_and_b32 s17, s51, 0xffff
  s_mov_b32 s18, 0x700000
  s_mov_b32 s19, 0x20000
  s_mov_b32 s33, 229376
  s_mov_b32 s30, 0
  s_mov_b32 s77, 27648
  v_add_u32 v24, 320, v1
  v_mul_u32_u24 v25, 4682, v24
  v_lshrrev_b32 v25, 16, v25
  v_mul_u32_u24 v26, 14, v25
  v_sub_u32 v26, v24, v26
  v_mul_u32_u24 v25, 7168, v25
  v_lshl_add_u32 v25, v26, 4, v25
  s_mul_i32 s83, s5, 224
  v_add_u32 v7, s83, v25
  s_mov_b32 s20, s52
  s_and_b32 s21, s53, 0xffff
  s_mov_b32 s22, 0x700000
  s_mov_b32 s23, 0x20000
  s_mov_b32 s34, 229376
  s_mov_b32 s31, 0
  s_mov_b32 s78, 31744
  v_add_u32 v24, 128, v1
  v_mul_u32_u24 v25, 4682, v24
  v_lshrrev_b32 v25, 16, v25
  v_mul_u32_u24 v26, 14, v25
  v_sub_u32 v26, v24, v26
  v_mul_u32_u24 v25, 7168, v25
  v_lshl_add_u32 v25, v26, 4, v25
  s_mul_i32 s83, s5, 224
  v_add_u32 v8, s83, v25
  s_mov_b32 s64, s52
  s_and_b32 s65, s53, 0xffff
  s_mov_b32 s66, 0x700000
  s_mov_b32 s67, 0x20000
  s_mov_b32 s74, 229376
  s_mov_b32 s72, 0
  s_mov_b32 s79, 35840
  v_add_u32 v24, 384, v1
  v_mul_u32_u24 v25, 4682, v24
  v_lshrrev_b32 v25, 16, v25
  v_mul_u32_u24 v26, 14, v25
  v_sub_u32 v26, v24, v26
  v_mul_u32_u24 v25, 7168, v25
  v_lshl_add_u32 v25, v26, 4, v25
  s_mul_i32 s83, s5, 224
  v_add_u32 v9, s83, v25
  s_mov_b32 s68, s42
  s_and_b32 s69, s43, 0xffff
  s_mov_b32 s70, 0x600000
  s_mov_b32 s71, 0x20000
  s_mov_b32 s75, 196608
  s_mov_b32 s73, 0
  s_mov_b32 s80, 19456
  v_add_u32 v24, 192, v1
  v_mul_u32_u24 v25, 5462, v24
  v_lshrrev_b32 v25, 16, v25
  v_mul_u32_u24 v26, 12, v25
  v_sub_u32 v26, v24, v26
  v_bfe_u32 v27, v25, 2, 1
  v_lshlrev_b32 v27, 1, v27
  v_xor_b32 v26, v26, v27
  v_mul_u32_u24 v25, 6144, v25
  v_lshrrev_b32 v27, 2, v26
  v_lshlrev_b32 v27, 11, v27
  v_and_b32 v26, 3, v26
  v_lshl_add_u32 v25, v26, 4, v25
  v_add_u32 v25, v27, v25
  s_lshl_b32 s83, s5, 6
  v_add_u32 v10, s83, v25
  s_branch L_parallel_sum__linear_kernel_hedgehog__glu_gated_reglu__prompt_kernel_v1_thx
L_parallel_sum__linear_kernel_hedgehog__glu_gated_reglu__prompt_kernel_v1_th1:
  s_mov_b32 s12, s50
  s_and_b32 s13, s51, 0xffff
  s_mov_b32 s14, 0x700000
  s_mov_b32 s15, 0x20000
  s_mov_b32 s32, 229376
  s_mov_b32 s29, 0
  s_mov_b32 s76, 25600
  v_add_u32 v24, 192, v1
  v_mul_u32_u24 v25, 4682, v24
  v_lshrrev_b32 v25, 16, v25
  v_mul_u32_u24 v26, 14, v25
  v_sub_u32 v26, v24, v26
  v_mul_u32_u24 v25, 7168, v25
  v_lshl_add_u32 v25, v26, 4, v25
  s_mul_i32 s83, s5, 224
  v_add_u32 v6, s83, v25
  s_mov_b32 s16, s52
  s_and_b32 s17, s53, 0xffff
  s_mov_b32 s18, 0x700000
  s_mov_b32 s19, 0x20000
  s_mov_b32 s33, 229376
  s_mov_b32 s30, 0
  s_mov_b32 s77, 29696
  v_add_u32 v24, 0, v1
  v_mul_u32_u24 v25, 4682, v24
  v_lshrrev_b32 v25, 16, v25
  v_mul_u32_u24 v26, 14, v25
  v_sub_u32 v26, v24, v26
  v_mul_u32_u24 v25, 7168, v25
  v_lshl_add_u32 v25, v26, 4, v25
  s_mul_i32 s83, s5, 224
  v_add_u32 v7, s83, v25
  s_mov_b32 s20, s52
  s_and_b32 s21, s53, 0xffff
  s_mov_b32 s22, 0x700000
  s_mov_b32 s23, 0x20000
  s_mov_b32 s34, 229376
  s_mov_b32 s31, 0
  s_mov_b32 s78, 33792
  v_add_u32 v24, 256, v1
  v_mul_u32_u24 v25, 4682, v24
  v_lshrrev_b32 v25, 16, v25
  v_mul_u32_u24 v26, 14, v25
  v_sub_u32 v26, v24, v26
  v_mul_u32_u24 v25, 7168, v25
  v_lshl_add_u32 v25, v26, 4, v25
  s_mul_i32 s83, s5, 224
  v_add_u32 v8, s83, v25
  s_mov_b32 s64, s42
  s_and_b32 s65, s43, 0xffff
  s_mov_b32 s66, 0x600000
  s_mov_b32 s67, 0x20000
  s_mov_b32 s74, 196608
  s_mov_b32 s72, 0
  s_mov_b32 s79, 17408
  v_add_u32 v24, 64, v1
  v_mul_u32_u24 v25, 5462, v24
  v_lshrrev_b32 v25, 16, v25
  v_mul_u32_u24 v26, 12, v25
  v_sub_u32 v26, v24, v26
  v_bfe_u32 v27, v25, 2, 1
  v_lshlrev_b32 v27, 1, v27
  v_xor_b32 v26, v26, v27
  v_mul_u32_u24 v25, 6144, v25
  v_lshrrev_b32 v27, 2, v26
  v_lshlrev_b32 v27, 11, v27
  v_and_b32 v26, 3, v26
  v_lshl_add_u32 v25, v26, 4, v25
  v_add_u32 v25, v27, v25
  s_lshl_b32 s83, s5, 6
  v_add_u32 v9, s83, v25
  s_mov_b32 s68, s42
  s_and_b32 s69, s43, 0xffff
  s_mov_b32 s70, 0x600000
  s_mov_b32 s71, 0x20000
  s_mov_b32 s75, 196608
  s_mov_b32 s73, 0
  s_mov_b32 s80, 21504
  v_add_u32 v24, 320, v1
  v_mul_u32_u24 v25, 5462, v24
  v_lshrrev_b32 v25, 16, v25
  v_mul_u32_u24 v26, 12, v25
  v_sub_u32 v26, v24, v26
  v_bfe_u32 v27, v25, 2, 1
  v_lshlrev_b32 v27, 1, v27
  v_xor_b32 v26, v26, v27
  v_mul_u32_u24 v25, 6144, v25
  v_lshrrev_b32 v27, 2, v26
  v_lshlrev_b32 v27, 11, v27
  v_and_b32 v26, 3, v26
  v_lshl_add_u32 v25, v26, 4, v25
  v_add_u32 v25, v27, v25
  s_lshl_b32 s83, s5, 6
  v_add_u32 v10, s83, v25
L_parallel_sum__linear_kernel_hedgehog__glu_gated_reglu__prompt_kernel_v1_thx:
  s_mov_b32 s24, s44
  s_and_b32 s25, s45, 0xffff
  s_mov_b32 s26, 0x10000
  s_mov_b32 s27, 0x20000
  s_lshl_b32 s82, s5, 11
  s_add_u32 s82, s82, 1024
  s_mov_b32 m0, 148480
  s_nop 0
  buffer_load_dwordx4 v2, s[24:27], s82 offen lds
  s_add_u32 m0, s76, 0
  s_nop 0
  buffer_load_dwordx4 v6, s[12:15], s29 offen lds
  s_add_u32 s29, s29, s32
  s_add_u32 m0, s77, 0
  s_nop 0
  buffer_load_dwordx4 v7, s[16:19], s30 offen lds
  s_add_u32 s30, s30, s33
  s_add_u32 m0, s78, 0
  s_nop 0
  buffer_load_dwordx4 v8, s[20:23], s31 offen lds
  s_add_u32 s31, s31, s34
  s_add_u32 m0, s79, 0
  s_nop 0
  buffer_load_dwordx4 v9, s[64:67], s72 offen lds
  s_add_u32 s72, s72, s74
  s_add_u32 m0, s80, 0
  s_nop 0
  buffer_load_dwordx4 v10, s[68:71], s73 offen lds
  s_add_u32 s73, s73, s75
  s_add_u32 m0, s76, 36864
  s_nop 0
  buffer_load_dwordx4 v6, s[12:15], s29 offen lds
  s_add_u32 s29, s29, s32
  s_add_u32 m0, s77, 36864
  s_nop 0
  buffer_load_dwordx4 v7, s[16:19], s30 offen lds
  s_add_u32 s30, s30, s33
  s_add_u32 m0, s78, 36864
  s_nop 0
  buffer_load_dwordx4 v8, s[20:23], s31 offen lds
  s_add_u32 s31, s31, s34
  s_add_u32 m0, s79, 36864
  s_nop 0
  buffer_load_dwordx4 v9, s[64:67], s72 offen lds
  s_add_u32 s72, s72, s74
  s_add_u32 m0, s80, 36864
  s_nop 0
  buffer_load_dwordx4 v10, s[68:71], s73 offen lds
  s_add_u32 s73, s73, s75
  s_cmp_eq_u32 s85, 1
  s_cbranch_scc1 L_parallel_sum__linear_kernel_hedgehog__glu_gated_reglu__prompt_kernel_xw2
  s_waitcnt vmcnt(11)
L_parallel_sum__linear_kernel_hedgehog__glu_gated_reglu__prompt_kernel_xw2:
  v_lshlrev_b32 v96, 16, v80
  v_and_b32 v97, 0xffff0000, v80
  v_lshlrev_b32 v98, 16, v81
  v_and_b32 v99, 0xffff0000, v81
  v_lshlrev_b32 v100, 16, v82
  v_and_b32 v101, 0xffff0000, v82
  v_lshlrev_b32 v102, 16, v83
  v_and_b32 v103, 0xffff0000, v83
  v_lshlrev_b32 v104, 16, v84
  v_and_b32 v105, 0xffff0000, v84
  v_lshlrev_b32 v106, 16, v85
  v_and_b32 v107, 0xffff0000, v85
  v_lshlrev_b32 v108, 16, v86
  v_and_b32 v109, 0xffff0000, v86
  v_lshlrev_b32 v110, 16, v87
  v_and_b32 v111, 0xffff0000, v87
  v_lshlrev_b32 v112, 16, v88
  v_and_b32 v113, 0xffff0000, v88
  v_lshlrev_b32 v114, 16, v89
  v_and_b32 v115, 0xffff0000, v89
  v_lshlrev_b32 v116, 16, v90
  v_and_b32 v117, 0xffff0000, v90
  v_lshlrev_b32 v118, 16, v91
  v_and_b32 v119, 0xffff0000, v91
  v_lshlrev_b32 v120, 16, v92
  v_and_b32 v121, 0xffff0000, v92
  v_lshlrev_b32 v122, 16, v93
  v_and_b32 v123, 0xffff0000, v93
  v_lshlrev_b32 v124, 16, v94
  v_and_b32 v125, 0xffff0000, v94
  v_lshlrev_b32 v126, 16, v95
  v_and_b32 v127, 0xffff0000, v95
  v_pk_add_f32 v[128:129], v[96:97], v[98:99]
  v_pk_add_f32 v[128:129], v[128:129], v[100:101]
  v_pk_add_f32 v[128:129], v[128:129], v[102:103]
  v_pk_add_f32 v[128:129], v[128:129], v[104:105]
  v_pk_add_f32 v[128:129], v[128:129], v[106:107]
  v_pk_add_f32 v[128:129], v[128:129], v[108:109]
  v_pk_add_f32 v[128:129], v[128:129], v[110:111]
  v_pk_add_f32 v[128:129], v[128:129], v[112:113]
  v_pk_add_f32 v[128:129], v[128:129], v[114:115]
  v_pk_add_f32 v[128:129], v[128:129], v[116:117]
  v_pk_add_f32 v[128:129], v[128:129], v[118:119]
  v_pk_add_f32 v[128:129], v[128:129], v[120:121]
  v_pk_add_f32 v[128:129], v[128:129], v[122:123]
  v_pk_add_f32 v[128:129], v[128:129], v[124:125]
  v_pk_add_f32 v[128:129], v[128:129], v[126:127]
  v_add_f32 v128, v128, v129
  s_nop 1
  v_add_f32_dpp v128, v128, v128 row_ror:8 row_mask:0xf bank_mask:0xf
  v_mov_b32 v129, v128
  s_nop 1
  v_permlane16_swap_b32 v128, v129
  v_add_f32 v128, v128, v129
  v_mov_b32 v129, v128
  s_nop 1
  v_permlane32_swap_b32 v128, v129
  v_add_f32 v128, v128, v129
  s_lshl_b32 s83, s3, 5
  v_lshl_add_u32 v130, v40, 2, s83
  v_add_u32 v130, 149504, v130
  ds_write_b32 v130, v128
  v_lshlrev_b32 v131, 2, v40
  v_add_u32 v131, 149504, v131
  s_waitcnt lgkmcnt(0)
  s_barrier
  ds_read_b32 v132, v131 offset:0
  ds_read_b32 v133, v131 offset:32
  ds_read_b32 v134, v131 offset:64
  ds_read_b32 v135, v131 offset:96
  s_waitcnt lgkmcnt(0)
  v_add_f32 v132, v132, v133
  v_add_f32 v134, v134, v135
  v_add_f32 v128, v132, v134
  v_mul_f32 v128, 0x3a800000, v128
  v_mov_b32 v129, v128
  v_pk_add_f32 v[136:137], v[96:97], v[128:129] neg_lo:[0,1] neg_hi:[0,1]
  v_pk_mul_f32 v[138:139], v[136:137], v[136:137]
  v_pk_add_f32 v[136:137], v[98:99], v[128:129] neg_lo:[0,1] neg_hi:[0,1]
  v_pk_fma_f32 v[138:139], v[136:137], v[136:137], v[138:139]
  v_pk_add_f32 v[136:137], v[100:101], v[128:129] neg_lo:[0,1] neg_hi:[0,1]
  v_pk_fma_f32 v[138:139], v[136:137], v[136:137], v[138:139]
  v_pk_add_f32 v[136:137], v[102:103], v[128:129] neg_lo:[0,1] neg_hi:[0,1]
  v_pk_fma_f32 v[138:139], v[136:137], v[136:137], v[138:139]
  v_pk_add_f32 v[136:137], v[104:105], v[128:129] neg_lo:[0,1] neg_hi:[0,1]
  v_pk_fma_f32 v[138:139], v[136:137], v[136:137], v[138:139]
  v_pk_add_f32 v[136:137], v[106:107], v[128:129] neg_lo:[0,1] neg_hi:[0,1]
  v_pk_fma_f32 v[138:139], v[136:137], v[136:137], v[138:139]
  v_pk_add_f32 v[136:137], v[108:109], v[128:129] neg_lo:[0,1] neg_hi:[0,1]
  v_pk_fma_f32 v[138:139], v[136:137], v[136:137], v[138:139]
  v_pk_add_f32 v[136:137], v[110:111], v[128:129] neg_lo:[0,1] neg_hi:[0,1]
  v_pk_fma_f32 v[138:139], v[136:137], v[136:137], v[138:139]
  v_pk_add_f32 v[136:137], v[112:113], v[128:129] neg_lo:[0,1] neg_hi:[0,1]
  v_pk_fma_f32 v[138:139], v[136:137], v[136:137], v[138:139]
  v_pk_add_f32 v[136:137], v[114:115], v[128:129] neg_lo:[0,1] neg_hi:[0,1]
  v_pk_fma_f32 v[138:139], v[136:137], v[136:137], v[138:139]
  v_pk_add_f32 v[136:137], v[116:117], v[128:129] neg_lo:[0,1] neg_hi:[0,1]
  v_pk_fma_f32 v[138:139], v[136:137], v[136:137], v[138:139]
  v_pk_add_f32 v[136:137], v[118:119], v[128:129] neg_lo:[0,1] neg_hi:[0,1]
  v_pk_fma_f32 v[138:139], v[136:137], v[136:137], v[138:139]
  v_pk_add_f32 v[136:137], v[120:121], v[128:129] neg_lo:[0,1] neg_hi:[0,1]
  v_pk_fma_f32 v[138:139], v[136:137], v[136:137], v[138:139]
  v_pk_add_f32 v[136:137], v[122:123], v[128:129] neg_lo:[0,1] neg_hi:[0,1]
  v_pk_fma_f32 v[138:139], v[136:137], v[136:137], v[138:139]
  v_pk_add_f32 v[136:137], v[124:125], v[128:129] neg_lo:[0,1] neg_hi:[0,1]
  v_pk_fma_f32 v[138:139], v[136:137], v[136:137], v[138:139]
  v_pk_add_f32 v[136:137], v[126:127], v[128:129] neg_lo:[0,1] neg_hi:[0,1]
  v_pk_fma_f32 v[138:139], v[136:137], v[136:137], v[138:139]
  v_add_f32 v140, v138, v139
  v_cvt_pk_bf16_f32 v141, v128, v128
  v_and_b32 v141, 0xffff0000, v141
  v_add_f32_dpp v140, v140, v140 row_ror:8 row_mask:0xf bank_mask:0xf
  v_mov_b32 v129, v140
  s_nop 1
  v_permlane16_swap_b32 v140, v129
  v_add_f32 v140, v140, v129
  v_mov_b32 v129, v140
  s_nop 1
  v_permlane32_swap_b32 v140, v129
  v_add_f32 v140, v140, v129
  s_lshl_b32 s83, s3, 5
  v_lshl_add_u32 v130, v40, 2, s83
  v_add_u32 v130, 149632, v130
  ds_write_b32 v130, v140
  v_lshlrev_b32 v131, 2, v40
  v_add_u32 v131, 149632, v131
  s_waitcnt lgkmcnt(0)
  s_barrier
  ds_read_b32 v132, v131 offset:0
  ds_read_b32 v133, v131 offset:32
  ds_read_b32 v134, v131 offset:64
  ds_read_b32 v135, v131 offset:96
  s_waitcnt lgkmcnt(0)
  v_add_f32 v132, v132, v133
  v_add_f32 v134, v134, v135
  v_add_f32 v140, v132, v134
  v_mul_f32 v140, 0x3a800000, v140
  v_cvt_pk_bf16_f32 v140, v140, v140
  v_and_b32 v140, 0xffff0000, v140
  v_add_f32 v140, 0x3727c5ac, v140
  v_cvt_pk_bf16_f32 v140, v140, v140
  v_and_b32 v140, 0xffff0000, v140
  v_sqrt_f32 v140, v140
  s_nop 0
  v_cvt_pk_bf16_f32 v140, v140, v140
  v_and_b32 v140, 0xffff0000, v140
  v_rcp_f32 v142, v140
  s_nop 0
  v_fma_f32 v143, -v140, v142, 1.0
  v_fma_f32 v142, v143, v142, v142
  v_mov_b32 v143, v142
  v_mov_b32 v140, v141
  v_pk_add_f32 v[96:97], v[96:97], v[140:141] neg_lo:[0,1] neg_hi:[0,1]
  v_pk_add_f32 v[98:99], v[98:99], v[140:141] neg_lo:[0,1] neg_hi:[0,1]
  v_pk_add_f32 v[100:101], v[100:101], v[140:141] neg_lo:[0,1] neg_hi:[0,1]
  v_pk_add_f32 v[102:103], v[102:103], v[140:141] neg_lo:[0,1] neg_hi:[0,1]
  v_pk_add_f32 v[104:105], v[104:105], v[140:141] neg_lo:[0,1] neg_hi:[0,1]
  v_pk_add_f32 v[106:107], v[106:107], v[140:141] neg_lo:[0,1] neg_hi:[0,1]
  v_pk_add_f32 v[108:109], v[108:109], v[140:141] neg_lo:[0,1] neg_hi:[0,1]
  v_pk_add_f32 v[110:111], v[110:111], v[140:141] neg_lo:[0,1] neg_hi:[0,1]
  v_pk_add_f32 v[112:113], v[112:113], v[140:141] neg_lo:[0,1] neg_hi:[0,1]
  v_pk_add_f32 v[114:115], v[114:115], v[140:141] neg_lo:[0,1] neg_hi:[0,1]
  v_pk_add_f32 v[116:117], v[116:117], v[140:141] neg_lo:[0,1] neg_hi:[0,1]
  v_pk_add_f32 v[118:119], v[118:119], v[140:141] neg_lo:[0,1] neg_hi:[0,1]
  v_pk_add_f32 v[120:121], v[120:121], v[140:141] neg_lo:[0,1] neg_hi:[0,1]
  v_pk_add_f32 v[122:123], v[122:123], v[140:141] neg_lo:[0,1] neg_hi:[0,1]
  v_pk_add_f32 v[124:125], v[124:125], v[140:141] neg_lo:[0,1] neg_hi:[0,1]
  v_pk_add_f32 v[126:127], v[126:127], v[140:141] neg_lo:[0,1] neg_hi:[0,1]
  v_cvt_pk_bf16_f32 v80, v96, v97
  v_cvt_pk_bf16_f32 v81, v98, v99
  v_cvt_pk_bf16_f32 v82, v100, v101
  v_cvt_pk_bf16_f32 v83, v102, v103
  v_cvt_pk_bf16_f32 v84, v104, v105
  v_cvt_pk_bf16_f32 v85, v106, v107
  v_cvt_pk_bf16_f32 v86, v108, v109
  v_cvt_pk_bf16_f32 v87, v110, v111
  v_cvt_pk_bf16_f32 v88, v112, v113
  v_cvt_pk_bf16_f32 v89, v114, v115
  v_cvt_pk_bf16_f32 v90, v116, v117
  v_cvt_pk_bf16_f32 v91, v118, v119
  v_cvt_pk_bf16_f32 v92, v120, v121
  v_cvt_pk_bf16_f32 v93, v122, v123
  v_cvt_pk_bf16_f32 v94, v124, v125
  v_cvt_pk_bf16_f32 v95, v126, v127
  v_lshlrev_b32 v96, 16, v80
  v_and_b32 v97, 0xffff0000, v80
  v_lshlrev_b32 v98, 16, v81
  v_and_b32 v99, 0xffff0000, v81
  v_lshlrev_b32 v100, 16, v82
  v_and_b32 v101, 0xffff0000, v82
  v_lshlrev_b32 v102, 16, v83
  v_and_b32 v103, 0xffff0000, v83
  v_lshlrev_b32 v104, 16, v84
  v_and_b32 v105, 0xffff0000, v84
  v_lshlrev_b32 v106, 16, v85
  v_and_b32 v107, 0xffff0000, v85
  v_lshlrev_b32 v108, 16, v86
  v_and_b32 v109, 0xffff0000, v86
  v_lshlrev_b32 v110, 16, v87
  v_and_b32 v111, 0xffff0000, v87
  v_lshlrev_b32 v112, 16, v88
  v_and_b32 v113, 0xffff0000, v88
  v_lshlrev_b32 v114, 16, v89
  v_and_b32 v115, 0xffff0000, v89
  v_lshlrev_b32 v116, 16, v90
  v_and_b32 v117, 0xffff0000, v90
  v_lshlrev_b32 v118, 16, v91
  v_and_b32 v119, 0xffff0000, v91
  v_lshlrev_b32 v120, 16, v92
  v_and_b32 v121, 0xffff0000, v92
  v_lshlrev_b32 v122, 16, v93
  v_and_b32 v123, 0xffff0000, v93
  v_lshlrev_b32 v124, 16, v94
  v_and_b32 v125, 0xffff0000, v94
  v_lshlrev_b32 v126, 16, v95
  v_and_b32 v127, 0xffff0000, v95
  v_pk_mul_f32 v[96:97], v[96:97], v[142:143]
  v_pk_mul_f32 v[98:99], v[98:99], v[142:143]
  v_pk_mul_f32 v[100:101], v[100:101], v[142:143]
  v_pk_mul_f32 v[102:103], v[102:103], v[142:143]
  v_pk_mul_f32 v[104:105], v[104:105], v[142:143]
  v_pk_mul_f32 v[106:107], v[106:107], v[142:143]
  v_pk_mul_f32 v[108:109], v[108:109], v[142:143]
  v_pk_mul_f32 v[110:111], v[110:111], v[142:143]
  v_pk_mul_f32 v[112:113], v[112:113], v[142:143]
  v_pk_mul_f32 v[114:115], v[114:115], v[142:143]
  v_pk_mul_f32 v[116:117], v[116:117], v[142:143]
  v_pk_mul_f32 v[118:119], v[118:119], v[142:143]
  v_pk_mul_f32 v[120:121], v[120:121], v[142:143]
  v_pk_mul_f32 v[122:123], v[122:123], v[142:143]
  v_pk_mul_f32 v[124:125], v[124:125], v[142:143]
  v_pk_mul_f32 v[126:127], v[126:127], v[142:143]
  s_lshl_b32 s82, s4, 4
  s_lshr_b32 s83, s5, 1
  s_add_u32 s82, s82, s83
  s_lshl_b32 s82, s82, 15
  s_lshl_b32 s83, s3, 13
  s_add_u32 s82, s82, s83
  s_lshl_b32 s83, s7, 7
  s_add_u32 s82, s82, s83
  v_cvt_pk_bf16_f32 v144, v96, v97
  v_cvt_pk_bf16_f32 v145, v98, v99
  v_cvt_pk_bf16_f32 v146, v104, v105
  v_cvt_pk_bf16_f32 v147, v106, v107
  v_cvt_pk_bf16_f32 v148, v100, v101
  v_cvt_pk_bf16_f32 v149, v102, v103
  v_cvt_pk_bf16_f32 v150, v108, v109
  v_cvt_pk_bf16_f32 v151, v110, v111
  buffer_store_dwordx4 v[144:147], v47, s[8:11], s82 offen sc1
  buffer_store_dwordx4 v[148:151], v47, s[8:11], s82 offen offset:256 sc1
  v_cvt_pk_bf16_f32 v152, v112, v113
  v_cvt_pk_bf16_f32 v153, v114, v115
  v_cvt_pk_bf16_f32 v154, v120, v121
  v_cvt_pk_bf16_f32 v155, v122, v123
  v_cvt_pk_bf16_f32 v156, v116, v117
  v_cvt_pk_bf16_f32 v157, v118, v119
  v_cvt_pk_bf16_f32 v158, v124, v125
  v_cvt_pk_bf16_f32 v159, v126, v127
  s_add_u32 s82, s82, 4096
  buffer_store_dwordx4 v[152:155], v47, s[8:11], s82 offen sc1
  buffer_store_dwordx4 v[156:159], v47, s[8:11], s82 offen offset:256 sc1
  s_mov_b32 s24, s58
  s_and_b32 s25, s59, 0xffff
  s_mov_b32 s26, 0x100
  s_mov_b32 s27, 0x20000
  v_mov_b32 v17, 0
  s_lshl_b32 s82, s4, 5
  buffer_load_dword v18, v17, s[24:27], s82 offen sc1
  s_waitcnt vmcnt(0)
  s_barrier
  v_mov_b32 v16, 1
  v_mov_b32 v17, 0
  s_cmp_eq_u32 s3, 0
  s_cbranch_scc0 L_parallel_sum__linear_kernel_hedgehog__glu_gated_reglu__prompt_kernel_v1_ln_np
  s_mov_b64 s[86:87], exec
  s_mov_b64 exec, 1
  v_readfirstlane_b32 s88, v18
  s_nop 3
  s_cmp_ge_u32 s88, 1
  s_cbranch_scc1 L_parallel_sum__linear_kernel_hedgehog__glu_gated_reglu__prompt_kernel_v1_ln_z_ok
  s_mov_b32 s89, 0
L_parallel_sum__linear_kernel_hedgehog__glu_gated_reglu__prompt_kernel_v1_ln_z:
  buffer_load_dword v18, v17, s[24:27], s82 offen sc1
  s_waitcnt vmcnt(0)
  v_readfirstlane_b32 s88, v18
  s_add_u32 s89, s89, 1
  s_nop 2
  s_cmp_ge_u32 s88, 1
  s_cbranch_scc1 L_parallel_sum__linear_kernel_hedgehog__glu_gated_reglu__prompt_kernel_v1_ln_z_ok
  s_cmp_ge_u32 s89, 1048576
  s_cbranch_scc1 L_parallel_sum__linear_kernel_hedgehog__glu_gated_reglu__prompt_kernel_v1_ln_z_ok
  s_sleep 1
  s_branch L_parallel_sum__linear_kernel_hedgehog__glu_gated_reglu__prompt_kernel_v1_ln_z
L_parallel_sum__linear_kernel_hedgehog__glu_gated_reglu__prompt_kernel_v1_ln_z_ok:
  s_add_u32 s24, s60, 0x3000000
  s_addc_u32 s25, s61, 0
  s_and_b32 s25, s25, 0xffff
  s_mov_b32 s26, 0xc400
  s_mov_b32 s27, 0x20000
  s_lshl_b32 s82, s4, 7
  s_add_u32 s82, s82, 49152
  buffer_atomic_add v16, v17, s[24:27], s82 offen sc1
  s_mov_b64 exec, s[86:87]
L_parallel_sum__linear_kernel_hedgehog__glu_gated_reglu__prompt_kernel_v1_ln_np:
  v_mov_b32 v48, 0
  v_mov_b32 v49, 0
  v_mov_b32 v50, 0
  v_mov_b32 v51, 0
  v_mov_b32 v52, 0
  v_mov_b32 v53, 0
  v_mov_b32 v54, 0
  v_mov_b32 v55, 0
  v_mov_b32 v56, 0
  v_mov_b32 v57, 0
  v_mov_b32 v58, 0
  v_mov_b32 v59, 0
  v_mov_b32 v60, 0
  v_mov_b32 v61, 0
  v_mov_b32 v62, 0
  v_mov_b32 v63, 0
  v_mov_b32 v64, 0
  v_mov_b32 v65, 0
  v_mov_b32 v66, 0
  v_mov_b32 v67, 0
  v_mov_b32 v68, 0
  v_mov_b32 v69, 0
  v_mov_b32 v70, 0
  v_mov_b32 v71, 0
  v_mov_b32 v72, 0
  v_mov_b32 v73, 0
  v_mov_b32 v74, 0
  v_mov_b32 v75, 0
  v_mov_b32 v76, 0
  v_mov_b32 v77, 0
  v_mov_b32 v78, 0
  v_mov_b32 v79, 0
  v_mov_b32 v80, 0
  v_mov_b32 v81, 0
  v_mov_b32 v82, 0
  v_mov_b32 v83, 0
  v_mov_b32 v84, 0
  v_mov_b32 v85, 0
  v_mov_b32 v86, 0
  v_mov_b32 v87, 0
  v_mov_b32 v88, 0
  v_mov_b32 v89, 0
  v_mov_b32 v90, 0
  v_mov_b32 v91, 0
  v_mov_b32 v92, 0
  v_mov_b32 v93, 0
  v_mov_b32 v94, 0
  v_mov_b32 v95, 0
  v_mov_b32 v96, 0
  v_mov_b32 v97, 0
  v_mov_b32 v98, 0
  v_mov_b32 v99, 0
  v_mov_b32 v100, 0
  v_mov_b32 v101, 0
  v_mov_b32 v102, 0
  v_mov_b32 v103, 0
  v_mov_b32 v104, 0
  v_mov_b32 v105, 0
  v_mov_b32 v106, 0
  v_mov_b32 v107, 0
  v_mov_b32 v108, 0
  v_mov_b32 v109, 0
  v_mov_b32 v110, 0
  v_mov_b32 v111, 0
  v_mov_b32 v112, 0
  v_mov_b32 v113, 0
  v_mov_b32 v114, 0
  v_mov_b32 v115, 0
  v_mov_b32 v116, 0
  v_mov_b32 v117, 0
  v_mov_b32 v118, 0
  v_mov_b32 v119, 0
  v_mov_b32 v120, 0
  v_mov_b32 v121, 0
  v_mov_b32 v122, 0
  v_mov_b32 v123, 0
  v_mov_b32 v124, 0
  v_mov_b32 v125, 0
  v_mov_b32 v126, 0
  v_mov_b32 v127, 0
  v_mov_b32 v128, 0
  v_mov_b32 v129, 0
  v_mov_b32 v130, 0
  v_mov_b32 v131, 0
  v_mov_b32 v132, 0
  v_mov_b32 v133, 0
  v_mov_b32 v134, 0
  v_mov_b32 v135, 0
  v_mov_b32 v136, 0
  v_mov_b32 v137, 0
  v_mov_b32 v138, 0
  v_mov_b32 v139, 0
  v_mov_b32 v140, 0
  v_mov_b32 v141, 0
  v_mov_b32 v142, 0
  v_mov_b32 v143, 0
  v_mov_b32 v144, 0
  v_mov_b32 v145, 0
  v_mov_b32 v146, 0
  v_mov_b32 v147, 0
  v_mov_b32 v148, 0
  v_mov_b32 v149, 0
  v_mov_b32 v150, 0
  v_mov_b32 v151, 0
  v_mov_b32 v152, 0
  v_mov_b32 v153, 0
  v_mov_b32 v154, 0
  v_mov_b32 v155, 0
  v_mov_b32 v156, 0
  v_mov_b32 v157, 0
  v_mov_b32 v158, 0
  v_mov_b32 v159, 0
  v_mov_b32 v160, 0
  v_mov_b32 v161, 0
  v_mov_b32 v162, 0
  v_mov_b32 v163, 0
  v_mov_b32 v164, 0
  v_mov_b32 v165, 0
  v_mov_b32 v166, 0
  v_mov_b32 v167, 0
  v_mov_b32 v168, 0
  v_mov_b32 v169, 0
  v_mov_b32 v170, 0
  v_mov_b32 v171, 0
  v_mov_b32 v172, 0
  v_mov_b32 v173, 0
  v_mov_b32 v174, 0
  v_mov_b32 v175, 0
  v_mov_b32 v176, 0
  v_mov_b32 v177, 0
  v_mov_b32 v178, 0
  v_mov_b32 v179, 0
  v_mov_b32 v180, 0
  v_mov_b32 v181, 0
  v_mov_b32 v182, 0
  v_mov_b32 v183, 0
  v_mov_b32 v184, 0
  v_mov_b32 v185, 0
  v_mov_b32 v186, 0
  v_mov_b32 v187, 0
  v_mov_b32 v188, 0
  v_mov_b32 v189, 0
  v_mov_b32 v190, 0
  v_mov_b32 v191, 0
  v_mov_b32 v192, 0
  v_mov_b32 v193, 0
  v_mov_b32 v194, 0
  v_mov_b32 v195, 0
  v_mov_b32 v196, 0
  v_mov_b32 v197, 0
  v_mov_b32 v198, 0
  v_mov_b32 v199, 0
  v_mov_b32 v200, 0
  v_mov_b32 v201, 0
  v_mov_b32 v202, 0
  v_mov_b32 v203, 0
  v_mov_b32 v204, 0
  v_mov_b32 v205, 0
  v_mov_b32 v206, 0
  v_mov_b32 v207, 0
  v_mov_b32 v208, 0
  v_mov_b32 v209, 0
  v_mov_b32 v210, 0
  v_mov_b32 v211, 0
  v_mov_b32 v212, 0
  v_mov_b32 v213, 0
  v_mov_b32 v214, 0
  v_mov_b32 v215, 0
  v_mov_b32 v216, 0
  v_mov_b32 v217, 0
  v_mov_b32 v218, 0
  v_mov_b32 v219, 0
  v_mov_b32 v220, 0
  v_mov_b32 v221, 0
  v_mov_b32 v222, 0
  v_mov_b32 v223, 0
  v_mov_b32 v224, 0
  v_mov_b32 v225, 0
  v_mov_b32 v226, 0
  v_mov_b32 v227, 0
  v_mov_b32 v228, 0
  v_mov_b32 v229, 0
  v_mov_b32 v230, 0
  v_mov_b32 v231, 0
  v_mov_b32 v232, 0
  v_mov_b32 v233, 0
  v_mov_b32 v234, 0
  v_mov_b32 v235, 0
  v_mov_b32 v236, 0
  v_mov_b32 v237, 0
  v_mov_b32 v238, 0
  v_mov_b32 v239, 0
  v_mov_b32 v240, 0
  v_mov_b32 v241, 0
  v_mov_b32 v242, 0
  v_mov_b32 v243, 0
  v_mov_b32 v244, 0
  v_mov_b32 v245, 0
  v_mov_b32 v246, 0
  v_mov_b32 v247, 0
  v_mov_b32 v248, 0
  v_mov_b32 v249, 0
  v_mov_b32 v250, 0
  v_mov_b32 v251, 0
  v_mov_b32 v252, 0
  v_mov_b32 v253, 0
  v_mov_b32 v254, 0
  v_mov_b32 v255, 0
  v_accvgpr_write_b32 a0, 0
  v_accvgpr_write_b32 a1, 0
  v_accvgpr_write_b32 a2, 0
  v_accvgpr_write_b32 a3, 0
  v_accvgpr_write_b32 a4, 0
  v_accvgpr_write_b32 a5, 0
  v_accvgpr_write_b32 a6, 0
  v_accvgpr_write_b32 a7, 0
  v_accvgpr_write_b32 a8, 0
  v_accvgpr_write_b32 a9, 0
  v_accvgpr_write_b32 a10, 0
  v_accvgpr_write_b32 a11, 0
  v_accvgpr_write_b32 a12, 0
  v_accvgpr_write_b32 a13, 0
  v_accvgpr_write_b32 a14, 0
  v_accvgpr_write_b32 a15, 0
  v_accvgpr_write_b32 a16, 0
  v_accvgpr_write_b32 a17, 0
  v_accvgpr_write_b32 a18, 0
  v_accvgpr_write_b32 a19, 0
  v_accvgpr_write_b32 a20, 0
  v_accvgpr_write_b32 a21, 0
  v_accvgpr_write_b32 a22, 0
  v_accvgpr_write_b32 a23, 0
  v_accvgpr_write_b32 a24, 0
  v_accvgpr_write_b32 a25, 0
  v_accvgpr_write_b32 a26, 0
  v_accvgpr_write_b32 a27, 0
  v_accvgpr_write_b32 a28, 0
  v_accvgpr_write_b32 a29, 0
  v_accvgpr_write_b32 a30, 0
  v_accvgpr_write_b32 a31, 0
  v_accvgpr_write_b32 a32, 0
  v_accvgpr_write_b32 a33, 0
  v_accvgpr_write_b32 a34, 0
  v_accvgpr_write_b32 a35, 0
  v_accvgpr_write_b32 a36, 0
  v_accvgpr_write_b32 a37, 0
  v_accvgpr_write_b32 a38, 0
  v_accvgpr_write_b32 a39, 0
  v_accvgpr_write_b32 a40, 0
  v_accvgpr_write_b32 a41, 0
  v_accvgpr_write_b32 a42, 0
  v_accvgpr_write_b32 a43, 0
  v_accvgpr_write_b32 a44, 0
  v_accvgpr_write_b32 a45, 0
  v_accvgpr_write_b32 a46, 0
  v_accvgpr_write_b32 a47, 0
  v_accvgpr_write_b32 a48, 0
  v_accvgpr_write_b32 a49, 0
  v_accvgpr_write_b32 a50, 0
  v_accvgpr_write_b32 a51, 0
  v_accvgpr_write_b32 a52, 0
  v_accvgpr_write_b32 a53, 0
  v_accvgpr_write_b32 a54, 0
  v_accvgpr_write_b32 a55, 0
  v_accvgpr_write_b32 a56, 0
  v_accvgpr_write_b32 a57, 0
  v_accvgpr_write_b32 a58, 0
  v_accvgpr_write_b32 a59, 0
  v_accvgpr_write_b32 a60, 0
  v_accvgpr_write_b32 a61, 0
  v_accvgpr_write_b32 a62, 0
  v_accvgpr_write_b32 a63, 0
  v_accvgpr_write_b32 a64, 0
  v_accvgpr_write_b32 a65, 0
  v_accvgpr_write_b32 a66, 0
  v_accvgpr_write_b32 a67, 0
  v_accvgpr_write_b32 a68, 0
  v_accvgpr_write_b32 a69, 0
  v_accvgpr_write_b32 a70, 0
  v_accvgpr_write_b32 a71, 0
  v_accvgpr_write_b32 a72, 0
  v_accvgpr_write_b32 a73, 0
  v_accvgpr_write_b32 a74, 0
  v_accvgpr_write_b32 a75, 0
  v_accvgpr_write_b32 a76, 0
  v_accvgpr_write_b32 a77, 0
  v_accvgpr_write_b32 a78, 0
  v_accvgpr_write_b32 a79, 0
  v_accvgpr_write_b32 a80, 0
  v_accvgpr_write_b32 a81, 0
  v_accvgpr_write_b32 a82, 0
  v_accvgpr_write_b32 a83, 0
  v_accvgpr_write_b32 a84, 0
  v_accvgpr_write_b32 a85, 0
  v_accvgpr_write_b32 a86, 0
  v_accvgpr_write_b32 a87, 0
  v_accvgpr_write_b32 a88, 0
  v_accvgpr_write_b32 a89, 0
  v_accvgpr_write_b32 a90, 0
  v_accvgpr_write_b32 a91, 0
  v_accvgpr_write_b32 a92, 0
  v_accvgpr_write_b32 a93, 0
  v_accvgpr_write_b32 a94, 0
  v_accvgpr_write_b32 a95, 0
  v_accvgpr_write_b32 a96, 0
  v_accvgpr_write_b32 a97, 0
  v_accvgpr_write_b32 a98, 0
  v_accvgpr_write_b32 a99, 0
  v_accvgpr_write_b32 a100, 0
  v_accvgpr_write_b32 a101, 0
  v_accvgpr_write_b32 a102, 0
  v_accvgpr_write_b32 a103, 0
  v_accvgpr_write_b32 a104, 0
  v_accvgpr_write_b32 a105, 0
  v_accvgpr_write_b32 a106, 0
  v_accvgpr_write_b32 a107, 0
  v_accvgpr_write_b32 a108, 0
  v_accvgpr_write_b32 a109, 0
  v_accvgpr_write_b32 a110, 0
  v_accvgpr_write_b32 a111, 0
  s_cmp_eq_u32 s3, 0
  s_cbranch_scc0 L_parallel_sum__linear_kernel_hedgehog__glu_gated_reglu__prompt_kernel_v1_ln_np1
  s_mov_b64 exec, 1
  s_mov_b32 s89, 0
L_parallel_sum__linear_kernel_hedgehog__glu_gated_reglu__prompt_kernel_v1_ln:
  buffer_load_dword v18, v17, s[24:27], s82 offen sc1
  s_waitcnt vmcnt(0)
  v_readfirstlane_b32 s88, v18
  s_add_u32 s89, s89, 1
  s_nop 2
  s_cmp_ge_u32 s88, 32
  s_cbranch_scc1 L_parallel_sum__linear_kernel_hedgehog__glu_gated_reglu__prompt_kernel_v1_ln_ok
  s_cmp_ge_u32 s89, 1048576
  s_cbranch_scc1 L_parallel_sum__linear_kernel_hedgehog__glu_gated_reglu__prompt_kernel_v1_ln_ok
  s_sleep 1
  s_branch L_parallel_sum__linear_kernel_hedgehog__glu_gated_reglu__prompt_kernel_v1_ln
L_parallel_sum__linear_kernel_hedgehog__glu_gated_reglu__prompt_kernel_v1_ln_ok:
  s_mov_b64 exec, s[86:87]
L_parallel_sum__linear_kernel_hedgehog__glu_gated_reglu__prompt_kernel_v1_ln_np1:
  s_barrier
  s_add_u32 m0, s81, 0
  s_nop 0
  buffer_load_dwordx4 v2, s[8:11], s28 offen sc1 lds
  s_add_u32 m0, s81, 1024
  s_nop 0
  buffer_load_dwordx4 v3, s[8:11], s28 offen sc1 lds
  s_add_u32 m0, s81, 2048
  s_nop 0
  buffer_load_dwordx4 v4, s[8:11], s28 offen sc1 lds
  s_add_u32 m0, s81, 3072
  s_nop 0
  buffer_load_dwordx4 v5, s[8:11], s28 offen sc1 lds
  s_add_u32 s28, s28, 1024
  s_add_u32 m0, s81, 36864
  s_nop 0
  buffer_load_dwordx4 v2, s[8:11], s28 offen sc1 lds
  s_add_u32 m0, s81, 37888
  s_nop 0
  buffer_load_dwordx4 v3, s[8:11], s28 offen sc1 lds
  s_add_u32 m0, s81, 38912
  s_nop 0
  buffer_load_dwordx4 v4, s[8:11], s28 offen sc1 lds
  s_add_u32 m0, s81, 39936
  s_nop 0
  buffer_load_dwordx4 v5, s[8:11], s28 offen sc1 lds
  s_add_u32 s28, s28, 1024
  s_add_u32 m0, s81, 73728
  s_nop 0
  buffer_load_dwordx4 v2, s[8:11], s28 offen sc1 lds
  s_add_u32 m0, s81, 74752
  s_nop 0
  buffer_load_dwordx4 v3, s[8:11], s28 offen sc1 lds
  s_add_u32 m0, s81, 75776
  s_nop 0
  buffer_load_dwordx4 v4, s[8:11], s28 offen sc1 lds
  s_add_u32 m0, s81, 76800
  s_nop 0
  buffer_load_dwordx4 v5, s[8:11], s28 offen sc1 lds
  s_add_u32 s28, s28, 1024
  s_add_u32 m0, s76, 73728
  s_nop 0
  buffer_load_dwordx4 v6, s[12:15], s29 offen lds
  s_add_u32 s29, s29, s32
  s_add_u32 m0, s77, 73728
  s_nop 0
  buffer_load_dwordx4 v7, s[16:19], s30 offen lds
  s_add_u32 s30, s30, s33
  s_add_u32 m0, s78, 73728
  s_nop 0
  buffer_load_dwordx4 v8, s[20:23], s31 offen lds
  s_add_u32 s31, s31, s34
  s_add_u32 m0, s79, 73728
  s_nop 0
  buffer_load_dwordx4 v9, s[64:67], s72 offen lds
  s_add_u32 s72, s72, s74
  s_add_u32 m0, s80, 73728
  s_nop 0
  buffer_load_dwordx4 v10, s[68:71], s73 offen lds
  s_add_u32 s73, s73, s75
  s_add_u32 m0, s81, 110592
  s_nop 0
  buffer_load_dwordx4 v2, s[8:11], s28 offen sc1 lds
  s_add_u32 m0, s81, 111616
  s_nop 0
  buffer_load_dwordx4 v3, s[8:11], s28 offen sc1 lds
  s_add_u32 m0, s81, 112640
  s_nop 0
  buffer_load_dwordx4 v4, s[8:11], s28 offen sc1 lds
  s_add_u32 m0, s81, 113664
  s_nop 0
  buffer_load_dwordx4 v5, s[8:11], s28 offen sc1 lds
  s_add_u32 s28, s28, 1024
  s_add_u32 m0, s76, 110592
  s_nop 0
  buffer_load_dwordx4 v6, s[12:15], s29 offen lds
  s_add_u32 s29, s29, s32
  s_add_u32 m0, s77, 110592
  s_nop 0
  buffer_load_dwordx4 v7, s[16:19], s30 offen lds
  s_add_u32 s30, s30, s33
  s_add_u32 m0, s78, 110592
  s_nop 0
  buffer_load_dwordx4 v8, s[20:23], s31 offen lds
  s_add_u32 s31, s31, s34
  s_add_u32 m0, s79, 110592
  s_nop 0
  buffer_load_dwordx4 v9, s[64:67], s72 offen lds
  s_add_u32 s72, s72, s74
  s_add_u32 m0, s80, 110592
  s_nop 0
  buffer_load_dwordx4 v10, s[68:71], s73 offen lds
  s_add_u32 s73, s73, s75
  s_mov_b32 s36, 0
  s_mov_b32 s39, 0
  s_mov_b32 s62, 36864
  s_mov_b32 s63, 0xfffe5000
  s_waitcnt vmcnt(22)
  s_barrier
  ds_read_b64_tr_b16 a[176:177], v14 offset:0
  ds_read_b64_tr_b16 a[178:179], v14 offset:3072
  ds_read_b128 a[112:115], v11 offset:0
  ds_read_b128 a[116:119], v11 offset:1024
  ds_read_b128 a[120:123], v11 offset:2048
  ds_read_b128 a[124:127], v11 offset:3072
  ds_read_b128 a[128:131], v11 offset:4096
  ds_read_b128 a[132:135], v11 offset:5120
  ds_read_b128 a[136:139], v11 offset:6144
  ds_read_b128 a[140:143], v11 offset:7168
  ds_read_b64_tr_b16 a[180:181], v15 offset:0
  ds_read_b64_tr_b16 a[182:183], v15 offset:3072
  ds_read_b64_tr_b16 a[184:185], v12 offset:64
  ds_read_b64_tr_b16 a[186:187], v12 offset:3648
  ds_read_b64_tr_b16 a[188:189], v12 offset:7232
  ds_read_b64_tr_b16 a[190:191], v12 offset:10816
  ds_read_b64_tr_b16 a[192:193], v12 offset:96
  ds_read_b64_tr_b16 a[194:195], v12 offset:3680
  ds_read_b64_tr_b16 a[196:197], v12 offset:7264
  ds_read_b64_tr_b16 a[198:199], v12 offset:10848
  ds_read_b64_tr_b16 a[200:201], v12 offset:128
  ds_read_b64_tr_b16 a[202:203], v12 offset:3712
  ds_read_b64_tr_b16 a[204:205], v12 offset:7296
  ds_read_b64_tr_b16 a[206:207], v12 offset:10880
  ds_read_b64_tr_b16 a[208:209], v12 offset:160
  ds_read_b64_tr_b16 a[210:211], v12 offset:3744
  ds_read_b64_tr_b16 a[212:213], v12 offset:7328
  ds_read_b64_tr_b16 a[214:215], v12 offset:10912
  s_add_u32 s39, s39, 36864
  s_cmp_eq_u32 s39, 147456
  s_cselect_b32 s39, 0, s39
  s_cselect_b32 s37, s63, s62
  v_add_u32 v11, s37, v11
  v_add_u32 v12, s37, v12
  v_add_u32 v14, s37, v14
  v_add_u32 v15, s37, v15
  s_mov_b32 s38, 16
.p2align 6
L_parallel_sum__linear_kernel_hedgehog__glu_gated_reglu__prompt_kernel_loop1:
  s_cmp_le_u32 s38, 2
  s_cselect_b32 s28, 0x7f000000, s28
  s_cmp_eq_u32 s38, 2
  s_cbranch_scc0 L_parallel_sum__linear_kernel_hedgehog__glu_gated_reglu__prompt_kernel_c21
  s_cmp_eq_u32 s3, 3
  s_cbranch_scc0 L_parallel_sum__linear_kernel_hedgehog__glu_gated_reglu__prompt_kernel_cq1
  s_getpc_b64 s[86:87]
L_parallel_sum__linear_kernel_hedgehog__glu_gated_reglu__prompt_kernel_cq1_pc:
  s_sub_u32 s86, s86, L_parallel_sum__linear_kernel_hedgehog__glu_gated_reglu__prompt_kernel_cq1_pc - parallel_sum__linear_kernel_hedgehog__glu_gated_reglu__prompt_kernel
  s_subb_u32 s87, s87, 0
  s_lshr_b32 s88, s2, 3
  s_mul_i32 s88, s88, 24*128
  v_lshlrev_b32 v42, 7, v1
  v_add_u32 v42, s88, v42
  v_cmp_gt_u32 vcc, 24, v1
  s_nop 3
  s_and_saveexec_b64 s[88:89], vcc
  v_cmp_gt_u32 vcc, L_parallel_sum__linear_kernel_hedgehog__glu_gated_reglu__prompt_kernel_done - parallel_sum__linear_kernel_hedgehog__glu_gated_reglu__prompt_kernel, v42
  s_nop 3
  s_and_b64 exec, exec, vcc
  s_cbranch_execz L_parallel_sum__linear_kernel_hedgehog__glu_gated_reglu__prompt_kernel_cq1_x
  global_load_dword v43, v42, s[86:87]
L_parallel_sum__linear_kernel_hedgehog__glu_gated_reglu__prompt_kernel_cq1_x:
  s_mov_b64 exec, s[88:89]
L_parallel_sum__linear_kernel_hedgehog__glu_gated_reglu__prompt_kernel_cq1:
L_parallel_sum__linear_kernel_hedgehog__glu_gated_reglu__prompt_kernel_c21:
  s_lshr_b32 s49, s2, 5
  s_sub_u32 s49, 14, s49
  s_cmp_eq_u32 s38, s49
  s_cbranch_scc0 L_parallel_sum__linear_kernel_hedgehog__glu_gated_reglu__prompt_kernel_pf1
  s_mov_b32 s24, s54
  s_and_b32 s25, s55, 0xffff
  s_mov_b32 s26, 0x700000
  s_mov_b32 s27, 0x20000
  v_lshlrev_b32 v46, 7, v1
  v_and_b32 v47, 15, v1
  v_lshlrev_b32 v47, 7, v47
  s_lshl_b32 s90, s2, 2
  s_add_u32 s90, s90, s3
  s_mul_i32 s88, s90, 7168
  s_lshl_b32 s89, s90, 11
  buffer_load_dword v44, v46, s[24:27], s88 offen
  s_mov_b32 s24, s46
  s_and_b32 s25, s47, 0xffff
  s_mov_b32 s26, 0x200000
  s_mov_b32 s27, 0x20000
  buffer_load_dword v45, v47, s[24:27], s89 offen
L_parallel_sum__linear_kernel_hedgehog__glu_gated_reglu__prompt_kernel_pf1:
  s_waitcnt vmcnt(18) lgkmcnt(0)
  s_barrier
  v_mfma_f32_16x16x32_bf16 v[48:51], a[176:179], a[112:115], v[48:51]
  s_add_u32 m0, s36, s81
  v_mfma_f32_16x16x32_bf16 v[52:55], a[176:179], a[116:119], v[52:55]
  ds_read_b64_tr_b16 a[216:217], v14 offset:0
  v_mfma_f32_16x16x32_bf16 v[56:59], a[176:179], a[120:123], v[56:59]
  ds_read_b64_tr_b16 a[218:219], v14 offset:3072
  v_mfma_f32_16x16x32_bf16 v[60:63], a[176:179], a[124:127], v[60:63]
  buffer_load_dwordx4 v2, s[8:11], s28 offen sc1 lds
  v_mfma_f32_16x16x32_bf16 v[64:67], a[176:179], a[128:131], v[64:67]
  ds_read_b128 a[144:147], v11 offset:0
  v_mfma_f32_16x16x32_bf16 v[68:71], a[176:179], a[132:135], v[68:71]
  s_add_u32 m0, m0, 1024
  v_mfma_f32_16x16x32_bf16 v[72:75], a[176:179], a[136:139], v[72:75]
  ds_read_b128 a[148:151], v11 offset:1024
  v_mfma_f32_16x16x32_bf16 v[76:79], a[176:179], a[140:143], v[76:79]
  v_mfma_f32_16x16x32_bf16 v[108:111], a[180:183], a[140:143], v[108:111]
  buffer_load_dwordx4 v3, s[8:11], s28 offen sc1 lds
  v_mfma_f32_16x16x32_bf16 v[104:107], a[180:183], a[136:139], v[104:107]
  ds_read_b128 a[152:155], v11 offset:2048
  v_mfma_f32_16x16x32_bf16 v[100:103], a[180:183], a[132:135], v[100:103]
  ds_read_b128 a[156:159], v11 offset:3072
  v_mfma_f32_16x16x32_bf16 v[96:99], a[180:183], a[128:131], v[96:99]
  s_add_u32 m0, m0, 1024
  v_mfma_f32_16x16x32_bf16 v[92:95], a[180:183], a[124:127], v[92:95]
  ds_read_b128 a[160:163], v11 offset:4096
  v_mfma_f32_16x16x32_bf16 v[88:91], a[180:183], a[120:123], v[88:91]
  buffer_load_dwordx4 v4, s[8:11], s28 offen sc1 lds
  v_mfma_f32_16x16x32_bf16 v[84:87], a[180:183], a[116:119], v[84:87]
  ds_read_b128 a[164:167], v11 offset:5120
  v_mfma_f32_16x16x32_bf16 v[80:83], a[180:183], a[112:115], v[80:83]
  v_mfma_f32_16x16x32_bf16 v[112:115], a[184:187], a[112:115], v[112:115]
  s_add_u32 m0, m0, 1024
  v_mfma_f32_16x16x32_bf16 v[116:119], a[184:187], a[116:119], v[116:119]
  ds_read_b128 a[168:171], v11 offset:6144
  v_mfma_f32_16x16x32_bf16 v[120:123], a[184:187], a[120:123], v[120:123]
  ds_read_b128 a[172:175], v11 offset:7168
  v_mfma_f32_16x16x32_bf16 v[124:127], a[184:187], a[124:127], v[124:127]
  buffer_load_dwordx4 v5, s[8:11], s28 offen sc1 lds
  v_mfma_f32_16x16x32_bf16 v[128:131], a[184:187], a[128:131], v[128:131]
  ds_read_b64_tr_b16 a[220:221], v15 offset:0
  v_mfma_f32_16x16x32_bf16 v[132:135], a[184:187], a[132:135], v[132:135]
  s_add_u32 s28, s28, 1024
  v_mfma_f32_16x16x32_bf16 v[136:139], a[184:187], a[136:139], v[136:139]
  ds_read_b64_tr_b16 a[222:223], v15 offset:3072
  v_mfma_f32_16x16x32_bf16 v[140:143], a[184:187], a[140:143], v[140:143]
  v_mfma_f32_16x16x32_bf16 v[172:175], a[188:191], a[140:143], v[172:175]
  s_add_u32 m0, s36, s76
  v_mfma_f32_16x16x32_bf16 v[168:171], a[188:191], a[136:139], v[168:171]
  ds_read_b64_tr_b16 a[224:225], v12 offset:64
  v_mfma_f32_16x16x32_bf16 v[164:167], a[188:191], a[132:135], v[164:167]
  ds_read_b64_tr_b16 a[226:227], v12 offset:3648
  v_mfma_f32_16x16x32_bf16 v[160:163], a[188:191], a[128:131], v[160:163]
  buffer_load_dwordx4 v6, s[12:15], s29 offen lds
  v_mfma_f32_16x16x32_bf16 v[156:159], a[188:191], a[124:127], v[156:159]
  ds_read_b64_tr_b16 a[228:229], v12 offset:7232
  v_mfma_f32_16x16x32_bf16 v[152:155], a[188:191], a[120:123], v[152:155]
  s_add_u32 s29, s29, s32
  v_mfma_f32_16x16x32_bf16 v[148:151], a[188:191], a[116:119], v[148:151]
  ds_read_b64_tr_b16 a[230:231], v12 offset:10816
  v_mfma_f32_16x16x32_bf16 v[144:147], a[188:191], a[112:115], v[144:147]
  v_mfma_f32_16x16x32_bf16 v[176:179], a[192:195], a[112:115], v[176:179]
  s_add_u32 m0, s36, s77
  v_mfma_f32_16x16x32_bf16 v[180:183], a[192:195], a[116:119], v[180:183]
  ds_read_b64_tr_b16 a[232:233], v12 offset:96
  v_mfma_f32_16x16x32_bf16 v[184:187], a[192:195], a[120:123], v[184:187]
  ds_read_b64_tr_b16 a[234:235], v12 offset:3680
  v_mfma_f32_16x16x32_bf16 v[188:191], a[192:195], a[124:127], v[188:191]
  buffer_load_dwordx4 v7, s[16:19], s30 offen lds
  v_mfma_f32_16x16x32_bf16 v[192:195], a[192:195], a[128:131], v[192:195]
  ds_read_b64_tr_b16 a[236:237], v12 offset:7264
  v_mfma_f32_16x16x32_bf16 v[196:199], a[192:195], a[132:135], v[196:199]
  s_add_u32 s30, s30, s33
  v_mfma_f32_16x16x32_bf16 v[200:203], a[192:195], a[136:139], v[200:203]
  ds_read_b64_tr_b16 a[238:239], v12 offset:10848
  v_mfma_f32_16x16x32_bf16 v[204:207], a[192:195], a[140:143], v[204:207]
  v_mfma_f32_16x16x32_bf16 v[236:239], a[196:199], a[140:143], v[236:239]
  s_add_u32 m0, s36, s78
  v_mfma_f32_16x16x32_bf16 v[232:235], a[196:199], a[136:139], v[232:235]
  ds_read_b64_tr_b16 a[240:241], v12 offset:128
  v_mfma_f32_16x16x32_bf16 v[228:231], a[196:199], a[132:135], v[228:231]
  ds_read_b64_tr_b16 a[242:243], v12 offset:3712
  v_mfma_f32_16x16x32_bf16 v[224:227], a[196:199], a[128:131], v[224:227]
  buffer_load_dwordx4 v8, s[20:23], s31 offen lds
  v_mfma_f32_16x16x32_bf16 v[220:223], a[196:199], a[124:127], v[220:223]
  ds_read_b64_tr_b16 a[244:245], v12 offset:7296
  v_mfma_f32_16x16x32_bf16 v[216:219], a[196:199], a[120:123], v[216:219]
  s_add_u32 s31, s31, s34
  v_mfma_f32_16x16x32_bf16 v[212:215], a[196:199], a[116:119], v[212:215]
  ds_read_b64_tr_b16 a[246:247], v12 offset:10880
  v_mfma_f32_16x16x32_bf16 v[208:211], a[196:199], a[112:115], v[208:211]
  v_mfma_f32_16x16x32_bf16 v[240:243], a[200:203], a[112:115], v[240:243]
  s_add_u32 m0, s36, s79
  v_mfma_f32_16x16x32_bf16 v[244:247], a[200:203], a[116:119], v[244:247]
  ds_read_b64_tr_b16 a[248:249], v12 offset:160
  v_mfma_f32_16x16x32_bf16 v[248:251], a[200:203], a[120:123], v[248:251]
  ds_read_b64_tr_b16 a[250:251], v12 offset:3744
  v_mfma_f32_16x16x32_bf16 v[252:255], a[200:203], a[124:127], v[252:255]
  buffer_load_dwordx4 v9, s[64:67], s72 offen lds
  v_mfma_f32_16x16x32_bf16 a[0:3], a[200:203], a[128:131], a[0:3]
  ds_read_b64_tr_b16 a[252:253], v12 offset:7328
  v_mfma_f32_16x16x32_bf16 a[4:7], a[200:203], a[132:135], a[4:7]
  s_add_u32 s72, s72, s74
  v_mfma_f32_16x16x32_bf16 a[8:11], a[200:203], a[136:139], a[8:11]
  ds_read_b64_tr_b16 a[254:255], v12 offset:10912
  v_mfma_f32_16x16x32_bf16 a[12:15], a[200:203], a[140:143], a[12:15]
  v_mfma_f32_16x16x32_bf16 a[44:47], a[204:207], a[140:143], a[44:47]
  s_add_u32 m0, s36, s80
  v_mfma_f32_16x16x32_bf16 a[40:43], a[204:207], a[136:139], a[40:43]
  s_add_u32 s39, s39, 36864
  v_mfma_f32_16x16x32_bf16 a[36:39], a[204:207], a[132:135], a[36:39]
  s_cmp_eq_u32 s39, 147456
  v_mfma_f32_16x16x32_bf16 a[32:35], a[204:207], a[128:131], a[32:35]
  s_cselect_b32 s39, 0, s39
  v_mfma_f32_16x16x32_bf16 a[28:31], a[204:207], a[124:127], a[28:31]
  s_cselect_b32 s37, s63, s62
  v_mfma_f32_16x16x32_bf16 a[24:27], a[204:207], a[120:123], a[24:27]
  v_add_u32 v11, s37, v11
  v_mfma_f32_16x16x32_bf16 a[20:23], a[204:207], a[116:119], a[20:23]
  buffer_load_dwordx4 v10, s[68:71], s73 offen lds
  v_mfma_f32_16x16x32_bf16 a[16:19], a[204:207], a[112:115], a[16:19]
  v_mfma_f32_16x16x32_bf16 a[48:51], a[208:211], a[112:115], a[48:51]
  v_add_u32 v12, s37, v12
  v_mfma_f32_16x16x32_bf16 a[52:55], a[208:211], a[116:119], a[52:55]
  s_add_u32 s73, s73, s75
  v_mfma_f32_16x16x32_bf16 a[56:59], a[208:211], a[120:123], a[56:59]
  v_add_u32 v14, s37, v14
  v_mfma_f32_16x16x32_bf16 a[60:63], a[208:211], a[124:127], a[60:63]
  s_add_u32 s36, s36, 36864
  v_mfma_f32_16x16x32_bf16 a[64:67], a[208:211], a[128:131], a[64:67]
  s_cmp_eq_u32 s36, 147456
  v_mfma_f32_16x16x32_bf16 a[68:71], a[208:211], a[132:135], a[68:71]
  s_cselect_b32 s36, 0, s36
  v_mfma_f32_16x16x32_bf16 a[72:75], a[208:211], a[136:139], a[72:75]
  v_add_u32 v15, s37, v15
  v_mfma_f32_16x16x32_bf16 a[76:79], a[208:211], a[140:143], a[76:79]
  v_mfma_f32_16x16x32_bf16 a[108:111], a[212:215], a[140:143], a[108:111]
  v_mfma_f32_16x16x32_bf16 a[104:107], a[212:215], a[136:139], a[104:107]
  v_mfma_f32_16x16x32_bf16 a[100:103], a[212:215], a[132:135], a[100:103]
  v_mfma_f32_16x16x32_bf16 a[96:99], a[212:215], a[128:131], a[96:99]
  v_mfma_f32_16x16x32_bf16 a[92:95], a[212:215], a[124:127], a[92:95]
  v_mfma_f32_16x16x32_bf16 a[88:91], a[212:215], a[120:123], a[88:91]
  v_mfma_f32_16x16x32_bf16 a[84:87], a[212:215], a[116:119], a[84:87]
  v_mfma_f32_16x16x32_bf16 a[80:83], a[212:215], a[112:115], a[80:83]
  s_waitcnt vmcnt(18) lgkmcnt(0)
  s_barrier
  v_mfma_f32_16x16x32_bf16 v[48:51], a[216:219], a[144:147], v[48:51]
  s_add_u32 m0, s36, s81
  v_mfma_f32_16x16x32_bf16 v[52:55], a[216:219], a[148:151], v[52:55]
  ds_read_b64_tr_b16 a[176:177], v14 offset:0
  v_mfma_f32_16x16x32_bf16 v[56:59], a[216:219], a[152:155], v[56:59]
  ds_read_b64_tr_b16 a[178:179], v14 offset:3072
  v_mfma_f32_16x16x32_bf16 v[60:63], a[216:219], a[156:159], v[60:63]
  buffer_load_dwordx4 v2, s[8:11], s28 offen sc1 lds
  v_mfma_f32_16x16x32_bf16 v[64:67], a[216:219], a[160:163], v[64:67]
  ds_read_b128 a[112:115], v11 offset:0
  v_mfma_f32_16x16x32_bf16 v[68:71], a[216:219], a[164:167], v[68:71]
  s_add_u32 m0, m0, 1024
  v_mfma_f32_16x16x32_bf16 v[72:75], a[216:219], a[168:171], v[72:75]
  ds_read_b128 a[116:119], v11 offset:1024
  v_mfma_f32_16x16x32_bf16 v[76:79], a[216:219], a[172:175], v[76:79]
  buffer_load_dwordx4 v3, s[8:11], s28 offen sc1 lds
  v_mfma_f32_16x16x32_bf16 v[108:111], a[220:223], a[172:175], v[108:111]
  ds_read_b128 a[120:123], v11 offset:2048
  v_mfma_f32_16x16x32_bf16 v[104:107], a[220:223], a[168:171], v[104:107]
  ds_read_b128 a[124:127], v11 offset:3072
  v_mfma_f32_16x16x32_bf16 v[100:103], a[220:223], a[164:167], v[100:103]
  v_mfma_f32_16x16x32_bf16 v[96:99], a[220:223], a[160:163], v[96:99]
  s_add_u32 m0, m0, 1024
  v_mfma_f32_16x16x32_bf16 v[92:95], a[220:223], a[156:159], v[92:95]
  ds_read_b128 a[128:131], v11 offset:4096
  v_mfma_f32_16x16x32_bf16 v[88:91], a[220:223], a[152:155], v[88:91]
  buffer_load_dwordx4 v4, s[8:11], s28 offen sc1 lds
  v_mfma_f32_16x16x32_bf16 v[84:87], a[220:223], a[148:151], v[84:87]
  ds_read_b128 a[132:135], v11 offset:5120
  v_mfma_f32_16x16x32_bf16 v[80:83], a[220:223], a[144:147], v[80:83]
  s_add_u32 m0, m0, 1024
  v_mfma_f32_16x16x32_bf16 v[112:115], a[224:227], a[144:147], v[112:115]
  ds_read_b128 a[136:139], v11 offset:6144
  v_mfma_f32_16x16x32_bf16 v[116:119], a[224:227], a[148:151], v[116:119]
  ds_read_b128 a[140:143], v11 offset:7168
  v_mfma_f32_16x16x32_bf16 v[120:123], a[224:227], a[152:155], v[120:123]
  buffer_load_dwordx4 v5, s[8:11], s28 offen sc1 lds
  v_mfma_f32_16x16x32_bf16 v[124:127], a[224:227], a[156:159], v[124:127]
  ds_read_b64_tr_b16 a[180:181], v15 offset:0
  v_mfma_f32_16x16x32_bf16 v[128:131], a[224:227], a[160:163], v[128:131]
  v_mfma_f32_16x16x32_bf16 v[132:135], a[224:227], a[164:167], v[132:135]
  s_add_u32 s28, s28, 1024
  v_mfma_f32_16x16x32_bf16 v[136:139], a[224:227], a[168:171], v[136:139]
  ds_read_b64_tr_b16 a[182:183], v15 offset:3072
  v_mfma_f32_16x16x32_bf16 v[140:143], a[224:227], a[172:175], v[140:143]
  s_add_u32 m0, s36, s76
  v_mfma_f32_16x16x32_bf16 v[172:175], a[228:231], a[172:175], v[172:175]
  ds_read_b64_tr_b16 a[184:185], v12 offset:64
  v_mfma_f32_16x16x32_bf16 v[168:171], a[228:231], a[168:171], v[168:171]
  ds_read_b64_tr_b16 a[186:187], v12 offset:3648
  v_mfma_f32_16x16x32_bf16 v[164:167], a[228:231], a[164:167], v[164:167]
  buffer_load_dwordx4 v6, s[12:15], s29 offen lds
  v_mfma_f32_16x16x32_bf16 v[160:163], a[228:231], a[160:163], v[160:163]
  ds_read_b64_tr_b16 a[188:189], v12 offset:7232
  v_mfma_f32_16x16x32_bf16 v[156:159], a[228:231], a[156:159], v[156:159]
  s_add_u32 s29, s29, s32
  v_mfma_f32_16x16x32_bf16 v[152:155], a[228:231], a[152:155], v[152:155]
  ds_read_b64_tr_b16 a[190:191], v12 offset:10816
  v_mfma_f32_16x16x32_bf16 v[148:151], a[228:231], a[148:151], v[148:151]
  v_mfma_f32_16x16x32_bf16 v[144:147], a[228:231], a[144:147], v[144:147]
  s_add_u32 m0, s36, s77
  v_mfma_f32_16x16x32_bf16 v[176:179], a[232:235], a[144:147], v[176:179]
  ds_read_b64_tr_b16 a[192:193], v12 offset:96
  v_mfma_f32_16x16x32_bf16 v[180:183], a[232:235], a[148:151], v[180:183]
  ds_read_b64_tr_b16 a[194:195], v12 offset:3680
  v_mfma_f32_16x16x32_bf16 v[184:187], a[232:235], a[152:155], v[184:187]
  buffer_load_dwordx4 v7, s[16:19], s30 offen lds
  v_mfma_f32_16x16x32_bf16 v[188:191], a[232:235], a[156:159], v[188:191]
  ds_read_b64_tr_b16 a[196:197], v12 offset:7264
  v_mfma_f32_16x16x32_bf16 v[192:195], a[232:235], a[160:163], v[192:195]
  s_add_u32 s30, s30, s33
  v_mfma_f32_16x16x32_bf16 v[196:199], a[232:235], a[164:167], v[196:199]
  ds_read_b64_tr_b16 a[198:199], v12 offset:10848
  v_mfma_f32_16x16x32_bf16 v[200:203], a[232:235], a[168:171], v[200:203]
  s_add_u32 m0, s36, s78
  v_mfma_f32_16x16x32_bf16 v[204:207], a[232:235], a[172:175], v[204:207]
  ds_read_b64_tr_b16 a[200:201], v12 offset:128
  v_mfma_f32_16x16x32_bf16 v[236:239], a[236:239], a[172:175], v[236:239]
  ds_read_b64_tr_b16 a[202:203], v12 offset:3712
  v_mfma_f32_16x16x32_bf16 v[232:235], a[236:239], a[168:171], v[232:235]
  v_mfma_f32_16x16x32_bf16 v[228:231], a[236:239], a[164:167], v[228:231]
  buffer_load_dwordx4 v8, s[20:23], s31 offen lds
  v_mfma_f32_16x16x32_bf16 v[224:227], a[236:239], a[160:163], v[224:227]
  ds_read_b64_tr_b16 a[204:205], v12 offset:7296
  v_mfma_f32_16x16x32_bf16 v[220:223], a[236:239], a[156:159], v[220:223]
  s_add_u32 s31, s31, s34
  v_mfma_f32_16x16x32_bf16 v[216:219], a[236:239], a[152:155], v[216:219]
  ds_read_b64_tr_b16 a[206:207], v12 offset:10880
  v_mfma_f32_16x16x32_bf16 v[212:215], a[236:239], a[148:151], v[212:215]
  s_add_u32 m0, s36, s79
  v_mfma_f32_16x16x32_bf16 v[208:211], a[236:239], a[144:147], v[208:211]
  ds_read_b64_tr_b16 a[208:209], v12 offset:160
  v_mfma_f32_16x16x32_bf16 v[240:243], a[240:243], a[144:147], v[240:243]
  ds_read_b64_tr_b16 a[210:211], v12 offset:3744
  v_mfma_f32_16x16x32_bf16 v[244:247], a[240:243], a[148:151], v[244:247]
  buffer_load_dwordx4 v9, s[64:67], s72 offen lds
  v_mfma_f32_16x16x32_bf16 v[248:251], a[240:243], a[152:155], v[248:251]
  ds_read_b64_tr_b16 a[212:213], v12 offset:7328
  v_mfma_f32_16x16x32_bf16 v[252:255], a[240:243], a[156:159], v[252:255]
  v_mfma_f32_16x16x32_bf16 a[0:3], a[240:243], a[160:163], a[0:3]
  s_add_u32 s72, s72, s74
  v_mfma_f32_16x16x32_bf16 a[4:7], a[240:243], a[164:167], a[4:7]
  ds_read_b64_tr_b16 a[214:215], v12 offset:10912
  v_mfma_f32_16x16x32_bf16 a[8:11], a[240:243], a[168:171], a[8:11]
  s_add_u32 m0, s36, s80
  v_mfma_f32_16x16x32_bf16 a[12:15], a[240:243], a[172:175], a[12:15]
  s_add_u32 s39, s39, 36864
  v_mfma_f32_16x16x32_bf16 a[44:47], a[244:247], a[172:175], a[44:47]
  s_cmp_eq_u32 s39, 147456
  v_mfma_f32_16x16x32_bf16 a[40:43], a[244:247], a[168:171], a[40:43]
  s_cselect_b32 s39, 0, s39
  v_mfma_f32_16x16x32_bf16 a[36:39], a[244:247], a[164:167], a[36:39]
  s_cselect_b32 s37, s63, s62
  v_mfma_f32_16x16x32_bf16 a[32:35], a[244:247], a[160:163], a[32:35]
  v_add_u32 v11, s37, v11
  v_mfma_f32_16x16x32_bf16 a[28:31], a[244:247], a[156:159], a[28:31]
  buffer_load_dwordx4 v10, s[68:71], s73 offen lds
  v_mfma_f32_16x16x32_bf16 a[24:27], a[244:247], a[152:155], a[24:27]
  v_mfma_f32_16x16x32_bf16 a[20:23], a[244:247], a[148:151], a[20:23]
  v_add_u32 v12, s37, v12
  v_mfma_f32_16x16x32_bf16 a[16:19], a[244:247], a[144:147], a[16:19]
  s_add_u32 s73, s73, s75
  v_mfma_f32_16x16x32_bf16 a[48:51], a[248:251], a[144:147], a[48:51]
  v_add_u32 v14, s37, v14
  v_mfma_f32_16x16x32_bf16 a[52:55], a[248:251], a[148:151], a[52:55]
  s_add_u32 s36, s36, 36864
  v_mfma_f32_16x16x32_bf16 a[56:59], a[248:251], a[152:155], a[56:59]
  s_cmp_eq_u32 s36, 147456
  v_mfma_f32_16x16x32_bf16 a[60:63], a[248:251], a[156:159], a[60:63]
  s_cselect_b32 s36, 0, s36
  v_mfma_f32_16x16x32_bf16 a[64:67], a[248:251], a[160:163], a[64:67]
  v_add_u32 v15, s37, v15
  v_mfma_f32_16x16x32_bf16 a[68:71], a[248:251], a[164:167], a[68:71]
  s_sub_u32 s38, s38, 1
  v_mfma_f32_16x16x32_bf16 a[72:75], a[248:251], a[168:171], a[72:75]
  s_cmp_lg_u32 s38, 0
  v_mfma_f32_16x16x32_bf16 a[76:79], a[248:251], a[172:175], a[76:79]
  v_mfma_f32_16x16x32_bf16 a[108:111], a[252:255], a[172:175], a[108:111]
  v_mfma_f32_16x16x32_bf16 a[104:107], a[252:255], a[168:171], a[104:107]
  v_mfma_f32_16x16x32_bf16 a[100:103], a[252:255], a[164:167], a[100:103]
  v_mfma_f32_16x16x32_bf16 a[96:99], a[252:255], a[160:163], a[96:99]
  v_mfma_f32_16x16x32_bf16 a[92:95], a[252:255], a[156:159], a[92:95]
  v_mfma_f32_16x16x32_bf16 a[88:91], a[252:255], a[152:155], a[88:91]
  v_mfma_f32_16x16x32_bf16 a[84:87], a[252:255], a[148:151], a[84:87]
  v_mfma_f32_16x16x32_bf16 a[80:83], a[252:255], a[144:147], a[80:83]
  s_cbranch_scc1 L_parallel_sum__linear_kernel_hedgehog__glu_gated_reglu__prompt_kernel_loop1
  s_waitcnt vmcnt(0) lgkmcnt(0)
  s_nop 7
  s_add_u32 s24, s60, 0x3000000
  s_addc_u32 s25, s61, 0
  s_and_b32 s25, s25, 0xffff
  s_mov_b32 s26, 0xc000
  s_mov_b32 s27, 0x20000
  s_mov_b32 s72, 0x3fb8aa3b
  s_mov_b32 s73, 0x3fb8aa3b
  s_mov_b32 s62, 0xbfb8aa3b
  s_mov_b32 s63, 0xbfb8aa3b
  s_add_u32 s8, s60, 0x400000
  s_addc_u32 s9, s61, 0
  s_and_b32 s9, s9, 0xffff
  s_mov_b32 s10, 0x1200000
  s_mov_b32 s11, 0x20000
  v_lshrrev_b32 v3, 4, v1
  v_bfe_u32 v4, v1, 2, 2
  v_lshl_add_u32 v4, v3, 2, v4
  v_and_b32 v5, 3, v1
  v_lshlrev_b32 v4, 6, v4
  v_lshl_add_u32 v4, v5, 3, v4
  v_add_u32 v4, 147456, v4
  ds_read_b64_tr_b16 a[112:113], v4 offset:0
  ds_read_b64_tr_b16 a[114:115], v4 offset:1024
  ds_read_b64_tr_b16 a[116:117], v4 offset:32
  ds_read_b64_tr_b16 a[118:119], v4 offset:1056
  s_lshl_b32 s82, s4, 4
  s_lshl_b32 s83, s6, 3
  s_add_u32 s82, s82, s83
  s_mul_i32 s37, s82, 147456
  s_mov_b32 s48, s4
  s_mov_b32 s49, s5
  s_lshl_b32 s74, s5, 7
  s_add_u32 s74, s74, 0
  s_mul_i32 s75, s5, 98304
  s_mul_i32 s83, s3, 2048
  s_add_u32 s75, s75, s83
  s_add_u32 s76, s5, 112
  s_lshl_b32 s76, s76, 10
  s_add_u32 s76, s76, s37
  s_lshl_b32 s85, s4, 2
  s_lshr_b32 s83, s5, 3
  s_add_u32 s85, s85, s83
  s_lshl_b32 s85, s85, 7
  s_add_u32 s85, s85, 8192
  s_lshr_b32 s83, s5, 1
  s_mul_i32 s83, s83, 7
  s_lshl_b32 s84, s7, 2
  s_add_u32 s84, s84, s83
  s_add_u32 s36, s84, 1
  s_lshl_b32 s36, s36, 10
  s_add_u32 s36, s36, s37
  v_max_f32 v112, 0, v112
  v_max_f32 v116, 0, v116
  v_max_f32 v113, 0, v113
  v_max_f32 v117, 0, v117
  v_max_f32 v114, 0, v114
  v_max_f32 v118, 0, v118
  v_max_f32 v115, 0, v115
  v_max_f32 v119, 0, v119
  v_pk_mul_f32 v[112:113], v[112:113], v[144:145]
  v_pk_mul_f32 v[116:117], v[116:117], v[148:149]
  v_pk_mul_f32 v[114:115], v[114:115], v[146:147]
  v_pk_mul_f32 v[118:119], v[118:119], v[150:151]
  v_max_f32 v176, 0, v176
  v_max_f32 v180, 0, v180
  v_max_f32 v177, 0, v177
  v_max_f32 v181, 0, v181
  v_max_f32 v178, 0, v178
  v_max_f32 v182, 0, v182
  v_max_f32 v179, 0, v179
  v_max_f32 v183, 0, v183
  v_pk_mul_f32 v[176:177], v[176:177], v[208:209]
  v_pk_mul_f32 v[180:181], v[180:181], v[212:213]
  v_pk_mul_f32 v[178:179], v[178:179], v[210:211]
  v_pk_mul_f32 v[182:183], v[182:183], v[214:215]
  v_cvt_pk_bf16_f32 v112, v112, v113
  v_cvt_pk_bf16_f32 v116, v116, v117
  v_cvt_pk_bf16_f32 v113, v114, v115
  v_cvt_pk_bf16_f32 v117, v118, v119
  v_cvt_pk_bf16_f32 v114, v176, v177
  v_cvt_pk_bf16_f32 v118, v180, v181
  v_cvt_pk_bf16_f32 v115, v178, v179
  v_cvt_pk_bf16_f32 v119, v182, v183
  buffer_store_dwordx4 v[112:115], v2, s[8:11], s36 offen sc1
  s_add_u32 s36, s36, 147456
  buffer_store_dwordx4 v[116:119], v2, s[8:11], s36 offen sc1
  s_add_u32 s36, s36, 147456
  v_max_f32 v120, 0, v120
  v_max_f32 v124, 0, v124
  v_max_f32 v121, 0, v121
  v_max_f32 v125, 0, v125
  v_max_f32 v122, 0, v122
  v_max_f32 v126, 0, v126
  v_max_f32 v123, 0, v123
  v_max_f32 v127, 0, v127
  v_pk_mul_f32 v[120:121], v[120:121], v[152:153]
  v_pk_mul_f32 v[124:125], v[124:125], v[156:157]
  v_pk_mul_f32 v[122:123], v[122:123], v[154:155]
  v_pk_mul_f32 v[126:127], v[126:127], v[158:159]
  v_max_f32 v184, 0, v184
  v_max_f32 v188, 0, v188
  v_max_f32 v185, 0, v185
  v_max_f32 v189, 0, v189
  v_max_f32 v186, 0, v186
  v_max_f32 v190, 0, v190
  v_max_f32 v187, 0, v187
  v_max_f32 v191, 0, v191
  v_pk_mul_f32 v[184:185], v[184:185], v[216:217]
  v_pk_mul_f32 v[188:189], v[188:189], v[220:221]
  v_pk_mul_f32 v[186:187], v[186:187], v[218:219]
  v_pk_mul_f32 v[190:191], v[190:191], v[222:223]
  v_cvt_pk_bf16_f32 v120, v120, v121
  v_cvt_pk_bf16_f32 v124, v124, v125
  v_cvt_pk_bf16_f32 v121, v122, v123
  v_cvt_pk_bf16_f32 v125, v126, v127
  v_cvt_pk_bf16_f32 v122, v184, v185
  v_cvt_pk_bf16_f32 v126, v188, v189
  v_cvt_pk_bf16_f32 v123, v186, v187
  v_cvt_pk_bf16_f32 v127, v190, v191
  buffer_store_dwordx4 v[120:123], v2, s[8:11], s36 offen sc1
  s_add_u32 s36, s36, 147456
  buffer_store_dwordx4 v[124:127], v2, s[8:11], s36 offen sc1
  s_add_u32 s36, s36, 147456
  v_max_f32 v128, 0, v128
  v_max_f32 v132, 0, v132
  v_max_f32 v129, 0, v129
  v_max_f32 v133, 0, v133
  v_max_f32 v130, 0, v130
  v_max_f32 v134, 0, v134
  v_max_f32 v131, 0, v131
  v_max_f32 v135, 0, v135
  v_pk_mul_f32 v[128:129], v[128:129], v[160:161]
  v_pk_mul_f32 v[132:133], v[132:133], v[164:165]
  v_pk_mul_f32 v[130:131], v[130:131], v[162:163]
  v_pk_mul_f32 v[134:135], v[134:135], v[166:167]
  v_max_f32 v192, 0, v192
  v_max_f32 v196, 0, v196
  v_max_f32 v193, 0, v193
  v_max_f32 v197, 0, v197
  v_max_f32 v194, 0, v194
  v_max_f32 v198, 0, v198
  v_max_f32 v195, 0, v195
  v_max_f32 v199, 0, v199
  v_pk_mul_f32 v[192:193], v[192:193], v[224:225]
  v_pk_mul_f32 v[196:197], v[196:197], v[228:229]
  v_pk_mul_f32 v[194:195], v[194:195], v[226:227]
  v_pk_mul_f32 v[198:199], v[198:199], v[230:231]
  v_cvt_pk_bf16_f32 v128, v128, v129
  v_cvt_pk_bf16_f32 v132, v132, v133
  v_cvt_pk_bf16_f32 v129, v130, v131
  v_cvt_pk_bf16_f32 v133, v134, v135
  v_cvt_pk_bf16_f32 v130, v192, v193
  v_cvt_pk_bf16_f32 v134, v196, v197
  v_cvt_pk_bf16_f32 v131, v194, v195
  v_cvt_pk_bf16_f32 v135, v198, v199
  buffer_store_dwordx4 v[128:131], v2, s[8:11], s36 offen sc1
  s_add_u32 s36, s36, 147456
  buffer_store_dwordx4 v[132:135], v2, s[8:11], s36 offen sc1
  s_add_u32 s36, s36, 147456
  v_max_f32 v136, 0, v136
  v_max_f32 v140, 0, v140
  v_max_f32 v137, 0, v137
  v_max_f32 v141, 0, v141
  v_max_f32 v138, 0, v138
  v_max_f32 v142, 0, v142
  v_max_f32 v139, 0, v139
  v_max_f32 v143, 0, v143
  v_pk_mul_f32 v[136:137], v[136:137], v[168:169]
  v_pk_mul_f32 v[140:141], v[140:141], v[172:173]
  v_pk_mul_f32 v[138:139], v[138:139], v[170:171]
  v_pk_mul_f32 v[142:143], v[142:143], v[174:175]
  v_max_f32 v200, 0, v200
  v_max_f32 v204, 0, v204
  v_max_f32 v201, 0, v201
  v_max_f32 v205, 0, v205
  v_max_f32 v202, 0, v202
  v_max_f32 v206, 0, v206
  v_max_f32 v203, 0, v203
  v_max_f32 v207, 0, v207
  v_pk_mul_f32 v[200:201], v[200:201], v[232:233]
  v_pk_mul_f32 v[204:205], v[204:205], v[236:237]
  v_pk_mul_f32 v[202:203], v[202:203], v[234:235]
  v_pk_mul_f32 v[206:207], v[206:207], v[238:239]
  v_cvt_pk_bf16_f32 v136, v136, v137
  v_cvt_pk_bf16_f32 v140, v140, v141
  v_cvt_pk_bf16_f32 v137, v138, v139
  v_cvt_pk_bf16_f32 v141, v142, v143
  v_cvt_pk_bf16_f32 v138, v200, v201
  v_cvt_pk_bf16_f32 v142, v204, v205
  v_cvt_pk_bf16_f32 v139, v202, v203
  v_cvt_pk_bf16_f32 v143, v206, v207
  buffer_store_dwordx4 v[136:139], v2, s[8:11], s36 offen sc1
  s_add_u32 s36, s36, 147456
  buffer_store_dwordx4 v[140:143], v2, s[8:11], s36 offen sc1
  s_add_u32 s36, s36, 147456
  s_add_u32 s36, s84, 2
  s_lshl_b32 s36, s36, 10
  s_add_u32 s36, s36, s37
  v_accvgpr_read_b32 v20, a16
  v_accvgpr_read_b32 v36, a20
  v_accvgpr_read_b32 v21, a17
  v_accvgpr_read_b32 v37, a21
  v_accvgpr_read_b32 v22, a18
  v_accvgpr_read_b32 v38, a22
  v_accvgpr_read_b32 v23, a19
  v_accvgpr_read_b32 v39, a23
  v_max_f32 v240, 0, v240
  v_max_f32 v244, 0, v244
  v_max_f32 v241, 0, v241
  v_max_f32 v245, 0, v245
  v_max_f32 v242, 0, v242
  v_max_f32 v246, 0, v246
  v_max_f32 v243, 0, v243
  v_max_f32 v247, 0, v247
  v_pk_mul_f32 v[240:241], v[240:241], v[20:21]
  v_pk_mul_f32 v[244:245], v[244:245], v[36:37]
  v_pk_mul_f32 v[242:243], v[242:243], v[22:23]
  v_pk_mul_f32 v[246:247], v[246:247], v[38:39]
  v_accvgpr_read_b32 v24, a48
  v_accvgpr_read_b32 v40, a52
  v_accvgpr_read_b32 v25, a49
  v_accvgpr_read_b32 v41, a53
  v_accvgpr_read_b32 v26, a50
  v_accvgpr_read_b32 v42, a54
  v_accvgpr_read_b32 v27, a51
  v_accvgpr_read_b32 v43, a55
  v_accvgpr_read_b32 v28, a80
  v_accvgpr_read_b32 v44, a84
  v_accvgpr_read_b32 v29, a81
  v_accvgpr_read_b32 v45, a85
  v_accvgpr_read_b32 v30, a82
  v_accvgpr_read_b32 v46, a86
  v_accvgpr_read_b32 v31, a83
  v_accvgpr_read_b32 v47, a87
  v_max_f32 v24, 0, v24
  v_max_f32 v40, 0, v40
  v_max_f32 v25, 0, v25
  v_max_f32 v41, 0, v41
  v_max_f32 v26, 0, v26
  v_max_f32 v42, 0, v42
  v_max_f32 v27, 0, v27
  v_max_f32 v43, 0, v43
  v_pk_mul_f32 v[24:25], v[24:25], v[28:29]
  v_pk_mul_f32 v[40:41], v[40:41], v[44:45]
  v_pk_mul_f32 v[26:27], v[26:27], v[30:31]
  v_pk_mul_f32 v[42:43], v[42:43], v[46:47]
  v_cvt_pk_bf16_f32 v240, v240, v241
  v_cvt_pk_bf16_f32 v244, v244, v245
  v_cvt_pk_bf16_f32 v241, v242, v243
  v_cvt_pk_bf16_f32 v245, v246, v247
  v_cvt_pk_bf16_f32 v242, v24, v25
  v_cvt_pk_bf16_f32 v246, v40, v41
  v_cvt_pk_bf16_f32 v243, v26, v27
  v_cvt_pk_bf16_f32 v247, v42, v43
  buffer_store_dwordx4 v[240:243], v2, s[8:11], s36 offen sc1
  s_add_u32 s36, s36, 147456
  buffer_store_dwordx4 v[244:247], v2, s[8:11], s36 offen sc1
  s_add_u32 s36, s36, 147456
  v_accvgpr_read_b32 v20, a24
  v_accvgpr_read_b32 v36, a28
  v_accvgpr_read_b32 v21, a25
  v_accvgpr_read_b32 v37, a29
  v_accvgpr_read_b32 v22, a26
  v_accvgpr_read_b32 v38, a30
  v_accvgpr_read_b32 v23, a27
  v_accvgpr_read_b32 v39, a31
  v_max_f32 v248, 0, v248
  v_max_f32 v252, 0, v252
  v_max_f32 v249, 0, v249
  v_max_f32 v253, 0, v253
  v_max_f32 v250, 0, v250
  v_max_f32 v254, 0, v254
  v_max_f32 v251, 0, v251
  v_max_f32 v255, 0, v255
  v_pk_mul_f32 v[248:249], v[248:249], v[20:21]
  v_pk_mul_f32 v[252:253], v[252:253], v[36:37]
  v_pk_mul_f32 v[250:251], v[250:251], v[22:23]
  v_pk_mul_f32 v[254:255], v[254:255], v[38:39]
  v_accvgpr_read_b32 v24, a56
  v_accvgpr_read_b32 v40, a60
  v_accvgpr_read_b32 v25, a57
  v_accvgpr_read_b32 v41, a61
  v_accvgpr_read_b32 v26, a58
  v_accvgpr_read_b32 v42, a62
  v_accvgpr_read_b32 v27, a59
  v_accvgpr_read_b32 v43, a63
  v_accvgpr_read_b32 v28, a88
  v_accvgpr_read_b32 v44, a92
  v_accvgpr_read_b32 v29, a89
  v_accvgpr_read_b32 v45, a93
  v_accvgpr_read_b32 v30, a90
  v_accvgpr_read_b32 v46, a94
  v_accvgpr_read_b32 v31, a91
  v_accvgpr_read_b32 v47, a95
  v_max_f32 v24, 0, v24
  v_max_f32 v40, 0, v40
  v_max_f32 v25, 0, v25
  v_max_f32 v41, 0, v41
  v_max_f32 v26, 0, v26
  v_max_f32 v42, 0, v42
  v_max_f32 v27, 0, v27
  v_max_f32 v43, 0, v43
  v_pk_mul_f32 v[24:25], v[24:25], v[28:29]
  v_pk_mul_f32 v[40:41], v[40:41], v[44:45]
  v_pk_mul_f32 v[26:27], v[26:27], v[30:31]
  v_pk_mul_f32 v[42:43], v[42:43], v[46:47]
  v_cvt_pk_bf16_f32 v248, v248, v249
  v_cvt_pk_bf16_f32 v252, v252, v253
  v_cvt_pk_bf16_f32 v249, v250, v251
  v_cvt_pk_bf16_f32 v253, v254, v255
  v_cvt_pk_bf16_f32 v250, v24, v25
  v_cvt_pk_bf16_f32 v254, v40, v41
  v_cvt_pk_bf16_f32 v251, v26, v27
  v_cvt_pk_bf16_f32 v255, v42, v43
  buffer_store_dwordx4 v[248:251], v2, s[8:11], s36 offen sc1
  s_add_u32 s36, s36, 147456
  buffer_store_dwordx4 v[252:255], v2, s[8:11], s36 offen sc1
  s_add_u32 s36, s36, 147456
  v_accvgpr_read_b32 v16, a0
  v_accvgpr_read_b32 v32, a4
  v_accvgpr_read_b32 v17, a1
  v_accvgpr_read_b32 v33, a5
  v_accvgpr_read_b32 v18, a2
  v_accvgpr_read_b32 v34, a6
  v_accvgpr_read_b32 v19, a3
  v_accvgpr_read_b32 v35, a7
  v_accvgpr_read_b32 v20, a32
  v_accvgpr_read_b32 v36, a36
  v_accvgpr_read_b32 v21, a33
  v_accvgpr_read_b32 v37, a37
  v_accvgpr_read_b32 v22, a34
  v_accvgpr_read_b32 v38, a38
  v_accvgpr_read_b32 v23, a35
  v_accvgpr_read_b32 v39, a39
  v_max_f32 v16, 0, v16
  v_max_f32 v32, 0, v32
  v_max_f32 v17, 0, v17
  v_max_f32 v33, 0, v33
  v_max_f32 v18, 0, v18
  v_max_f32 v34, 0, v34
  v_max_f32 v19, 0, v19
  v_max_f32 v35, 0, v35
  v_pk_mul_f32 v[16:17], v[16:17], v[20:21]
  v_pk_mul_f32 v[32:33], v[32:33], v[36:37]
  v_pk_mul_f32 v[18:19], v[18:19], v[22:23]
  v_pk_mul_f32 v[34:35], v[34:35], v[38:39]
  v_accvgpr_read_b32 v24, a64
  v_accvgpr_read_b32 v40, a68
  v_accvgpr_read_b32 v25, a65
  v_accvgpr_read_b32 v41, a69
  v_accvgpr_read_b32 v26, a66
  v_accvgpr_read_b32 v42, a70
  v_accvgpr_read_b32 v27, a67
  v_accvgpr_read_b32 v43, a71
  v_accvgpr_read_b32 v28, a96
  v_accvgpr_read_b32 v44, a100
  v_accvgpr_read_b32 v29, a97
  v_accvgpr_read_b32 v45, a101
  v_accvgpr_read_b32 v30, a98
  v_accvgpr_read_b32 v46, a102
  v_accvgpr_read_b32 v31, a99
  v_accvgpr_read_b32 v47, a103
  v_max_f32 v24, 0, v24
  v_max_f32 v40, 0, v40
  v_max_f32 v25, 0, v25
  v_max_f32 v41, 0, v41
  v_max_f32 v26, 0, v26
  v_max_f32 v42, 0, v42
  v_max_f32 v27, 0, v27
  v_max_f32 v43, 0, v43
  v_pk_mul_f32 v[24:25], v[24:25], v[28:29]
  v_pk_mul_f32 v[40:41], v[40:41], v[44:45]
  v_pk_mul_f32 v[26:27], v[26:27], v[30:31]
  v_pk_mul_f32 v[42:43], v[42:43], v[46:47]
  v_cvt_pk_bf16_f32 v16, v16, v17
  v_cvt_pk_bf16_f32 v32, v32, v33
  v_cvt_pk_bf16_f32 v17, v18, v19
  v_cvt_pk_bf16_f32 v33, v34, v35
  v_cvt_pk_bf16_f32 v18, v24, v25
  v_cvt_pk_bf16_f32 v34, v40, v41
  v_cvt_pk_bf16_f32 v19, v26, v27
  v_cvt_pk_bf16_f32 v35, v42, v43
  buffer_store_dwordx4 v[16:19], v2, s[8:11], s36 offen sc1
  s_add_u32 s36, s36, 147456
  buffer_store_dwordx4 v[32:35], v2, s[8:11], s36 offen sc1
  s_add_u32 s36, s36, 147456
  v_accvgpr_read_b32 v16, a8
  v_accvgpr_read_b32 v32, a12
  v_accvgpr_read_b32 v17, a9
  v_accvgpr_read_b32 v33, a13
  v_accvgpr_read_b32 v18, a10
  v_accvgpr_read_b32 v34, a14
  v_accvgpr_read_b32 v19, a11
  v_accvgpr_read_b32 v35, a15
  v_accvgpr_read_b32 v20, a40
  v_accvgpr_read_b32 v36, a44
  v_accvgpr_read_b32 v21, a41
  v_accvgpr_read_b32 v37, a45
  v_accvgpr_read_b32 v22, a42
  v_accvgpr_read_b32 v38, a46
  v_accvgpr_read_b32 v23, a43
  v_accvgpr_read_b32 v39, a47
  v_max_f32 v16, 0, v16
  v_max_f32 v32, 0, v32
  v_max_f32 v17, 0, v17
  v_max_f32 v33, 0, v33
  v_max_f32 v18, 0, v18
  v_max_f32 v34, 0, v34
  v_max_f32 v19, 0, v19
  v_max_f32 v35, 0, v35
  v_pk_mul_f32 v[16:17], v[16:17], v[20:21]
  v_pk_mul_f32 v[32:33], v[32:33], v[36:37]
  v_pk_mul_f32 v[18:19], v[18:19], v[22:23]
  v_pk_mul_f32 v[34:35], v[34:35], v[38:39]
  v_accvgpr_read_b32 v24, a72
  v_accvgpr_read_b32 v40, a76
  v_accvgpr_read_b32 v25, a73
  v_accvgpr_read_b32 v41, a77
  v_accvgpr_read_b32 v26, a74
  v_accvgpr_read_b32 v42, a78
  v_accvgpr_read_b32 v27, a75
  v_accvgpr_read_b32 v43, a79
  v_accvgpr_read_b32 v28, a104
  v_accvgpr_read_b32 v44, a108
  v_accvgpr_read_b32 v29, a105
  v_accvgpr_read_b32 v45, a109
  v_accvgpr_read_b32 v30, a106
  v_accvgpr_read_b32 v46, a110
  v_accvgpr_read_b32 v31, a107
  v_accvgpr_read_b32 v47, a111
  v_max_f32 v24, 0, v24
  v_max_f32 v40, 0, v40
  v_max_f32 v25, 0, v25
  v_max_f32 v41, 0, v41
  v_max_f32 v26, 0, v26
  v_max_f32 v42, 0, v42
  v_max_f32 v27, 0, v27
  v_max_f32 v43, 0, v43
  v_pk_mul_f32 v[24:25], v[24:25], v[28:29]
  v_pk_mul_f32 v[40:41], v[40:41], v[44:45]
  v_pk_mul_f32 v[26:27], v[26:27], v[30:31]
  v_pk_mul_f32 v[42:43], v[42:43], v[46:47]
  v_cvt_pk_bf16_f32 v16, v16, v17
  v_cvt_pk_bf16_f32 v32, v32, v33
  v_cvt_pk_bf16_f32 v17, v18, v19
  v_cvt_pk_bf16_f32 v33, v34, v35
  v_cvt_pk_bf16_f32 v18, v24, v25
  v_cvt_pk_bf16_f32 v34, v40, v41
  v_cvt_pk_bf16_f32 v19, v26, v27
  v_cvt_pk_bf16_f32 v35, v42, v43
  buffer_store_dwordx4 v[16:19], v2, s[8:11], s36 offen sc1
  s_add_u32 s36, s36, 147456
  buffer_store_dwordx4 v[32:35], v2, s[8:11], s36 offen sc1
  s_add_u32 s36, s36, 147456
  s_waitcnt lgkmcnt(0)
  v_cvt_pk_bf16_f32 v48, v48, v49
  v_cvt_pk_bf16_f32 v49, v50, v51
  v_cvt_pk_bf16_f32 v50, v80, v81
  v_cvt_pk_bf16_f32 v51, v82, v83
  v_cvt_pk_bf16_f32 v52, v52, v53
  v_cvt_pk_bf16_f32 v53, v54, v55
  v_cvt_pk_bf16_f32 v54, v84, v85
  v_cvt_pk_bf16_f32 v55, v86, v87
  v_cvt_pk_bf16_f32 v56, v56, v57
  v_cvt_pk_bf16_f32 v57, v58, v59
  v_cvt_pk_bf16_f32 v58, v88, v89
  v_cvt_pk_bf16_f32 v59, v90, v91
  v_cvt_pk_bf16_f32 v60, v60, v61
  v_cvt_pk_bf16_f32 v61, v62, v63
  v_cvt_pk_bf16_f32 v62, v92, v93
  v_cvt_pk_bf16_f32 v63, v94, v95
  v_cvt_pk_bf16_f32 v64, v64, v65
  v_cvt_pk_bf16_f32 v65, v66, v67
  v_cvt_pk_bf16_f32 v66, v96, v97
  v_cvt_pk_bf16_f32 v67, v98, v99
  v_cvt_pk_bf16_f32 v68, v68, v69
  v_cvt_pk_bf16_f32 v69, v70, v71
  v_cvt_pk_bf16_f32 v70, v100, v101
  v_cvt_pk_bf16_f32 v71, v102, v103
  v_cvt_pk_bf16_f32 v72, v72, v73
  v_cvt_pk_bf16_f32 v73, v74, v75
  v_cvt_pk_bf16_f32 v74, v104, v105
  v_cvt_pk_bf16_f32 v75, v106, v107
  v_cvt_pk_bf16_f32 v76, v76, v77
  v_cvt_pk_bf16_f32 v77, v78, v79
  v_cvt_pk_bf16_f32 v78, v108, v109
  v_cvt_pk_bf16_f32 v79, v110, v111
  v_mfma_f32_16x16x32_bf16 v[80:83], a[112:115], v[48:51], 0
  v_mfma_f32_16x16x32_bf16 v[48:51], a[116:119], v[48:51], 0
  v_mfma_f32_16x16x32_bf16 v[84:87], a[112:115], v[52:55], 0
  v_mfma_f32_16x16x32_bf16 v[52:55], a[116:119], v[52:55], 0
  v_mfma_f32_16x16x32_bf16 v[88:91], a[112:115], v[56:59], 0
  v_mfma_f32_16x16x32_bf16 v[56:59], a[116:119], v[56:59], 0
  v_mfma_f32_16x16x32_bf16 v[92:95], a[112:115], v[60:63], 0
  v_mfma_f32_16x16x32_bf16 v[60:63], a[116:119], v[60:63], 0
  v_mfma_f32_16x16x32_bf16 v[96:99], a[112:115], v[64:67], 0
  v_mfma_f32_16x16x32_bf16 v[64:67], a[116:119], v[64:67], 0
  v_mfma_f32_16x16x32_bf16 v[100:103], a[112:115], v[68:71], 0
  v_mfma_f32_16x16x32_bf16 v[68:71], a[116:119], v[68:71], 0
  v_mfma_f32_16x16x32_bf16 v[104:107], a[112:115], v[72:75], 0
  v_mfma_f32_16x16x32_bf16 v[72:75], a[116:119], v[72:75], 0
  v_mfma_f32_16x16x32_bf16 v[108:111], a[112:115], v[76:79], 0
  v_mfma_f32_16x16x32_bf16 v[76:79], a[116:119], v[76:79], 0
  v_max3_f32 v16, v80, v81, v82
  v_max3_f32 v20, v84, v85, v86
  v_max3_f32 v24, v88, v89, v90
  v_max3_f32 v28, v92, v93, v94
  v_max3_f32 v32, v96, v97, v98
  v_max3_f32 v36, v100, v101, v102
  v_max3_f32 v40, v104, v105, v106
  v_max3_f32 v44, v108, v109, v110
  v_max3_f32 v17, -v80, -v81, -v82
  v_max3_f32 v21, -v84, -v85, -v86
  v_max3_f32 v25, -v88, -v89, -v90
  v_max3_f32 v29, -v92, -v93, -v94
  v_max3_f32 v33, -v96, -v97, -v98
  v_max3_f32 v37, -v100, -v101, -v102
  v_max3_f32 v41, -v104, -v105, -v106
  v_max3_f32 v45, -v108, -v109, -v110
  v_max3_f32 v16, v16, v83, v48
  v_max3_f32 v20, v20, v87, v52
  v_max3_f32 v24, v24, v91, v56
  v_max3_f32 v28, v28, v95, v60
  v_max3_f32 v32, v32, v99, v64
  v_max3_f32 v36, v36, v103, v68
  v_max3_f32 v40, v40, v107, v72
  v_max3_f32 v44, v44, v111, v76
  v_max3_f32 v17, v17, -v83, -v48
  v_max3_f32 v21, v21, -v87, -v52
  v_max3_f32 v25, v25, -v91, -v56
  v_max3_f32 v29, v29, -v95, -v60
  v_max3_f32 v33, v33, -v99, -v64
  v_max3_f32 v37, v37, -v103, -v68
  v_max3_f32 v41, v41, -v107, -v72
  v_max3_f32 v45, v45, -v111, -v76
  v_max3_f32 v16, v16, v49, v50
  v_max3_f32 v20, v20, v53, v54
  v_max3_f32 v24, v24, v57, v58
  v_max3_f32 v28, v28, v61, v62
  v_max3_f32 v32, v32, v65, v66
  v_max3_f32 v36, v36, v69, v70
  v_max3_f32 v40, v40, v73, v74
  v_max3_f32 v44, v44, v77, v78
  v_max3_f32 v17, v17, -v49, -v50
  v_max3_f32 v21, v21, -v53, -v54
  v_max3_f32 v25, v25, -v57, -v58
  v_max3_f32 v29, v29, -v61, -v62
  v_max3_f32 v33, v33, -v65, -v66
  v_max3_f32 v37, v37, -v69, -v70
  v_max3_f32 v41, v41, -v73, -v74
  v_max3_f32 v45, v45, -v77, -v78
  v_max_f32 v16, v16, v51
  v_max_f32 v20, v20, v55
  v_max_f32 v24, v24, v59
  v_max_f32 v28, v28, v63
  v_max_f32 v32, v32, v67
  v_max_f32 v36, v36, v71
  v_max_f32 v40, v40, v75
  v_max_f32 v44, v44, v79
  v_max_f32_e64 v17, v17, -v51
  v_max_f32_e64 v21, v21, -v55
  v_max_f32_e64 v25, v25, -v59
  v_max_f32_e64 v29, v29, -v63
  v_max_f32_e64 v33, v33, -v67
  v_max_f32_e64 v37, v37, -v71
  v_max_f32_e64 v41, v41, -v75
  v_max_f32_e64 v45, v45, -v79
  v_permlane16_swap_b32 v16, v17
  v_permlane16_swap_b32 v20, v21
  v_permlane16_swap_b32 v24, v25
  v_permlane16_swap_b32 v28, v29
  v_permlane16_swap_b32 v32, v33
  v_permlane16_swap_b32 v36, v37
  v_permlane16_swap_b32 v40, v41
  v_permlane16_swap_b32 v44, v45
  v_max_f32 v16, v16, v17
  v_max_f32 v20, v20, v21
  v_max_f32 v24, v24, v25
  v_max_f32 v28, v28, v29
  v_max_f32 v32, v32, v33
  v_max_f32 v36, v36, v37
  v_max_f32 v40, v40, v41
  v_max_f32 v44, v44, v45
  v_mov_b32 v17, v16
  v_mov_b32 v21, v20
  v_mov_b32 v25, v24
  v_mov_b32 v29, v28
  v_mov_b32 v33, v32
  v_mov_b32 v37, v36
  v_mov_b32 v41, v40
  v_mov_b32 v45, v44
  v_permlane32_swap_b32 v16, v17
  v_permlane32_swap_b32 v20, v21
  v_permlane32_swap_b32 v24, v25
  v_permlane32_swap_b32 v28, v29
  v_permlane32_swap_b32 v32, v33
  v_permlane32_swap_b32 v36, v37
  v_permlane32_swap_b32 v40, v41
  v_permlane32_swap_b32 v44, v45
  v_max_f32 v16, v16, v17
  v_max_f32 v20, v20, v21
  v_max_f32 v24, v24, v25
  v_max_f32 v28, v28, v29
  v_max_f32 v32, v32, v33
  v_max_f32 v36, v36, v37
  v_max_f32 v40, v40, v41
  v_max_f32 v44, v44, v45
  v_mul_f32 v16, s72, v16
  v_mul_f32 v20, s72, v20
  v_mul_f32 v24, s72, v24
  v_mul_f32 v28, s72, v28
  v_mul_f32 v32, s72, v32
  v_mul_f32 v36, s72, v36
  v_mul_f32 v40, s72, v40
  v_mul_f32 v44, s72, v44
  v_mov_b32 v17, v16
  v_mov_b32 v21, v20
  v_mov_b32 v25, v24
  v_mov_b32 v29, v28
  v_mov_b32 v33, v32
  v_mov_b32 v37, v36
  v_mov_b32 v41, v40
  v_mov_b32 v45, v44
  v_permlane16_swap_b32 v16, v17
  v_permlane16_swap_b32 v20, v21
  v_permlane16_swap_b32 v24, v25
  v_permlane16_swap_b32 v28, v29
  v_permlane16_swap_b32 v32, v33
  v_permlane16_swap_b32 v36, v37
  v_permlane16_swap_b32 v40, v41
  v_permlane16_swap_b32 v44, v45
  v_pk_fma_f32 v[176:177], v[80:81], s[72:73], v[16:17] op_sel_hi:[1,1,0] neg_lo:[0,0,1] neg_hi:[0,0,1]
  v_pk_fma_f32 v[184:185], v[84:85], s[72:73], v[20:21] op_sel_hi:[1,1,0] neg_lo:[0,0,1] neg_hi:[0,0,1]
  v_pk_fma_f32 v[192:193], v[88:89], s[72:73], v[24:25] op_sel_hi:[1,1,0] neg_lo:[0,0,1] neg_hi:[0,0,1]
  v_pk_fma_f32 v[200:201], v[92:93], s[72:73], v[28:29] op_sel_hi:[1,1,0] neg_lo:[0,0,1] neg_hi:[0,0,1]
  v_pk_fma_f32 v[208:209], v[96:97], s[72:73], v[32:33] op_sel_hi:[1,1,0] neg_lo:[0,0,1] neg_hi:[0,0,1]
  v_pk_fma_f32 v[216:217], v[100:101], s[72:73], v[36:37] op_sel_hi:[1,1,0] neg_lo:[0,0,1] neg_hi:[0,0,1]
  v_pk_fma_f32 v[224:225], v[104:105], s[72:73], v[40:41] op_sel_hi:[1,1,0] neg_lo:[0,0,1] neg_hi:[0,0,1]
  v_pk_fma_f32 v[232:233], v[108:109], s[72:73], v[44:45] op_sel_hi:[1,1,0] neg_lo:[0,0,1] neg_hi:[0,0,1]
  v_pk_fma_f32 v[178:179], v[82:83], s[72:73], v[16:17] op_sel_hi:[1,1,0] neg_lo:[0,0,1] neg_hi:[0,0,1]
  v_pk_fma_f32 v[186:187], v[86:87], s[72:73], v[20:21] op_sel_hi:[1,1,0] neg_lo:[0,0,1] neg_hi:[0,0,1]
  v_pk_fma_f32 v[194:195], v[90:91], s[72:73], v[24:25] op_sel_hi:[1,1,0] neg_lo:[0,0,1] neg_hi:[0,0,1]
  v_pk_fma_f32 v[202:203], v[94:95], s[72:73], v[28:29] op_sel_hi:[1,1,0] neg_lo:[0,0,1] neg_hi:[0,0,1]
  v_pk_fma_f32 v[210:211], v[98:99], s[72:73], v[32:33] op_sel_hi:[1,1,0] neg_lo:[0,0,1] neg_hi:[0,0,1]
  v_pk_fma_f32 v[218:219], v[102:103], s[72:73], v[36:37] op_sel_hi:[1,1,0] neg_lo:[0,0,1] neg_hi:[0,0,1]
  v_pk_fma_f32 v[226:227], v[106:107], s[72:73], v[40:41] op_sel_hi:[1,1,0] neg_lo:[0,0,1] neg_hi:[0,0,1]
  v_pk_fma_f32 v[234:235], v[110:111], s[72:73], v[44:45] op_sel_hi:[1,1,0] neg_lo:[0,0,1] neg_hi:[0,0,1]
  v_pk_fma_f32 v[180:181], v[48:49], s[72:73], v[16:17] op_sel_hi:[1,1,0] neg_lo:[0,0,1] neg_hi:[0,0,1]
  v_pk_fma_f32 v[188:189], v[52:53], s[72:73], v[20:21] op_sel_hi:[1,1,0] neg_lo:[0,0,1] neg_hi:[0,0,1]
  v_pk_fma_f32 v[196:197], v[56:57], s[72:73], v[24:25] op_sel_hi:[1,1,0] neg_lo:[0,0,1] neg_hi:[0,0,1]
  v_pk_fma_f32 v[204:205], v[60:61], s[72:73], v[28:29] op_sel_hi:[1,1,0] neg_lo:[0,0,1] neg_hi:[0,0,1]
  v_pk_fma_f32 v[212:213], v[64:65], s[72:73], v[32:33] op_sel_hi:[1,1,0] neg_lo:[0,0,1] neg_hi:[0,0,1]
  v_pk_fma_f32 v[220:221], v[68:69], s[72:73], v[36:37] op_sel_hi:[1,1,0] neg_lo:[0,0,1] neg_hi:[0,0,1]
  v_pk_fma_f32 v[228:229], v[72:73], s[72:73], v[40:41] op_sel_hi:[1,1,0] neg_lo:[0,0,1] neg_hi:[0,0,1]
  v_pk_fma_f32 v[236:237], v[76:77], s[72:73], v[44:45] op_sel_hi:[1,1,0] neg_lo:[0,0,1] neg_hi:[0,0,1]
  v_pk_fma_f32 v[182:183], v[50:51], s[72:73], v[16:17] op_sel_hi:[1,1,0] neg_lo:[0,0,1] neg_hi:[0,0,1]
  v_pk_fma_f32 v[190:191], v[54:55], s[72:73], v[20:21] op_sel_hi:[1,1,0] neg_lo:[0,0,1] neg_hi:[0,0,1]
  v_pk_fma_f32 v[198:199], v[58:59], s[72:73], v[24:25] op_sel_hi:[1,1,0] neg_lo:[0,0,1] neg_hi:[0,0,1]
  v_pk_fma_f32 v[206:207], v[62:63], s[72:73], v[28:29] op_sel_hi:[1,1,0] neg_lo:[0,0,1] neg_hi:[0,0,1]
  v_pk_fma_f32 v[214:215], v[66:67], s[72:73], v[32:33] op_sel_hi:[1,1,0] neg_lo:[0,0,1] neg_hi:[0,0,1]
  v_pk_fma_f32 v[222:223], v[70:71], s[72:73], v[36:37] op_sel_hi:[1,1,0] neg_lo:[0,0,1] neg_hi:[0,0,1]
  v_pk_fma_f32 v[230:231], v[74:75], s[72:73], v[40:41] op_sel_hi:[1,1,0] neg_lo:[0,0,1] neg_hi:[0,0,1]
  v_pk_fma_f32 v[238:239], v[78:79], s[72:73], v[44:45] op_sel_hi:[1,1,0] neg_lo:[0,0,1] neg_hi:[0,0,1]
  v_pk_fma_f32 v[80:81], v[80:81], s[62:63], v[16:17] op_sel:[0,0,1] op_sel_hi:[1,1,1] neg_lo:[0,0,1] neg_hi:[0,0,1]
  v_pk_fma_f32 v[84:85], v[84:85], s[62:63], v[20:21] op_sel:[0,0,1] op_sel_hi:[1,1,1] neg_lo:[0,0,1] neg_hi:[0,0,1]
  v_pk_fma_f32 v[88:89], v[88:89], s[62:63], v[24:25] op_sel:[0,0,1] op_sel_hi:[1,1,1] neg_lo:[0,0,1] neg_hi:[0,0,1]
  v_pk_fma_f32 v[92:93], v[92:93], s[62:63], v[28:29] op_sel:[0,0,1] op_sel_hi:[1,1,1] neg_lo:[0,0,1] neg_hi:[0,0,1]
  v_pk_fma_f32 v[96:97], v[96:97], s[62:63], v[32:33] op_sel:[0,0,1] op_sel_hi:[1,1,1] neg_lo:[0,0,1] neg_hi:[0,0,1]
  v_pk_fma_f32 v[100:101], v[100:101], s[62:63], v[36:37] op_sel:[0,0,1] op_sel_hi:[1,1,1] neg_lo:[0,0,1] neg_hi:[0,0,1]
  v_pk_fma_f32 v[104:105], v[104:105], s[62:63], v[40:41] op_sel:[0,0,1] op_sel_hi:[1,1,1] neg_lo:[0,0,1] neg_hi:[0,0,1]
  v_pk_fma_f32 v[108:109], v[108:109], s[62:63], v[44:45] op_sel:[0,0,1] op_sel_hi:[1,1,1] neg_lo:[0,0,1] neg_hi:[0,0,1]
  v_pk_fma_f32 v[82:83], v[82:83], s[62:63], v[16:17] op_sel:[0,0,1] op_sel_hi:[1,1,1] neg_lo:[0,0,1] neg_hi:[0,0,1]
  v_pk_fma_f32 v[86:87], v[86:87], s[62:63], v[20:21] op_sel:[0,0,1] op_sel_hi:[1,1,1] neg_lo:[0,0,1] neg_hi:[0,0,1]
  v_pk_fma_f32 v[90:91], v[90:91], s[62:63], v[24:25] op_sel:[0,0,1] op_sel_hi:[1,1,1] neg_lo:[0,0,1] neg_hi:[0,0,1]
  v_pk_fma_f32 v[94:95], v[94:95], s[62:63], v[28:29] op_sel:[0,0,1] op_sel_hi:[1,1,1] neg_lo:[0,0,1] neg_hi:[0,0,1]
  v_pk_fma_f32 v[98:99], v[98:99], s[62:63], v[32:33] op_sel:[0,0,1] op_sel_hi:[1,1,1] neg_lo:[0,0,1] neg_hi:[0,0,1]
  v_pk_fma_f32 v[102:103], v[102:103], s[62:63], v[36:37] op_sel:[0,0,1] op_sel_hi:[1,1,1] neg_lo:[0,0,1] neg_hi:[0,0,1]
  v_pk_fma_f32 v[106:107], v[106:107], s[62:63], v[40:41] op_sel:[0,0,1] op_sel_hi:[1,1,1] neg_lo:[0,0,1] neg_hi:[0,0,1]
  v_pk_fma_f32 v[110:111], v[110:111], s[62:63], v[44:45] op_sel:[0,0,1] op_sel_hi:[1,1,1] neg_lo:[0,0,1] neg_hi:[0,0,1]
  v_pk_fma_f32 v[48:49], v[48:49], s[62:63], v[16:17] op_sel:[0,0,1] op_sel_hi:[1,1,1] neg_lo:[0,0,1] neg_hi:[0,0,1]
  v_pk_fma_f32 v[52:53], v[52:53], s[62:63], v[20:21] op_sel:[0,0,1] op_sel_hi:[1,1,1] neg_lo:[0,0,1] neg_hi:[0,0,1]
  v_pk_fma_f32 v[56:57], v[56:57], s[62:63], v[24:25] op_sel:[0,0,1] op_sel_hi:[1,1,1] neg_lo:[0,0,1] neg_hi:[0,0,1]
  v_pk_fma_f32 v[60:61], v[60:61], s[62:63], v[28:29] op_sel:[0,0,1] op_sel_hi:[1,1,1] neg_lo:[0,0,1] neg_hi:[0,0,1]
  v_pk_fma_f32 v[64:65], v[64:65], s[62:63], v[32:33] op_sel:[0,0,1] op_sel_hi:[1,1,1] neg_lo:[0,0,1] neg_hi:[0,0,1]
  v_pk_fma_f32 v[68:69], v[68:69], s[62:63], v[36:37] op_sel:[0,0,1] op_sel_hi:[1,1,1] neg_lo:[0,0,1] neg_hi:[0,0,1]
  v_pk_fma_f32 v[72:73], v[72:73], s[62:63], v[40:41] op_sel:[0,0,1] op_sel_hi:[1,1,1] neg_lo:[0,0,1] neg_hi:[0,0,1]
  v_pk_fma_f32 v[76:77], v[76:77], s[62:63], v[44:45] op_sel:[0,0,1] op_sel_hi:[1,1,1] neg_lo:[0,0,1] neg_hi:[0,0,1]
  v_pk_fma_f32 v[50:51], v[50:51], s[62:63], v[16:17] op_sel:[0,0,1] op_sel_hi:[1,1,1] neg_lo:[0,0,1] neg_hi:[0,0,1]
  v_pk_fma_f32 v[54:55], v[54:55], s[62:63], v[20:21] op_sel:[0,0,1] op_sel_hi:[1,1,1] neg_lo:[0,0,1] neg_hi:[0,0,1]
  v_pk_fma_f32 v[58:59], v[58:59], s[62:63], v[24:25] op_sel:[0,0,1] op_sel_hi:[1,1,1] neg_lo:[0,0,1] neg_hi:[0,0,1]
  v_pk_fma_f32 v[62:63], v[62:63], s[62:63], v[28:29] op_sel:[0,0,1] op_sel_hi:[1,1,1] neg_lo:[0,0,1] neg_hi:[0,0,1]
  v_pk_fma_f32 v[66:67], v[66:67], s[62:63], v[32:33] op_sel:[0,0,1] op_sel_hi:[1,1,1] neg_lo:[0,0,1] neg_hi:[0,0,1]
  v_pk_fma_f32 v[70:71], v[70:71], s[62:63], v[36:37] op_sel:[0,0,1] op_sel_hi:[1,1,1] neg_lo:[0,0,1] neg_hi:[0,0,1]
  v_pk_fma_f32 v[74:75], v[74:75], s[62:63], v[40:41] op_sel:[0,0,1] op_sel_hi:[1,1,1] neg_lo:[0,0,1] neg_hi:[0,0,1]
  v_pk_fma_f32 v[78:79], v[78:79], s[62:63], v[44:45] op_sel:[0,0,1] op_sel_hi:[1,1,1] neg_lo:[0,0,1] neg_hi:[0,0,1]
  v_exp_f32 v176, v176
  v_exp_f32 v184, v184
  v_exp_f32 v192, v192
  v_exp_f32 v200, v200
  v_exp_f32 v208, v208
  v_exp_f32 v216, v216
  v_exp_f32 v224, v224
  v_exp_f32 v232, v232
  v_exp_f32 v177, v177
  v_exp_f32 v185, v185
  v_exp_f32 v193, v193
  v_exp_f32 v201, v201
  v_exp_f32 v209, v209
  v_exp_f32 v217, v217
  v_exp_f32 v225, v225
  v_exp_f32 v233, v233
  v_exp_f32 v178, v178
  v_exp_f32 v186, v186
  v_exp_f32 v194, v194
  v_exp_f32 v202, v202
  v_exp_f32 v210, v210
  v_exp_f32 v218, v218
  v_exp_f32 v226, v226
  v_exp_f32 v234, v234
  v_exp_f32 v179, v179
  v_exp_f32 v187, v187
  v_exp_f32 v195, v195
  v_exp_f32 v203, v203
  v_exp_f32 v211, v211
  v_exp_f32 v219, v219
  v_exp_f32 v227, v227
  v_exp_f32 v235, v235
  v_exp_f32 v180, v180
  v_exp_f32 v188, v188
  v_exp_f32 v196, v196
  v_exp_f32 v204, v204
  v_exp_f32 v212, v212
  v_exp_f32 v220, v220
  v_exp_f32 v228, v228
  v_exp_f32 v236, v236
  v_exp_f32 v181, v181
  v_exp_f32 v189, v189
  v_exp_f32 v197, v197
  v_exp_f32 v205, v205
  v_exp_f32 v213, v213
  v_exp_f32 v221, v221
  v_exp_f32 v229, v229
  v_exp_f32 v237, v237
  v_exp_f32 v182, v182
  v_exp_f32 v190, v190
  v_exp_f32 v198, v198
  v_exp_f32 v206, v206
  v_exp_f32 v214, v214
  v_exp_f32 v222, v222
  v_exp_f32 v230, v230
  v_exp_f32 v238, v238
  v_exp_f32 v183, v183
  v_exp_f32 v191, v191
  v_exp_f32 v199, v199
  v_exp_f32 v207, v207
  v_exp_f32 v215, v215
  v_exp_f32 v223, v223
  v_exp_f32 v231, v231
  v_exp_f32 v239, v239
  v_exp_f32 v80, v80
  v_exp_f32 v84, v84
  v_exp_f32 v88, v88
  v_exp_f32 v92, v92
  v_exp_f32 v96, v96
  v_exp_f32 v100, v100
  v_exp_f32 v104, v104
  v_exp_f32 v108, v108
  v_exp_f32 v81, v81
  v_exp_f32 v85, v85
  v_exp_f32 v89, v89
  v_exp_f32 v93, v93
  v_exp_f32 v97, v97
  v_exp_f32 v101, v101
  v_exp_f32 v105, v105
  v_exp_f32 v109, v109
  v_exp_f32 v82, v82
  v_exp_f32 v86, v86
  v_exp_f32 v90, v90
  v_exp_f32 v94, v94
  v_exp_f32 v98, v98
  v_exp_f32 v102, v102
  v_exp_f32 v106, v106
  v_exp_f32 v110, v110
  v_exp_f32 v83, v83
  v_exp_f32 v87, v87
  v_exp_f32 v91, v91
  v_exp_f32 v95, v95
  v_exp_f32 v99, v99
  v_exp_f32 v103, v103
  v_exp_f32 v107, v107
  v_exp_f32 v111, v111
  s_waitcnt vmcnt(0)
  s_barrier
  v_exp_f32 v48, v48
  v_exp_f32 v52, v52
  v_exp_f32 v56, v56
  v_exp_f32 v60, v60
  v_exp_f32 v64, v64
  v_exp_f32 v68, v68
  v_exp_f32 v72, v72
  v_exp_f32 v76, v76
  v_exp_f32 v49, v49
  v_exp_f32 v53, v53
  v_exp_f32 v57, v57
  v_exp_f32 v61, v61
  v_exp_f32 v65, v65
  v_exp_f32 v69, v69
  v_exp_f32 v73, v73
  v_exp_f32 v77, v77
  v_exp_f32 v50, v50
  v_exp_f32 v54, v54
  v_exp_f32 v58, v58
  v_exp_f32 v62, v62
  v_exp_f32 v66, v66
  v_exp_f32 v70, v70
  v_exp_f32 v74, v74
  v_exp_f32 v78, v78
  v_exp_f32 v51, v51
  v_exp_f32 v55, v55
  v_exp_f32 v59, v59
  v_exp_f32 v63, v63
  v_exp_f32 v67, v67
  v_exp_f32 v71, v71
  v_exp_f32 v75, v75
  v_exp_f32 v79, v79
  v_pk_add_f32 v[16:17], v[176:177], v[178:179]
  v_pk_add_f32 v[20:21], v[184:185], v[186:187]
  v_pk_add_f32 v[24:25], v[192:193], v[194:195]
  v_pk_add_f32 v[28:29], v[200:201], v[202:203]
  v_pk_add_f32 v[32:33], v[208:209], v[210:211]
  v_pk_add_f32 v[36:37], v[216:217], v[218:219]
  v_pk_add_f32 v[40:41], v[224:225], v[226:227]
  v_pk_add_f32 v[44:45], v[232:233], v[234:235]
  v_pk_add_f32 v[18:19], v[80:81], v[82:83]
  v_pk_add_f32 v[22:23], v[84:85], v[86:87]
  v_pk_add_f32 v[26:27], v[88:89], v[90:91]
  v_pk_add_f32 v[30:31], v[92:93], v[94:95]
  v_pk_add_f32 v[34:35], v[96:97], v[98:99]
  v_pk_add_f32 v[38:39], v[100:101], v[102:103]
  v_pk_add_f32 v[42:43], v[104:105], v[106:107]
  v_pk_add_f32 v[46:47], v[108:109], v[110:111]
  v_pk_add_f32 v[16:17], v[16:17], v[180:181]
  v_pk_add_f32 v[20:21], v[20:21], v[188:189]
  v_pk_add_f32 v[24:25], v[24:25], v[196:197]
  v_pk_add_f32 v[28:29], v[28:29], v[204:205]
  v_pk_add_f32 v[32:33], v[32:33], v[212:213]
  v_pk_add_f32 v[36:37], v[36:37], v[220:221]
  v_pk_add_f32 v[40:41], v[40:41], v[228:229]
  v_pk_add_f32 v[44:45], v[44:45], v[236:237]
  v_pk_add_f32 v[18:19], v[18:19], v[48:49]
  v_pk_add_f32 v[22:23], v[22:23], v[52:53]
  v_pk_add_f32 v[26:27], v[26:27], v[56:57]
  v_pk_add_f32 v[30:31], v[30:31], v[60:61]
  v_pk_add_f32 v[34:35], v[34:35], v[64:65]
  v_pk_add_f32 v[38:39], v[38:39], v[68:69]
  v_pk_add_f32 v[42:43], v[42:43], v[72:73]
  v_pk_add_f32 v[46:47], v[46:47], v[76:77]
  v_pk_add_f32 v[16:17], v[16:17], v[182:183]
  v_pk_add_f32 v[20:21], v[20:21], v[190:191]
  v_pk_add_f32 v[24:25], v[24:25], v[198:199]
  v_pk_add_f32 v[28:29], v[28:29], v[206:207]
  v_pk_add_f32 v[32:33], v[32:33], v[214:215]
  v_pk_add_f32 v[36:37], v[36:37], v[222:223]
  v_pk_add_f32 v[40:41], v[40:41], v[230:231]
  v_pk_add_f32 v[44:45], v[44:45], v[238:239]
  v_pk_add_f32 v[18:19], v[18:19], v[50:51]
  v_pk_add_f32 v[22:23], v[22:23], v[54:55]
  v_pk_add_f32 v[26:27], v[26:27], v[58:59]
  v_pk_add_f32 v[30:31], v[30:31], v[62:63]
  v_pk_add_f32 v[34:35], v[34:35], v[66:67]
  v_pk_add_f32 v[38:39], v[38:39], v[70:71]
  v_pk_add_f32 v[42:43], v[42:43], v[74:75]
  v_pk_add_f32 v[46:47], v[46:47], v[78:79]
  v_add_f32 v16, v16, v17
  v_add_f32 v20, v20, v21
  v_add_f32 v24, v24, v25
  v_add_f32 v28, v28, v29
  v_add_f32 v32, v32, v33
  v_add_f32 v36, v36, v37
  v_add_f32 v40, v40, v41
  v_add_f32 v44, v44, v45
  v_add_f32 v17, v18, v19
  v_add_f32 v21, v22, v23
  v_add_f32 v25, v26, v27
  v_add_f32 v29, v30, v31
  v_add_f32 v33, v34, v35
  v_add_f32 v37, v38, v39
  v_add_f32 v41, v42, v43
  v_add_f32 v45, v46, v47
  v_permlane16_swap_b32 v16, v17
  v_permlane16_swap_b32 v20, v21
  v_permlane16_swap_b32 v24, v25
  v_permlane16_swap_b32 v28, v29
  v_permlane16_swap_b32 v32, v33
  v_permlane16_swap_b32 v36, v37
  v_permlane16_swap_b32 v40, v41
  v_permlane16_swap_b32 v44, v45
  v_add_f32 v16, v16, v17
  v_add_f32 v20, v20, v21
  v_add_f32 v24, v24, v25
  v_add_f32 v28, v28, v29
  v_add_f32 v32, v32, v33
  v_add_f32 v36, v36, v37
  v_add_f32 v40, v40, v41
  v_add_f32 v44, v44, v45
  v_mov_b32 v17, v16
  v_mov_b32 v21, v20
  v_mov_b32 v25, v24
  v_mov_b32 v29, v28
  v_mov_b32 v33, v32
  v_mov_b32 v37, v36
  v_mov_b32 v41, v40
  v_mov_b32 v45, v44
  v_permlane32_swap_b32 v16, v17
  v_permlane32_swap_b32 v20, v21
  v_permlane32_swap_b32 v24, v25
  v_permlane32_swap_b32 v28, v29
  v_permlane32_swap_b32 v32, v33
  v_permlane32_swap_b32 v36, v37
  v_permlane32_swap_b32 v40, v41
  v_permlane32_swap_b32 v44, v45
  v_add_f32 v16, v16, v17
  v_add_f32 v20, v20, v21
  v_add_f32 v24, v24, v25
  v_add_f32 v28, v28, v29
  v_add_f32 v32, v32, v33
  v_add_f32 v36, v36, v37
  v_add_f32 v40, v40, v41
  v_add_f32 v44, v44, v45
  v_rcp_f32 v16, v16
  v_rcp_f32 v20, v20
  v_rcp_f32 v24, v24
  v_rcp_f32 v28, v28
  v_rcp_f32 v32, v32
  v_rcp_f32 v36, v36
  v_rcp_f32 v40, v40
  v_rcp_f32 v44, v44
  v_mov_b32 v17, v16
  v_mov_b32 v21, v20
  v_mov_b32 v25, v24
  v_mov_b32 v29, v28
  v_mov_b32 v33, v32
  v_mov_b32 v37, v36
  v_mov_b32 v41, v40
  v_mov_b32 v45, v44
  v_permlane16_swap_b32 v16, v17
  v_permlane16_swap_b32 v20, v21
  v_permlane16_swap_b32 v24, v25
  v_permlane16_swap_b32 v28, v29
  v_permlane16_swap_b32 v32, v33
  v_permlane16_swap_b32 v36, v37
  v_permlane16_swap_b32 v40, v41
  v_permlane16_swap_b32 v44, v45
  v_pk_mul_f32 v[176:177], v[176:177], v[16:17] op_sel_hi:[1,0]
  v_pk_mul_f32 v[184:185], v[184:185], v[20:21] op_sel_hi:[1,0]
  v_pk_mul_f32 v[192:193], v[192:193], v[24:25] op_sel_hi:[1,0]
  v_pk_mul_f32 v[200:201], v[200:201], v[28:29] op_sel_hi:[1,0]
  v_pk_mul_f32 v[208:209], v[208:209], v[32:33] op_sel_hi:[1,0]
  v_pk_mul_f32 v[216:217], v[216:217], v[36:37] op_sel_hi:[1,0]
  v_pk_mul_f32 v[224:225], v[224:225], v[40:41] op_sel_hi:[1,0]
  v_pk_mul_f32 v[232:233], v[232:233], v[44:45] op_sel_hi:[1,0]
  v_pk_mul_f32 v[178:179], v[178:179], v[16:17] op_sel_hi:[1,0]
  v_pk_mul_f32 v[186:187], v[186:187], v[20:21] op_sel_hi:[1,0]
  v_pk_mul_f32 v[194:195], v[194:195], v[24:25] op_sel_hi:[1,0]
  v_pk_mul_f32 v[202:203], v[202:203], v[28:29] op_sel_hi:[1,0]
  v_pk_mul_f32 v[210:211], v[210:211], v[32:33] op_sel_hi:[1,0]
  v_pk_mul_f32 v[218:219], v[218:219], v[36:37] op_sel_hi:[1,0]
  v_pk_mul_f32 v[226:227], v[226:227], v[40:41] op_sel_hi:[1,0]
  v_pk_mul_f32 v[234:235], v[234:235], v[44:45] op_sel_hi:[1,0]
  v_pk_mul_f32 v[180:181], v[180:181], v[16:17] op_sel_hi:[1,0]
  v_pk_mul_f32 v[188:189], v[188:189], v[20:21] op_sel_hi:[1,0]
  v_pk_mul_f32 v[196:197], v[196:197], v[24:25] op_sel_hi:[1,0]
  v_pk_mul_f32 v[204:205], v[204:205], v[28:29] op_sel_hi:[1,0]
  v_pk_mul_f32 v[212:213], v[212:213], v[32:33] op_sel_hi:[1,0]
  v_pk_mul_f32 v[220:221], v[220:221], v[36:37] op_sel_hi:[1,0]
  v_pk_mul_f32 v[228:229], v[228:229], v[40:41] op_sel_hi:[1,0]
  v_pk_mul_f32 v[236:237], v[236:237], v[44:45] op_sel_hi:[1,0]
  v_pk_mul_f32 v[182:183], v[182:183], v[16:17] op_sel_hi:[1,0]
  v_pk_mul_f32 v[190:191], v[190:191], v[20:21] op_sel_hi:[1,0]
  v_pk_mul_f32 v[198:199], v[198:199], v[24:25] op_sel_hi:[1,0]
  v_pk_mul_f32 v[206:207], v[206:207], v[28:29] op_sel_hi:[1,0]
  v_pk_mul_f32 v[214:215], v[214:215], v[32:33] op_sel_hi:[1,0]
  v_pk_mul_f32 v[222:223], v[222:223], v[36:37] op_sel_hi:[1,0]
  v_pk_mul_f32 v[230:231], v[230:231], v[40:41] op_sel_hi:[1,0]
  v_pk_mul_f32 v[238:239], v[238:239], v[44:45] op_sel_hi:[1,0]
  v_pk_mul_f32 v[80:81], v[80:81], v[16:17] op_sel:[0,1] op_sel_hi:[1,1]
  v_pk_mul_f32 v[84:85], v[84:85], v[20:21] op_sel:[0,1] op_sel_hi:[1,1]
  v_pk_mul_f32 v[88:89], v[88:89], v[24:25] op_sel:[0,1] op_sel_hi:[1,1]
  v_pk_mul_f32 v[92:93], v[92:93], v[28:29] op_sel:[0,1] op_sel_hi:[1,1]
  v_pk_mul_f32 v[96:97], v[96:97], v[32:33] op_sel:[0,1] op_sel_hi:[1,1]
  v_pk_mul_f32 v[100:101], v[100:101], v[36:37] op_sel:[0,1] op_sel_hi:[1,1]
  v_pk_mul_f32 v[104:105], v[104:105], v[40:41] op_sel:[0,1] op_sel_hi:[1,1]
  v_pk_mul_f32 v[108:109], v[108:109], v[44:45] op_sel:[0,1] op_sel_hi:[1,1]
  v_pk_mul_f32 v[82:83], v[82:83], v[16:17] op_sel:[0,1] op_sel_hi:[1,1]
  v_pk_mul_f32 v[86:87], v[86:87], v[20:21] op_sel:[0,1] op_sel_hi:[1,1]
  v_pk_mul_f32 v[90:91], v[90:91], v[24:25] op_sel:[0,1] op_sel_hi:[1,1]
  v_pk_mul_f32 v[94:95], v[94:95], v[28:29] op_sel:[0,1] op_sel_hi:[1,1]
  v_pk_mul_f32 v[98:99], v[98:99], v[32:33] op_sel:[0,1] op_sel_hi:[1,1]
  v_pk_mul_f32 v[102:103], v[102:103], v[36:37] op_sel:[0,1] op_sel_hi:[1,1]
  v_pk_mul_f32 v[106:107], v[106:107], v[40:41] op_sel:[0,1] op_sel_hi:[1,1]
  v_pk_mul_f32 v[110:111], v[110:111], v[44:45] op_sel:[0,1] op_sel_hi:[1,1]
  v_pk_mul_f32 v[48:49], v[48:49], v[16:17] op_sel:[0,1] op_sel_hi:[1,1]
  v_pk_mul_f32 v[52:53], v[52:53], v[20:21] op_sel:[0,1] op_sel_hi:[1,1]
  v_pk_mul_f32 v[56:57], v[56:57], v[24:25] op_sel:[0,1] op_sel_hi:[1,1]
  v_pk_mul_f32 v[60:61], v[60:61], v[28:29] op_sel:[0,1] op_sel_hi:[1,1]
  v_pk_mul_f32 v[64:65], v[64:65], v[32:33] op_sel:[0,1] op_sel_hi:[1,1]
  v_pk_mul_f32 v[68:69], v[68:69], v[36:37] op_sel:[0,1] op_sel_hi:[1,1]
  v_pk_mul_f32 v[72:73], v[72:73], v[40:41] op_sel:[0,1] op_sel_hi:[1,1]
  v_pk_mul_f32 v[76:77], v[76:77], v[44:45] op_sel:[0,1] op_sel_hi:[1,1]
  v_pk_mul_f32 v[50:51], v[50:51], v[16:17] op_sel:[0,1] op_sel_hi:[1,1]
  v_pk_mul_f32 v[54:55], v[54:55], v[20:21] op_sel:[0,1] op_sel_hi:[1,1]
  v_pk_mul_f32 v[58:59], v[58:59], v[24:25] op_sel:[0,1] op_sel_hi:[1,1]
  v_pk_mul_f32 v[62:63], v[62:63], v[28:29] op_sel:[0,1] op_sel_hi:[1,1]
  v_pk_mul_f32 v[66:67], v[66:67], v[32:33] op_sel:[0,1] op_sel_hi:[1,1]
  v_pk_mul_f32 v[70:71], v[70:71], v[36:37] op_sel:[0,1] op_sel_hi:[1,1]
  v_pk_mul_f32 v[74:75], v[74:75], v[40:41] op_sel:[0,1] op_sel_hi:[1,1]
  v_pk_mul_f32 v[78:79], v[78:79], v[44:45] op_sel:[0,1] op_sel_hi:[1,1]
  v_cvt_pk_bf16_f32 v176, v176, v177
  v_cvt_pk_bf16_f32 v184, v184, v185
  v_cvt_pk_bf16_f32 v192, v192, v193
  v_cvt_pk_bf16_f32 v200, v200, v201
  v_cvt_pk_bf16_f32 v208, v208, v209
  v_cvt_pk_bf16_f32 v216, v216, v217
  v_cvt_pk_bf16_f32 v224, v224, v225
  v_cvt_pk_bf16_f32 v232, v232, v233
  v_cvt_pk_bf16_f32 v177, v178, v179
  v_cvt_pk_bf16_f32 v185, v186, v187
  v_cvt_pk_bf16_f32 v193, v194, v195
  v_cvt_pk_bf16_f32 v201, v202, v203
  v_cvt_pk_bf16_f32 v209, v210, v211
  v_cvt_pk_bf16_f32 v217, v218, v219
  v_cvt_pk_bf16_f32 v225, v226, v227
  v_cvt_pk_bf16_f32 v233, v234, v235
  v_cvt_pk_bf16_f32 v178, v180, v181
  v_cvt_pk_bf16_f32 v186, v188, v189
  v_cvt_pk_bf16_f32 v194, v196, v197
  v_cvt_pk_bf16_f32 v202, v204, v205
  v_cvt_pk_bf16_f32 v210, v212, v213
  v_cvt_pk_bf16_f32 v218, v220, v221
  v_cvt_pk_bf16_f32 v226, v228, v229
  v_cvt_pk_bf16_f32 v234, v236, v237
  v_cvt_pk_bf16_f32 v179, v182, v183
  v_cvt_pk_bf16_f32 v187, v190, v191
  v_cvt_pk_bf16_f32 v195, v198, v199
  v_cvt_pk_bf16_f32 v203, v206, v207
  v_cvt_pk_bf16_f32 v211, v214, v215
  v_cvt_pk_bf16_f32 v219, v222, v223
  v_cvt_pk_bf16_f32 v227, v230, v231
  v_cvt_pk_bf16_f32 v235, v238, v239
  v_cvt_pk_bf16_f32 v80, v80, v81
  v_cvt_pk_bf16_f32 v84, v84, v85
  v_cvt_pk_bf16_f32 v88, v88, v89
  v_cvt_pk_bf16_f32 v92, v92, v93
  v_cvt_pk_bf16_f32 v96, v96, v97
  v_cvt_pk_bf16_f32 v100, v100, v101
  v_cvt_pk_bf16_f32 v104, v104, v105
  v_cvt_pk_bf16_f32 v108, v108, v109
  v_cvt_pk_bf16_f32 v81, v82, v83
  v_cvt_pk_bf16_f32 v85, v86, v87
  v_cvt_pk_bf16_f32 v89, v90, v91
  v_cvt_pk_bf16_f32 v93, v94, v95
  v_cvt_pk_bf16_f32 v97, v98, v99
  v_cvt_pk_bf16_f32 v101, v102, v103
  v_cvt_pk_bf16_f32 v105, v106, v107
  v_cvt_pk_bf16_f32 v109, v110, v111
  v_cvt_pk_bf16_f32 v82, v48, v49
  v_cvt_pk_bf16_f32 v86, v52, v53
  v_cvt_pk_bf16_f32 v90, v56, v57
  v_cvt_pk_bf16_f32 v94, v60, v61
  v_cvt_pk_bf16_f32 v98, v64, v65
  v_cvt_pk_bf16_f32 v102, v68, v69
  v_cvt_pk_bf16_f32 v106, v72, v73
  v_cvt_pk_bf16_f32 v110, v76, v77
  v_cvt_pk_bf16_f32 v83, v50, v51
  v_cvt_pk_bf16_f32 v87, v54, v55
  v_cvt_pk_bf16_f32 v91, v58, v59
  v_cvt_pk_bf16_f32 v95, v62, v63
  v_cvt_pk_bf16_f32 v99, v66, v67
  v_cvt_pk_bf16_f32 v103, v70, v71
  v_cvt_pk_bf16_f32 v107, v74, v75
  v_cvt_pk_bf16_f32 v111, v78, v79
  v_accvgpr_write_b32 a0, v176
  v_accvgpr_write_b32 a4, v80
  v_accvgpr_write_b32 a1, v177
  v_accvgpr_write_b32 a5, v81
  v_accvgpr_write_b32 a2, v178
  v_accvgpr_write_b32 a6, v82
  v_accvgpr_write_b32 a3, v179
  v_accvgpr_write_b32 a7, v83
  v_accvgpr_write_b32 a8, v184
  v_accvgpr_write_b32 a12, v84
  v_accvgpr_write_b32 a9, v185
  v_accvgpr_write_b32 a13, v85
  v_accvgpr_write_b32 a10, v186
  v_accvgpr_write_b32 a14, v86
  v_accvgpr_write_b32 a11, v187
  v_accvgpr_write_b32 a15, v87
  v_accvgpr_write_b32 a16, v192
  v_accvgpr_write_b32 a20, v88
  v_accvgpr_write_b32 a17, v193
  v_accvgpr_write_b32 a21, v89
  v_accvgpr_write_b32 a18, v194
  v_accvgpr_write_b32 a22, v90
  v_accvgpr_write_b32 a19, v195
  v_accvgpr_write_b32 a23, v91
  v_accvgpr_write_b32 a24, v200
  v_accvgpr_write_b32 a28, v92
  v_accvgpr_write_b32 a25, v201
  v_accvgpr_write_b32 a29, v93
  v_accvgpr_write_b32 a26, v202
  v_accvgpr_write_b32 a30, v94
  v_accvgpr_write_b32 a27, v203
  v_accvgpr_write_b32 a31, v95
  s_lshr_b32 s70, s3, 1
  s_lshl_b32 s70, s70, 13
  v_add_u32 v3, s70, v2
  v_add_u32 v3, 65536, v3
  ds_write_b128 v3, v[208:211] offset:0
  ds_write_b128 v3, v[96:99] offset:1024
  ds_write_b128 v3, v[216:219] offset:2048
  ds_write_b128 v3, v[100:103] offset:3072
  ds_write_b128 v3, v[224:227] offset:4096
  ds_write_b128 v3, v[104:107] offset:5120
  ds_write_b128 v3, v[232:235] offset:6144
  ds_write_b128 v3, v[108:111] offset:7168
  s_cmp_eq_u32 s3, 3
  s_cbranch_scc0 L_parallel_sum__linear_kernel_hedgehog__glu_gated_reglu__prompt_kernel_cr
  s_getpc_b64 s[86:87]
L_parallel_sum__linear_kernel_hedgehog__glu_gated_reglu__prompt_kernel_cr_pc:
  s_sub_u32 s86, s86, L_parallel_sum__linear_kernel_hedgehog__glu_gated_reglu__prompt_kernel_cr_pc - parallel_sum__linear_kernel_hedgehog__glu_gated_reglu__prompt_kernel
  s_subb_u32 s87, s87, 0
  s_lshr_b32 s88, s2, 3
  s_mul_i32 s88, s88, 24*128
  v_lshlrev_b32 v60, 7, v1
  v_add_u32 v60, s88, v60
  v_cmp_gt_u32 vcc, 24, v1
  s_nop 3
  s_and_saveexec_b64 s[88:89], vcc
  v_cmp_gt_u32 vcc, L_parallel_sum__linear_kernel_hedgehog__glu_gated_reglu__prompt_kernel_done - parallel_sum__linear_kernel_hedgehog__glu_gated_reglu__prompt_kernel, v60
  s_nop 3
  s_and_b64 exec, exec, vcc
  s_cbranch_execz L_parallel_sum__linear_kernel_hedgehog__glu_gated_reglu__prompt_kernel_cr_x
  global_load_dword v61, v60, s[86:87]
L_parallel_sum__linear_kernel_hedgehog__glu_gated_reglu__prompt_kernel_cr_x:
  s_mov_b64 exec, s[88:89]
L_parallel_sum__linear_kernel_hedgehog__glu_gated_reglu__prompt_kernel_cr:
  s_and_b32 s70, s2, 3
  s_lshr_b32 s71, s2, 5
  v_lshrrev_b32 v6, 4, v1
  s_and_b32 s64, s3, 1
  s_lshl_b32 s64, s64, 2
  v_add_u32 v5, s64, v6
  v_bfe_u32 v7, v1, 1, 3
  v_xor_b32 v7, v7, v5
  v_and_b32 v8, 1, v1
  v_lshl_add_u32 v7, v7, 1, v8
  v_lshlrev_b32 v7, 4, v7
  v_lshl_add_u32 v7, v6, 11, v7
  s_lshl_b32 s64, s71, 8
  v_add_u32 v10, s64, v7
  s_mov_b32 s12, s54
  s_and_b32 s13, s55, 0xffff
  s_mov_b32 s14, 0x700000
  s_mov_b32 s15, 0x20000
  s_lshl_b32 s64, s3, 13
  s_mul_i32 s69, s70, 1835008
  s_add_u32 s29, s69, s64
  s_mul_i32 s69, s70, 524288
  s_add_u32 s65, s69, s64
  s_and_b32 s66, s47, 0xffff
  s_mov_b32 s67, 2097152
  s_lshl_b32 s68, s3, 10
  s_mov_b32 s30, 0
  v_xor_b32 v9, 128, v10
  s_sub_u32 s70, s29, 8192
  s_sub_u32 s71, s68, 1024
  s_add_u32 m0, s68, 0
  s_nop 0
  buffer_load_dwordx4 v10, s[12:15], s29 offen lds
  s_add_u32 m0, s71, 0
  s_add_u32 s29, s29, 32768
  buffer_load_dwordx4 v9, s[12:15], s70 offen lds
  s_add_u32 s70, s70, 32768
  s_add_u32 m0, s68, 4096
  s_nop 0
  buffer_load_dwordx4 v10, s[12:15], s29 offen lds
  s_add_u32 m0, s71, 4096
  s_add_u32 s29, s29, 32768
  buffer_load_dwordx4 v9, s[12:15], s70 offen lds
  s_add_u32 s70, s70, 32768
  s_add_u32 m0, s68, 8192
  s_nop 0
  buffer_load_dwordx4 v10, s[12:15], s29 offen lds
  s_add_u32 m0, s71, 8192
  s_add_u32 s29, s29, 32768
  buffer_load_dwordx4 v9, s[12:15], s70 offen lds
  s_add_u32 s70, s70, 32768
  s_add_u32 m0, s68, 12288
  s_nop 0
  buffer_load_dwordx4 v10, s[12:15], s29 offen lds
  s_add_u32 m0, s71, 12288
  s_add_u32 s29, s29, 32768
  buffer_load_dwordx4 v9, s[12:15], s70 offen lds
  s_add_u32 s70, s70, 32768
  s_add_u32 m0, s68, 16384
  s_nop 0
  buffer_load_dwordx4 v10, s[12:15], s29 offen lds
  s_add_u32 m0, s71, 16384
  s_add_u32 s29, s29, 32768
  buffer_load_dwordx4 v9, s[12:15], s70 offen lds
  s_add_u32 s70, s70, 32768
  s_add_u32 m0, s68, 20480
  s_nop 0
  buffer_load_dwordx4 v10, s[12:15], s29 offen lds
  s_add_u32 m0, s71, 20480
  s_add_u32 s29, s29, 32768
  buffer_load_dwordx4 v9, s[12:15], s70 offen lds
  s_add_u32 s70, s70, 32768
  s_add_u32 m0, s68, 24576
  s_nop 0
  buffer_load_dwordx4 v10, s[12:15], s29 offen lds
  s_add_u32 m0, s71, 24576
  s_add_u32 s29, s29, 32768
  buffer_load_dwordx4 v9, s[12:15], s70 offen lds
  s_add_u32 s70, s70, 32768
  s_add_u32 m0, s68, 28672
  s_nop 0
  buffer_load_dwordx4 v10, s[12:15], s29 offen lds
  s_add_u32 m0, s71, 28672
  s_add_u32 s29, s29, 32768
  buffer_load_dwordx4 v9, s[12:15], s70 offen lds
  s_add_u32 s70, s70, 32768
  s_add_u32 m0, s68, 32768
  s_nop 0
  buffer_load_dwordx4 v10, s[12:15], s29 offen lds
  s_add_u32 m0, s71, 32768
  s_add_u32 s29, s29, 32768
  buffer_load_dwordx4 v9, s[12:15], s70 offen lds
  s_add_u32 s70, s70, 32768
  s_add_u32 m0, s68, 36864
  s_nop 0
  buffer_load_dwordx4 v10, s[12:15], s29 offen lds
  s_add_u32 m0, s71, 36864
  s_add_u32 s29, s29, 32768
  buffer_load_dwordx4 v9, s[12:15], s70 offen lds
  s_add_u32 s70, s70, 32768
  s_add_u32 m0, s68, 40960
  s_nop 0
  buffer_load_dwordx4 v10, s[12:15], s29 offen lds
  s_add_u32 m0, s71, 40960
  s_add_u32 s29, s29, 32768
  buffer_load_dwordx4 v9, s[12:15], s70 offen lds
  s_add_u32 s70, s70, 32768
  s_add_u32 m0, s68, 45056
  s_nop 0
  buffer_load_dwordx4 v10, s[12:15], s29 offen lds
  s_add_u32 m0, s71, 45056
  s_add_u32 s29, s29, 32768
  buffer_load_dwordx4 v9, s[12:15], s70 offen lds
  s_add_u32 s70, s70, 32768
  s_bfe_u32 s88, s2, 0x10002
  s_lshl_b32 s88, s88, 2
  s_bfe_u32 s70, s2, 0x20003
  s_add_u32 s88, s88, s70
  s_lshl_b32 s88, s88, 2
  s_and_b32 s70, s2, 3
  s_add_u32 s88, s88, s70
  s_lshl_b32 s88, s88, 7
  s_add_u32 s88, s88, 4096
  s_mov_b64 s[86:87], exec
  s_mov_b64 exec, 1
  v_mov_b32 v17, 0
  s_mov_b32 s71, 0
L_parallel_sum__linear_kernel_hedgehog__glu_gated_reglu__prompt_kernel_e1_hr:
  buffer_load_dword v18, v17, s[24:27], s88 offen sc1
  s_waitcnt vmcnt(0)
  v_readfirstlane_b32 s70, v18
  s_add_u32 s71, s71, 1
  s_nop 2
  s_cmp_ge_u32 s70, 8
  s_cbranch_scc1 L_parallel_sum__linear_kernel_hedgehog__glu_gated_reglu__prompt_kernel_e1_hr_ok
  s_cmp_ge_u32 s71, 1048576
  s_cbranch_scc1 L_parallel_sum__linear_kernel_hedgehog__glu_gated_reglu__prompt_kernel_e1_hr_ok
  s_sleep 1
  s_branch L_parallel_sum__linear_kernel_hedgehog__glu_gated_reglu__prompt_kernel_e1_hr
L_parallel_sum__linear_kernel_hedgehog__glu_gated_reglu__prompt_kernel_e1_hr_ok:
  s_mov_b64 exec, s[86:87]
  s_and_b32 s6, s2, 3
  s_bfe_u32 s4, s2, 0x10002
  s_lshl_b32 s4, s4, 2
  s_bfe_u32 s7, s2, 0x20003
  s_add_u32 s4, s4, s7
  s_lshr_b32 s5, s2, 5
  v_lshlrev_b32 v2, 4, v1
  v_add_u32 v3, 0x24000, v2
  v_add_u32 v4, 0x48000, v2
  v_add_u32 v5, 0x6c000, v2
  v_mov_b32 v0, 0
  s_lshl_b32 s7, s4, 4
  s_lshl_b32 s64, s3, 2
  s_add_u32 s7, s7, s64
  s_mul_i32 s7, s7, 144
  s_mul_i32 s64, s6, 28
  s_add_u32 s7, s7, s64
  s_lshl_b32 s28, s7, 10
  s_mul_i32 s64, s6, 20
  s_sub_u32 s34, 84, s64
  s_lshl_b32 s34, s34, 10
  s_lshl_b32 s7, s4, 2
  s_add_u32 s7, s7, s6
  s_lshl_b32 s7, s7, 7
  s_add_u32 s35, s7, 8192
  buffer_load_dwordx4 a[192:195], v2, s[8:11], s28 offen sc1
  buffer_load_dwordx4 a[196:199], v3, s[8:11], s28 offen sc1
  buffer_load_dwordx4 a[200:203], v4, s[8:11], s28 offen sc1
  buffer_load_dwordx4 a[204:207], v5, s[8:11], s28 offen sc1
  s_add_u32 s28, s28, 1024
  buffer_load_dwordx4 a[208:211], v2, s[8:11], s28 offen sc1
  buffer_load_dwordx4 a[212:215], v3, s[8:11], s28 offen sc1
  buffer_load_dwordx4 a[216:219], v4, s[8:11], s28 offen sc1
  buffer_load_dwordx4 a[220:223], v5, s[8:11], s28 offen sc1
  s_add_u32 s28, s28, 1024
  buffer_load_dwordx4 a[224:227], v2, s[8:11], s28 offen sc1
  buffer_load_dwordx4 a[228:231], v3, s[8:11], s28 offen sc1
  buffer_load_dwordx4 a[232:235], v4, s[8:11], s28 offen sc1
  buffer_load_dwordx4 a[236:239], v5, s[8:11], s28 offen sc1
  s_add_u32 s28, s28, 1024
  s_mov_b32 s84, 1
  s_barrier
  s_branch L_parallel_sum__linear_kernel_hedgehog__glu_gated_reglu__prompt_kernel_g2
L_parallel_sum__linear_kernel_hedgehog__glu_gated_reglu__prompt_kernel_g2:
  s_cmp_ge_u32 s84, 1
  s_cbranch_scc1 L_parallel_sum__linear_kernel_hedgehog__glu_gated_reglu__prompt_kernel_lx
  s_bfe_u32 s88, s2, 0x10002
  s_lshl_b32 s88, s88, 2
  s_bfe_u32 s70, s2, 0x20003
  s_add_u32 s88, s88, s70
  s_lshl_b32 s88, s88, 2
  s_and_b32 s70, s2, 3
  s_add_u32 s88, s88, s70
  s_lshl_b32 s88, s88, 7
  s_add_u32 s88, s88, 4096
  s_mov_b64 s[86:87], exec
  s_mov_b64 exec, 1
  v_mov_b32 v17, 0
  s_mov_b32 s71, 0
L_parallel_sum__linear_kernel_hedgehog__glu_gated_reglu__prompt_kernel_lx_p:
  buffer_load_dword v18, v17, s[24:27], s88 offen sc1
  s_waitcnt vmcnt(0)
  v_readfirstlane_b32 s70, v18
  s_add_u32 s71, s71, 1
  s_nop 2
  s_cmp_ge_u32 s70, 8
  s_cbranch_scc1 L_parallel_sum__linear_kernel_hedgehog__glu_gated_reglu__prompt_kernel_lx_p_ok
  s_cmp_ge_u32 s71, 1048576
  s_cbranch_scc1 L_parallel_sum__linear_kernel_hedgehog__glu_gated_reglu__prompt_kernel_lx_p_ok
  s_sleep 1
  s_branch L_parallel_sum__linear_kernel_hedgehog__glu_gated_reglu__prompt_kernel_lx_p
L_parallel_sum__linear_kernel_hedgehog__glu_gated_reglu__prompt_kernel_lx_p_ok:
  s_mov_b64 exec, s[86:87]
  s_and_b32 s6, s2, 3
  s_bfe_u32 s4, s2, 0x10002
  s_lshl_b32 s4, s4, 2
  s_bfe_u32 s7, s2, 0x20003
  s_add_u32 s4, s4, s7
  s_lshr_b32 s5, s2, 5
  v_lshlrev_b32 v2, 4, v1
  v_add_u32 v3, 0x24000, v2
  v_add_u32 v4, 0x48000, v2
  v_add_u32 v5, 0x6c000, v2
  v_mov_b32 v0, 0
  s_lshl_b32 s7, s4, 4
  s_lshl_b32 s64, s3, 2
  s_add_u32 s7, s7, s64
  s_mul_i32 s7, s7, 144
  s_mul_i32 s64, s6, 28
  s_add_u32 s7, s7, s64
  s_lshl_b32 s28, s7, 10
  s_mul_i32 s64, s6, 20
  s_sub_u32 s34, 84, s64
  s_lshl_b32 s34, s34, 10
  s_lshl_b32 s7, s4, 2
  s_add_u32 s7, s7, s6
  s_lshl_b32 s7, s7, 7
  s_add_u32 s35, s7, 8192
  buffer_load_dwordx4 a[192:195], v2, s[8:11], s28 offen sc1
  buffer_load_dwordx4 a[196:199], v3, s[8:11], s28 offen sc1
  buffer_load_dwordx4 a[200:203], v4, s[8:11], s28 offen sc1
  buffer_load_dwordx4 a[204:207], v5, s[8:11], s28 offen sc1
  s_add_u32 s28, s28, 1024
  buffer_load_dwordx4 a[208:211], v2, s[8:11], s28 offen sc1
  buffer_load_dwordx4 a[212:215], v3, s[8:11], s28 offen sc1
  buffer_load_dwordx4 a[216:219], v4, s[8:11], s28 offen sc1
  buffer_load_dwordx4 a[220:223], v5, s[8:11], s28 offen sc1
  s_add_u32 s28, s28, 1024
  buffer_load_dwordx4 a[224:227], v2, s[8:11], s28 offen sc1
  buffer_load_dwordx4 a[228:231], v3, s[8:11], s28 offen sc1
  buffer_load_dwordx4 a[232:235], v4, s[8:11], s28 offen sc1
  buffer_load_dwordx4 a[236:239], v5, s[8:11], s28 offen sc1
  s_add_u32 s28, s28, 1024
L_parallel_sum__linear_kernel_hedgehog__glu_gated_reglu__prompt_kernel_lx:
  v_lshrrev_b32 v17, 4, v1
  v_bfe_u32 v18, v1, 2, 2
  v_lshl_add_u32 v18, v17, 2, v18
  v_and_b32 v19, 7, v18
  v_lshlrev_b32 v18, 8, v18
  v_and_b32 v20, 3, v1
  v_lshl_add_u32 v18, v20, 3, v18
  v_xor_b32 v20, 0, v19
  v_lshl_add_u32 v8, v20, 5, v18
  v_xor_b32 v20, 1, v19
  v_lshl_add_u32 v9, v20, 5, v18
  v_xor_b32 v20, 2, v19
  v_lshl_add_u32 v11, v20, 5, v18
  v_xor_b32 v20, 3, v19
  v_lshl_add_u32 v12, v20, 5, v18
  v_xor_b32 v20, 4, v19
  v_lshl_add_u32 v13, v20, 5, v18
  v_xor_b32 v20, 5, v19
  v_lshl_add_u32 v14, v20, 5, v18
  v_xor_b32 v20, 6, v19
  v_lshl_add_u32 v15, v20, 5, v18
  v_xor_b32 v20, 7, v19
  v_lshl_add_u32 v62, v20, 5, v18
  s_mov_b32 s31, 0
  s_mov_b32 s36, 16384
  s_mov_b32 s37, 0xffff4000
  s_waitcnt vmcnt(0)
  s_barrier
  s_cmp_eq_u32 s3, 0
  s_cbranch_scc0 L_parallel_sum__linear_kernel_hedgehog__glu_gated_reglu__prompt_kernel_hp
  v_mov_b32 v16, 1
  s_mov_b64 s[70:71], exec
  s_mov_b64 exec, 1
  buffer_atomic_add v16, v0, s[24:27], s74 offen sc1
  s_mov_b64 exec, s[70:71]
L_parallel_sum__linear_kernel_hedgehog__glu_gated_reglu__prompt_kernel_hp:
  ds_read_b64_tr_b16 v[64:65], v8 offset:0
  ds_read_b64_tr_b16 v[66:67], v8 offset:4096
  ds_read_b64_tr_b16 v[68:69], v9 offset:0
  ds_read_b64_tr_b16 v[70:71], v9 offset:4096
  ds_read_b64_tr_b16 v[72:73], v11 offset:0
  ds_read_b64_tr_b16 v[74:75], v11 offset:4096
  ds_read_b64_tr_b16 v[76:77], v12 offset:0
  ds_read_b64_tr_b16 v[78:79], v12 offset:4096
  ds_read_b64_tr_b16 v[80:81], v13 offset:0
  ds_read_b64_tr_b16 v[82:83], v13 offset:4096
  ds_read_b64_tr_b16 v[84:85], v14 offset:0
  ds_read_b64_tr_b16 v[86:87], v14 offset:4096
  ds_read_b64_tr_b16 v[88:89], v15 offset:0
  ds_read_b64_tr_b16 v[90:91], v15 offset:4096
  ds_read_b64_tr_b16 v[92:93], v62 offset:0
  ds_read_b64_tr_b16 v[94:95], v62 offset:4096
  s_waitcnt vmcnt(8) lgkmcnt(0)
  v_mfma_f32_16x16x32_bf16 v[128:131], v[64:67], a[192:195], 0
  buffer_load_dwordx4 a[240:243], v2, s[8:11], s28 offen sc1
  v_mfma_f32_16x16x32_bf16 v[132:135], v[64:67], a[196:199], 0
  ds_read_b64_tr_b16 v[96:97], v8 offset:8192
  v_mfma_f32_16x16x32_bf16 v[136:139], v[64:67], a[200:203], 0
  ds_read_b64_tr_b16 v[98:99], v8 offset:12288
  v_mfma_f32_16x16x32_bf16 v[140:143], v[64:67], a[204:207], 0
  buffer_load_dwordx4 a[244:247], v3, s[8:11], s28 offen sc1
  v_mfma_f32_16x16x32_bf16 v[156:159], v[68:71], a[204:207], 0
  ds_read_b64_tr_b16 v[100:101], v9 offset:8192
  v_mfma_f32_16x16x32_bf16 v[152:155], v[68:71], a[200:203], 0
  buffer_load_dwordx4 a[248:251], v4, s[8:11], s28 offen sc1
  v_mfma_f32_16x16x32_bf16 v[148:151], v[68:71], a[196:199], 0
  ds_read_b64_tr_b16 v[102:103], v9 offset:12288
  v_mfma_f32_16x16x32_bf16 v[144:147], v[68:71], a[192:195], 0
  v_mfma_f32_16x16x32_bf16 v[160:163], v[72:75], a[192:195], 0
  ds_read_b64_tr_b16 v[104:105], v11 offset:8192
  v_mfma_f32_16x16x32_bf16 v[164:167], v[72:75], a[196:199], 0
  buffer_load_dwordx4 a[252:255], v5, s[8:11], s28 offen sc1
  v_mfma_f32_16x16x32_bf16 v[168:171], v[72:75], a[200:203], 0
  ds_read_b64_tr_b16 v[106:107], v11 offset:12288
  v_mfma_f32_16x16x32_bf16 v[172:175], v[72:75], a[204:207], 0
  s_add_u32 s28, s28, 1024
  v_mfma_f32_16x16x32_bf16 v[188:191], v[76:79], a[204:207], 0
  ds_read_b64_tr_b16 v[108:109], v12 offset:8192
  v_mfma_f32_16x16x32_bf16 v[184:187], v[76:79], a[200:203], 0
  ds_read_b64_tr_b16 v[110:111], v12 offset:12288
  v_mfma_f32_16x16x32_bf16 v[180:183], v[76:79], a[196:199], 0
  s_add_u32 m0, s68, 49152
  v_mfma_f32_16x16x32_bf16 v[176:179], v[76:79], a[192:195], 0
  v_mfma_f32_16x16x32_bf16 v[192:195], v[80:83], a[192:195], 0
  ds_read_b64_tr_b16 v[112:113], v13 offset:8192
  v_mfma_f32_16x16x32_bf16 v[196:199], v[80:83], a[196:199], 0
  buffer_load_dwordx4 v10, s[12:15], s29 offen lds
  v_mfma_f32_16x16x32_bf16 v[200:203], v[80:83], a[200:203], 0
  ds_read_b64_tr_b16 v[114:115], v13 offset:12288
  v_mfma_f32_16x16x32_bf16 v[204:207], v[80:83], a[204:207], 0
  ds_read_b64_tr_b16 v[116:117], v14 offset:8192
  v_mfma_f32_16x16x32_bf16 v[220:223], v[84:87], a[204:207], 0
  s_add_u32 s29, s29, 32768
  v_mfma_f32_16x16x32_bf16 v[216:219], v[84:87], a[200:203], 0
  ds_read_b64_tr_b16 v[118:119], v14 offset:12288
  v_mfma_f32_16x16x32_bf16 v[212:215], v[84:87], a[196:199], 0
  s_add_u32 m0, s68, 53248
  v_mfma_f32_16x16x32_bf16 v[208:211], v[84:87], a[192:195], 0
  v_mfma_f32_16x16x32_bf16 v[224:227], v[88:91], a[192:195], 0
  ds_read_b64_tr_b16 v[120:121], v15 offset:8192
  v_mfma_f32_16x16x32_bf16 v[228:231], v[88:91], a[196:199], 0
  ds_read_b64_tr_b16 v[122:123], v15 offset:12288
  v_mfma_f32_16x16x32_bf16 v[232:235], v[88:91], a[200:203], 0
  buffer_load_dwordx4 v10, s[12:15], s29 offen lds
  v_mfma_f32_16x16x32_bf16 v[236:239], v[88:91], a[204:207], 0
  ds_read_b64_tr_b16 v[124:125], v62 offset:8192
  v_mfma_f32_16x16x32_bf16 v[252:255], v[92:95], a[204:207], 0
  s_add_u32 s29, s29, 32768
  v_mfma_f32_16x16x32_bf16 v[248:251], v[92:95], a[200:203], 0
  ds_read_b64_tr_b16 v[126:127], v62 offset:12288
  v_mfma_f32_16x16x32_bf16 v[244:247], v[92:95], a[196:199], 0
  v_mfma_f32_16x16x32_bf16 v[240:243], v[92:95], a[192:195], 0
  s_waitcnt vmcnt(10) lgkmcnt(0)
  s_barrier
  v_mfma_f32_16x16x32_bf16 v[128:131], v[96:99], a[208:211], v[128:131]
  buffer_load_dwordx4 a[192:195], v2, s[8:11], s28 offen sc1
  v_mfma_f32_16x16x32_bf16 v[132:135], v[96:99], a[212:215], v[132:135]
  ds_read_b64_tr_b16 v[64:65], v8 offset:16384
  v_mfma_f32_16x16x32_bf16 v[136:139], v[96:99], a[216:219], v[136:139]
  ds_read_b64_tr_b16 v[66:67], v8 offset:20480
  v_mfma_f32_16x16x32_bf16 v[140:143], v[96:99], a[220:223], v[140:143]
  buffer_load_dwordx4 a[196:199], v3, s[8:11], s28 offen sc1
  v_mfma_f32_16x16x32_bf16 v[156:159], v[100:103], a[220:223], v[156:159]
  ds_read_b64_tr_b16 v[68:69], v9 offset:16384
  v_mfma_f32_16x16x32_bf16 v[152:155], v[100:103], a[216:219], v[152:155]
  buffer_load_dwordx4 a[200:203], v4, s[8:11], s28 offen sc1
  v_mfma_f32_16x16x32_bf16 v[148:151], v[100:103], a[212:215], v[148:151]
  ds_read_b64_tr_b16 v[70:71], v9 offset:20480
  v_mfma_f32_16x16x32_bf16 v[144:147], v[100:103], a[208:211], v[144:147]
  v_mfma_f32_16x16x32_bf16 v[160:163], v[104:107], a[208:211], v[160:163]
  ds_read_b64_tr_b16 v[72:73], v11 offset:16384
  v_mfma_f32_16x16x32_bf16 v[164:167], v[104:107], a[212:215], v[164:167]
  buffer_load_dwordx4 a[204:207], v5, s[8:11], s28 offen sc1
  v_mfma_f32_16x16x32_bf16 v[168:171], v[104:107], a[216:219], v[168:171]
  ds_read_b64_tr_b16 v[74:75], v11 offset:20480
  v_mfma_f32_16x16x32_bf16 v[172:175], v[104:107], a[220:223], v[172:175]
  s_add_u32 s28, s28, 1024
  v_mfma_f32_16x16x32_bf16 v[188:191], v[108:111], a[220:223], v[188:191]
  ds_read_b64_tr_b16 v[76:77], v12 offset:16384
  v_mfma_f32_16x16x32_bf16 v[184:187], v[108:111], a[216:219], v[184:187]
  ds_read_b64_tr_b16 v[78:79], v12 offset:20480
  v_mfma_f32_16x16x32_bf16 v[180:183], v[108:111], a[212:215], v[180:183]
  s_add_u32 m0, s68, 57344
  v_mfma_f32_16x16x32_bf16 v[176:179], v[108:111], a[208:211], v[176:179]
  v_mfma_f32_16x16x32_bf16 v[192:195], v[112:115], a[208:211], v[192:195]
  ds_read_b64_tr_b16 v[80:81], v13 offset:16384
  v_mfma_f32_16x16x32_bf16 v[196:199], v[112:115], a[212:215], v[196:199]
  buffer_load_dwordx4 v10, s[12:15], s29 offen lds
  v_mfma_f32_16x16x32_bf16 v[200:203], v[112:115], a[216:219], v[200:203]
  ds_read_b64_tr_b16 v[82:83], v13 offset:20480
  v_mfma_f32_16x16x32_bf16 v[204:207], v[112:115], a[220:223], v[204:207]
  ds_read_b64_tr_b16 v[84:85], v14 offset:16384
  v_mfma_f32_16x16x32_bf16 v[220:223], v[116:119], a[220:223], v[220:223]
  s_add_u32 s29, s29, 32768
  v_mfma_f32_16x16x32_bf16 v[216:219], v[116:119], a[216:219], v[216:219]
  ds_read_b64_tr_b16 v[86:87], v14 offset:20480
  v_mfma_f32_16x16x32_bf16 v[212:215], v[116:119], a[212:215], v[212:215]
  s_add_u32 m0, s68, 61440
  v_mfma_f32_16x16x32_bf16 v[208:211], v[116:119], a[208:211], v[208:211]
  v_mfma_f32_16x16x32_bf16 v[224:227], v[120:123], a[208:211], v[224:227]
  ds_read_b64_tr_b16 v[88:89], v15 offset:16384
  v_mfma_f32_16x16x32_bf16 v[228:231], v[120:123], a[212:215], v[228:231]
  ds_read_b64_tr_b16 v[90:91], v15 offset:20480
  v_mfma_f32_16x16x32_bf16 v[232:235], v[120:123], a[216:219], v[232:235]
  buffer_load_dwordx4 v10, s[12:15], s29 offen lds
  v_mfma_f32_16x16x32_bf16 v[236:239], v[120:123], a[220:223], v[236:239]
  ds_read_b64_tr_b16 v[92:93], v62 offset:16384
  v_mfma_f32_16x16x32_bf16 v[252:255], v[124:127], a[220:223], v[252:255]
  s_add_u32 s29, s29, 32768
  v_mfma_f32_16x16x32_bf16 v[248:251], v[124:127], a[216:219], v[248:251]
  ds_read_b64_tr_b16 v[94:95], v62 offset:20480
  v_mfma_f32_16x16x32_bf16 v[244:247], v[124:127], a[212:215], v[244:247]
  v_mfma_f32_16x16x32_bf16 v[240:243], v[124:127], a[208:211], v[240:243]
  s_waitcnt vmcnt(12) lgkmcnt(0)
  v_mfma_f32_16x16x32_bf16 v[128:131], v[64:67], a[224:227], v[128:131]
  buffer_load_dword v17, v0, s[24:27], s74 offen sc1
  v_mfma_f32_16x16x32_bf16 v[132:135], v[64:67], a[228:231], v[132:135]
  ds_read_b64_tr_b16 v[96:97], v8 offset:24576
  v_mfma_f32_16x16x32_bf16 v[136:139], v[64:67], a[232:235], v[136:139]
  ds_read_b64_tr_b16 v[98:99], v8 offset:28672
  v_mfma_f32_16x16x32_bf16 v[140:143], v[64:67], a[236:239], v[140:143]
  buffer_load_dwordx4 a[208:211], v2, s[8:11], s28 offen sc1
  v_mfma_f32_16x16x32_bf16 v[156:159], v[68:71], a[236:239], v[156:159]
  ds_read_b64_tr_b16 v[100:101], v9 offset:24576
  v_mfma_f32_16x16x32_bf16 v[152:155], v[68:71], a[232:235], v[152:155]
  buffer_load_dwordx4 a[212:215], v3, s[8:11], s28 offen sc1
  v_mfma_f32_16x16x32_bf16 v[148:151], v[68:71], a[228:231], v[148:151]
  ds_read_b64_tr_b16 v[102:103], v9 offset:28672
  v_mfma_f32_16x16x32_bf16 v[144:147], v[68:71], a[224:227], v[144:147]
  buffer_load_dwordx4 a[216:219], v4, s[8:11], s28 offen sc1
  v_mfma_f32_16x16x32_bf16 v[160:163], v[72:75], a[224:227], v[160:163]
  ds_read_b64_tr_b16 v[104:105], v11 offset:24576
  v_mfma_f32_16x16x32_bf16 v[164:167], v[72:75], a[228:231], v[164:167]
  ds_read_b64_tr_b16 v[106:107], v11 offset:28672
  v_mfma_f32_16x16x32_bf16 v[168:171], v[72:75], a[232:235], v[168:171]
  v_mfma_f32_16x16x32_bf16 v[172:175], v[72:75], a[236:239], v[172:175]
  buffer_load_dwordx4 a[220:223], v5, s[8:11], s28 offen sc1
  v_mfma_f32_16x16x32_bf16 v[188:191], v[76:79], a[236:239], v[188:191]
  ds_read_b64_tr_b16 v[108:109], v12 offset:24576
  v_mfma_f32_16x16x32_bf16 v[184:187], v[76:79], a[232:235], v[184:187]
  s_add_u32 s28, s28, 1024
  v_mfma_f32_16x16x32_bf16 v[180:183], v[76:79], a[228:231], v[180:183]
  ds_read_b64_tr_b16 v[110:111], v12 offset:28672
  v_mfma_f32_16x16x32_bf16 v[176:179], v[76:79], a[224:227], v[176:179]
  s_add_u32 m0, s68, 0
  v_mfma_f32_16x16x32_bf16 v[192:195], v[80:83], a[224:227], v[192:195]
  ds_read_b64_tr_b16 v[112:113], v13 offset:24576
  v_mfma_f32_16x16x32_bf16 v[196:199], v[80:83], a[228:231], v[196:199]
  ds_read_b64_tr_b16 v[114:115], v13 offset:28672
  v_mfma_f32_16x16x32_bf16 v[200:203], v[80:83], a[232:235], v[200:203]
  buffer_load_dwordx4 v10, s[12:15], s29 offen lds
  v_mfma_f32_16x16x32_bf16 v[204:207], v[80:83], a[236:239], v[204:207]
  ds_read_b64_tr_b16 v[116:117], v14 offset:24576
  v_mfma_f32_16x16x32_bf16 v[220:223], v[84:87], a[236:239], v[220:223]
  v_mfma_f32_16x16x32_bf16 v[216:219], v[84:87], a[232:235], v[216:219]
  s_add_u32 s29, s29, 32768
  v_mfma_f32_16x16x32_bf16 v[212:215], v[84:87], a[228:231], v[212:215]
  ds_read_b64_tr_b16 v[118:119], v14 offset:28672
  v_mfma_f32_16x16x32_bf16 v[208:211], v[84:87], a[224:227], v[208:211]
  s_add_u32 m0, s68, 4096
  v_mfma_f32_16x16x32_bf16 v[224:227], v[88:91], a[224:227], v[224:227]
  ds_read_b64_tr_b16 v[120:121], v15 offset:24576
  v_mfma_f32_16x16x32_bf16 v[228:231], v[88:91], a[228:231], v[228:231]
  ds_read_b64_tr_b16 v[122:123], v15 offset:28672
  v_mfma_f32_16x16x32_bf16 v[232:235], v[88:91], a[232:235], v[232:235]
  buffer_load_dwordx4 v10, s[12:15], s29 offen lds
  v_mfma_f32_16x16x32_bf16 v[236:239], v[88:91], a[236:239], v[236:239]
  ds_read_b64_tr_b16 v[124:125], v62 offset:24576
  v_mfma_f32_16x16x32_bf16 v[252:255], v[92:95], a[236:239], v[252:255]
  s_add_u32 s29, s29, 32768
  v_mfma_f32_16x16x32_bf16 v[248:251], v[92:95], a[232:235], v[248:251]
  ds_read_b64_tr_b16 v[126:127], v62 offset:28672
  v_mfma_f32_16x16x32_bf16 v[244:247], v[92:95], a[228:231], v[244:247]
  v_mfma_f32_16x16x32_bf16 v[240:243], v[92:95], a[224:227], v[240:243]
  s_waitcnt vmcnt(15) lgkmcnt(0)
  s_barrier
  v_mfma_f32_16x16x32_bf16 v[128:131], v[96:99], a[240:243], v[128:131]
  buffer_load_dwordx4 a[224:227], v2, s[8:11], s28 offen sc1
  v_mfma_f32_16x16x32_bf16 v[132:135], v[96:99], a[244:247], v[132:135]
  ds_read_b64_tr_b16 v[64:65], v8 offset:32768
  v_mfma_f32_16x16x32_bf16 v[136:139], v[96:99], a[248:251], v[136:139]
  ds_read_b64_tr_b16 v[66:67], v8 offset:36864
  v_mfma_f32_16x16x32_bf16 v[140:143], v[96:99], a[252:255], v[140:143]
  buffer_load_dwordx4 a[228:231], v3, s[8:11], s28 offen sc1
  v_mfma_f32_16x16x32_bf16 v[156:159], v[100:103], a[252:255], v[156:159]
  ds_read_b64_tr_b16 v[68:69], v9 offset:32768
  v_mfma_f32_16x16x32_bf16 v[152:155], v[100:103], a[248:251], v[152:155]
  buffer_load_dwordx4 a[232:235], v4, s[8:11], s28 offen sc1
  v_mfma_f32_16x16x32_bf16 v[148:151], v[100:103], a[244:247], v[148:151]
  ds_read_b64_tr_b16 v[70:71], v9 offset:36864
  v_mfma_f32_16x16x32_bf16 v[144:147], v[100:103], a[240:243], v[144:147]
  v_mfma_f32_16x16x32_bf16 v[160:163], v[104:107], a[240:243], v[160:163]
  ds_read_b64_tr_b16 v[72:73], v11 offset:32768
  v_mfma_f32_16x16x32_bf16 v[164:167], v[104:107], a[244:247], v[164:167]
  buffer_load_dwordx4 a[236:239], v5, s[8:11], s28 offen sc1
  v_mfma_f32_16x16x32_bf16 v[168:171], v[104:107], a[248:251], v[168:171]
  ds_read_b64_tr_b16 v[74:75], v11 offset:36864
  v_mfma_f32_16x16x32_bf16 v[172:175], v[104:107], a[252:255], v[172:175]
  s_add_u32 s28, s28, 1024
  v_mfma_f32_16x16x32_bf16 v[188:191], v[108:111], a[252:255], v[188:191]
  ds_read_b64_tr_b16 v[76:77], v12 offset:32768
  v_mfma_f32_16x16x32_bf16 v[184:187], v[108:111], a[248:251], v[184:187]
  ds_read_b64_tr_b16 v[78:79], v12 offset:36864
  v_mfma_f32_16x16x32_bf16 v[180:183], v[108:111], a[244:247], v[180:183]
  s_add_u32 m0, s68, 8192
  v_mfma_f32_16x16x32_bf16 v[176:179], v[108:111], a[240:243], v[176:179]
  v_mfma_f32_16x16x32_bf16 v[192:195], v[112:115], a[240:243], v[192:195]
  ds_read_b64_tr_b16 v[80:81], v13 offset:32768
  v_mfma_f32_16x16x32_bf16 v[196:199], v[112:115], a[244:247], v[196:199]
  buffer_load_dwordx4 v10, s[12:15], s29 offen lds
  v_mfma_f32_16x16x32_bf16 v[200:203], v[112:115], a[248:251], v[200:203]
  ds_read_b64_tr_b16 v[82:83], v13 offset:36864
  v_mfma_f32_16x16x32_bf16 v[204:207], v[112:115], a[252:255], v[204:207]
  ds_read_b64_tr_b16 v[84:85], v14 offset:32768
  v_mfma_f32_16x16x32_bf16 v[220:223], v[116:119], a[252:255], v[220:223]
  s_add_u32 s29, s29, 32768
  v_mfma_f32_16x16x32_bf16 v[216:219], v[116:119], a[248:251], v[216:219]
  ds_read_b64_tr_b16 v[86:87], v14 offset:36864
  v_mfma_f32_16x16x32_bf16 v[212:215], v[116:119], a[244:247], v[212:215]
  s_add_u32 m0, s68, 12288
  v_mfma_f32_16x16x32_bf16 v[208:211], v[116:119], a[240:243], v[208:211]
  v_mfma_f32_16x16x32_bf16 v[224:227], v[120:123], a[240:243], v[224:227]
  ds_read_b64_tr_b16 v[88:89], v15 offset:32768
  v_mfma_f32_16x16x32_bf16 v[228:231], v[120:123], a[244:247], v[228:231]
  ds_read_b64_tr_b16 v[90:91], v15 offset:36864
  v_mfma_f32_16x16x32_bf16 v[232:235], v[120:123], a[248:251], v[232:235]
  buffer_load_dwordx4 v10, s[12:15], s29 offen lds
  v_mfma_f32_16x16x32_bf16 v[236:239], v[120:123], a[252:255], v[236:239]
  ds_read_b64_tr_b16 v[92:93], v62 offset:32768
  v_mfma_f32_16x16x32_bf16 v[252:255], v[124:127], a[252:255], v[252:255]
  s_add_u32 s29, s29, 32768
  v_mfma_f32_16x16x32_bf16 v[248:251], v[124:127], a[248:251], v[248:251]
  ds_read_b64_tr_b16 v[94:95], v62 offset:36864
  v_mfma_f32_16x16x32_bf16 v[244:247], v[124:127], a[244:247], v[244:247]
  v_mfma_f32_16x16x32_bf16 v[240:243], v[124:127], a[240:243], v[240:243]
  s_waitcnt vmcnt(15) lgkmcnt(0)
  v_mfma_f32_16x16x32_bf16 v[128:131], v[64:67], a[192:195], v[128:131]
  buffer_load_dwordx4 a[240:243], v2, s[8:11], s28 offen sc1
  v_mfma_f32_16x16x32_bf16 v[132:135], v[64:67], a[196:199], v[132:135]
  ds_read_b64_tr_b16 v[96:97], v8 offset:40960
  v_mfma_f32_16x16x32_bf16 v[136:139], v[64:67], a[200:203], v[136:139]
  ds_read_b64_tr_b16 v[98:99], v8 offset:45056
  v_mfma_f32_16x16x32_bf16 v[140:143], v[64:67], a[204:207], v[140:143]
  buffer_load_dwordx4 a[244:247], v3, s[8:11], s28 offen sc1
  v_mfma_f32_16x16x32_bf16 v[156:159], v[68:71], a[204:207], v[156:159]
  ds_read_b64_tr_b16 v[100:101], v9 offset:40960
  v_mfma_f32_16x16x32_bf16 v[152:155], v[68:71], a[200:203], v[152:155]
  buffer_load_dwordx4 a[248:251], v4, s[8:11], s28 offen sc1
  v_mfma_f32_16x16x32_bf16 v[148:151], v[68:71], a[196:199], v[148:151]
  ds_read_b64_tr_b16 v[102:103], v9 offset:45056
  v_mfma_f32_16x16x32_bf16 v[144:147], v[68:71], a[192:195], v[144:147]
  v_mfma_f32_16x16x32_bf16 v[160:163], v[72:75], a[192:195], v[160:163]
  ds_read_b64_tr_b16 v[104:105], v11 offset:40960
  v_mfma_f32_16x16x32_bf16 v[164:167], v[72:75], a[196:199], v[164:167]
  buffer_load_dwordx4 a[252:255], v5, s[8:11], s28 offen sc1
  v_mfma_f32_16x16x32_bf16 v[168:171], v[72:75], a[200:203], v[168:171]
  ds_read_b64_tr_b16 v[106:107], v11 offset:45056
  v_mfma_f32_16x16x32_bf16 v[172:175], v[72:75], a[204:207], v[172:175]
  s_add_u32 s28, s28, 1024
  v_mfma_f32_16x16x32_bf16 v[188:191], v[76:79], a[204:207], v[188:191]
  ds_read_b64_tr_b16 v[108:109], v12 offset:40960
  v_mfma_f32_16x16x32_bf16 v[184:187], v[76:79], a[200:203], v[184:187]
  ds_read_b64_tr_b16 v[110:111], v12 offset:45056
  v_mfma_f32_16x16x32_bf16 v[180:183], v[76:79], a[196:199], v[180:183]
  s_add_u32 m0, s68, 16384
  v_mfma_f32_16x16x32_bf16 v[176:179], v[76:79], a[192:195], v[176:179]
  v_mfma_f32_16x16x32_bf16 v[192:195], v[80:83], a[192:195], v[192:195]
  ds_read_b64_tr_b16 v[112:113], v13 offset:40960
  v_mfma_f32_16x16x32_bf16 v[196:199], v[80:83], a[196:199], v[196:199]
  buffer_load_dwordx4 v10, s[12:15], s29 offen lds
  v_mfma_f32_16x16x32_bf16 v[200:203], v[80:83], a[200:203], v[200:203]
  ds_read_b64_tr_b16 v[114:115], v13 offset:45056
  v_mfma_f32_16x16x32_bf16 v[204:207], v[80:83], a[204:207], v[204:207]
  ds_read_b64_tr_b16 v[116:117], v14 offset:40960
  v_mfma_f32_16x16x32_bf16 v[220:223], v[84:87], a[204:207], v[220:223]
  s_add_u32 s29, s29, 32768
  v_mfma_f32_16x16x32_bf16 v[216:219], v[84:87], a[200:203], v[216:219]
  ds_read_b64_tr_b16 v[118:119], v14 offset:45056
  v_mfma_f32_16x16x32_bf16 v[212:215], v[84:87], a[196:199], v[212:215]
  s_add_u32 m0, s68, 20480
  v_mfma_f32_16x16x32_bf16 v[208:211], v[84:87], a[192:195], v[208:211]
  v_mfma_f32_16x16x32_bf16 v[224:227], v[88:91], a[192:195], v[224:227]
  ds_read_b64_tr_b16 v[120:121], v15 offset:40960
  v_mfma_f32_16x16x32_bf16 v[228:231], v[88:91], a[196:199], v[228:231]
  ds_read_b64_tr_b16 v[122:123], v15 offset:45056
  v_mfma_f32_16x16x32_bf16 v[232:235], v[88:91], a[200:203], v[232:235]
  buffer_load_dwordx4 v10, s[12:15], s29 offen lds
  v_mfma_f32_16x16x32_bf16 v[236:239], v[88:91], a[204:207], v[236:239]
  ds_read_b64_tr_b16 v[124:125], v62 offset:40960
  v_mfma_f32_16x16x32_bf16 v[252:255], v[92:95], a[204:207], v[252:255]
  s_add_u32 s29, s29, 32768
  v_mfma_f32_16x16x32_bf16 v[248:251], v[92:95], a[200:203], v[248:251]
  ds_read_b64_tr_b16 v[126:127], v62 offset:45056
  v_mfma_f32_16x16x32_bf16 v[244:247], v[92:95], a[196:199], v[244:247]
  v_mfma_f32_16x16x32_bf16 v[240:243], v[92:95], a[192:195], v[240:243]
  s_cmp_ge_u32 s3, 2
  s_cbranch_scc1 L_parallel_sum__linear_kernel_hedgehog__glu_gated_reglu__prompt_kernel_g2_l1_x
  s_waitcnt vmcnt(18)
  v_readfirstlane_b32 s70, v17
  s_nop 3
  s_cmp_ge_u32 s70, 8
  s_cbranch_scc1 L_parallel_sum__linear_kernel_hedgehog__glu_gated_reglu__prompt_kernel_g2_l1_ok
  s_mov_b32 s71, 0
L_parallel_sum__linear_kernel_hedgehog__glu_gated_reglu__prompt_kernel_g2_l1:
  buffer_load_dword v17, v0, s[24:27], s74 offen sc1
  s_waitcnt vmcnt(0)
  v_readfirstlane_b32 s70, v17
  s_add_u32 s71, s71, 1
  s_nop 2
  s_cmp_ge_u32 s70, 8
  s_cbranch_scc1 L_parallel_sum__linear_kernel_hedgehog__glu_gated_reglu__prompt_kernel_g2_l1_ok
  s_cmp_ge_u32 s71, 1048576
  s_cbranch_scc1 L_parallel_sum__linear_kernel_hedgehog__glu_gated_reglu__prompt_kernel_g2_l1_ok
  s_sleep 1
  s_branch L_parallel_sum__linear_kernel_hedgehog__glu_gated_reglu__prompt_kernel_g2_l1
L_parallel_sum__linear_kernel_hedgehog__glu_gated_reglu__prompt_kernel_g2_l1_ok:
  s_add_u32 s20, s60, 0x1e00000
  s_addc_u32 s21, s61, 0
  s_and_b32 s21, s21, 0xffff
  s_mov_b32 s22, 0x300000
  s_mov_b32 s23, 0x20000
  s_mul_i32 s70, s48, 6
  s_lshl_b32 s71, s3, 2
  s_add_u32 s70, s70, s71
  v_lshrrev_b32 v18, 4, v1
  v_add_u32 v18, s70, v18
  s_lshl_b32 s71, s3, 1
  s_sub_u32 s71, 4, s71
  v_lshrrev_b32 v19, 4, v1
  v_cmp_gt_u32 vcc, s71, v19
  v_and_b32 v19, 15, v1
  v_lshlrev_b32 v20, 8, v18
  v_lshl_add_u32 v20, v19, 4, v20
  v_lshlrev_b32 v21, 7, v18
  v_lshl_add_u32 v21, v19, 3, v21
  v_mov_b32 v19, 0x7f000000
  v_cndmask_b32 v20, v19, v20, vcc
  v_cndmask_b32 v21, v19, v21, vcc
  s_mul_i32 s69, s49, 98304
  buffer_load_dwordx4 a[64:67], v20, s[20:23], s69 offen sc1
  s_add_u32 s69, s69, 12288
  buffer_load_dwordx4 a[68:71], v20, s[20:23], s69 offen sc1
  s_add_u32 s69, s69, 12288
  buffer_load_dwordx4 a[72:75], v20, s[20:23], s69 offen sc1
  s_add_u32 s69, s69, 12288
  buffer_load_dwordx4 a[76:79], v20, s[20:23], s69 offen sc1
  s_add_u32 s69, s69, 12288
  buffer_load_dwordx4 a[80:83], v20, s[20:23], s69 offen sc1
  s_add_u32 s69, s69, 12288
  buffer_load_dwordx4 a[84:87], v20, s[20:23], s69 offen sc1
  s_add_u32 s69, s69, 12288
  buffer_load_dwordx4 a[88:91], v20, s[20:23], s69 offen sc1
  s_add_u32 s69, s69, 12288
  buffer_load_dwordx4 a[92:95], v20, s[20:23], s69 offen sc1
  s_add_u32 s69, s69, 12288
L_parallel_sum__linear_kernel_hedgehog__glu_gated_reglu__prompt_kernel_g2_l1_x:
  s_waitcnt vmcnt(14) lgkmcnt(0)
  s_barrier
  v_mfma_f32_16x16x32_bf16 v[128:131], v[96:99], a[208:211], v[128:131]
  buffer_load_dwordx4 a[192:195], v2, s[8:11], s28 offen sc1
  v_mfma_f32_16x16x32_bf16 v[132:135], v[96:99], a[212:215], v[132:135]
  ds_read_b64_tr_b16 v[64:65], v8 offset:49152
  v_mfma_f32_16x16x32_bf16 v[136:139], v[96:99], a[216:219], v[136:139]
  ds_read_b64_tr_b16 v[66:67], v8 offset:53248
  v_mfma_f32_16x16x32_bf16 v[140:143], v[96:99], a[220:223], v[140:143]
  buffer_load_dwordx4 a[196:199], v3, s[8:11], s28 offen sc1
  v_mfma_f32_16x16x32_bf16 v[156:159], v[100:103], a[220:223], v[156:159]
  ds_read_b64_tr_b16 v[68:69], v9 offset:49152
  v_mfma_f32_16x16x32_bf16 v[152:155], v[100:103], a[216:219], v[152:155]
  buffer_load_dwordx4 a[200:203], v4, s[8:11], s28 offen sc1
  v_mfma_f32_16x16x32_bf16 v[148:151], v[100:103], a[212:215], v[148:151]
  ds_read_b64_tr_b16 v[70:71], v9 offset:53248
  v_mfma_f32_16x16x32_bf16 v[144:147], v[100:103], a[208:211], v[144:147]
  v_mfma_f32_16x16x32_bf16 v[160:163], v[104:107], a[208:211], v[160:163]
  ds_read_b64_tr_b16 v[72:73], v11 offset:49152
  v_mfma_f32_16x16x32_bf16 v[164:167], v[104:107], a[212:215], v[164:167]
  buffer_load_dwordx4 a[204:207], v5, s[8:11], s28 offen sc1
  v_mfma_f32_16x16x32_bf16 v[168:171], v[104:107], a[216:219], v[168:171]
  ds_read_b64_tr_b16 v[74:75], v11 offset:53248
  v_mfma_f32_16x16x32_bf16 v[172:175], v[104:107], a[220:223], v[172:175]
  s_add_u32 s28, s28, 1024
  v_mfma_f32_16x16x32_bf16 v[188:191], v[108:111], a[220:223], v[188:191]
  ds_read_b64_tr_b16 v[76:77], v12 offset:49152
  v_mfma_f32_16x16x32_bf16 v[184:187], v[108:111], a[216:219], v[184:187]
  ds_read_b64_tr_b16 v[78:79], v12 offset:53248
  v_mfma_f32_16x16x32_bf16 v[180:183], v[108:111], a[212:215], v[180:183]
  s_add_u32 m0, s68, 24576
  v_mfma_f32_16x16x32_bf16 v[176:179], v[108:111], a[208:211], v[176:179]
  v_mfma_f32_16x16x32_bf16 v[192:195], v[112:115], a[208:211], v[192:195]
  ds_read_b64_tr_b16 v[80:81], v13 offset:49152
  v_mfma_f32_16x16x32_bf16 v[196:199], v[112:115], a[212:215], v[196:199]
  buffer_load_dwordx4 v10, s[12:15], s29 offen lds
  v_mfma_f32_16x16x32_bf16 v[200:203], v[112:115], a[216:219], v[200:203]
  ds_read_b64_tr_b16 v[82:83], v13 offset:53248
  v_mfma_f32_16x16x32_bf16 v[204:207], v[112:115], a[220:223], v[204:207]
  ds_read_b64_tr_b16 v[84:85], v14 offset:49152
  v_mfma_f32_16x16x32_bf16 v[220:223], v[116:119], a[220:223], v[220:223]
  s_add_u32 s29, s29, 32768
  v_mfma_f32_16x16x32_bf16 v[216:219], v[116:119], a[216:219], v[216:219]
  ds_read_b64_tr_b16 v[86:87], v14 offset:53248
  v_mfma_f32_16x16x32_bf16 v[212:215], v[116:119], a[212:215], v[212:215]
  s_add_u32 m0, s68, 28672
  v_mfma_f32_16x16x32_bf16 v[208:211], v[116:119], a[208:211], v[208:211]
  v_mfma_f32_16x16x32_bf16 v[224:227], v[120:123], a[208:211], v[224:227]
  ds_read_b64_tr_b16 v[88:89], v15 offset:49152
  v_mfma_f32_16x16x32_bf16 v[228:231], v[120:123], a[212:215], v[228:231]
  ds_read_b64_tr_b16 v[90:91], v15 offset:53248
  v_mfma_f32_16x16x32_bf16 v[232:235], v[120:123], a[216:219], v[232:235]
  buffer_load_dwordx4 v10, s[12:15], s29 offen lds
  v_mfma_f32_16x16x32_bf16 v[236:239], v[120:123], a[220:223], v[236:239]
  ds_read_b64_tr_b16 v[92:93], v62 offset:49152
  v_mfma_f32_16x16x32_bf16 v[252:255], v[124:127], a[220:223], v[252:255]
  s_add_u32 s29, s29, 32768
  v_mfma_f32_16x16x32_bf16 v[248:251], v[124:127], a[216:219], v[248:251]
  ds_read_b64_tr_b16 v[94:95], v62 offset:53248
  v_mfma_f32_16x16x32_bf16 v[244:247], v[124:127], a[212:215], v[244:247]
  v_mfma_f32_16x16x32_bf16 v[240:243], v[124:127], a[208:211], v[240:243]
  s_waitcnt vmcnt(14) lgkmcnt(0)
  v_mfma_f32_16x16x32_bf16 v[128:131], v[64:67], a[224:227], v[128:131]
  buffer_load_dwordx4 a[208:211], v2, s[8:11], s28 offen sc1
  v_mfma_f32_16x16x32_bf16 v[132:135], v[64:67], a[228:231], v[132:135]
  ds_read_b64_tr_b16 v[96:97], v8 offset:57344
  v_mfma_f32_16x16x32_bf16 v[136:139], v[64:67], a[232:235], v[136:139]
  ds_read_b64_tr_b16 v[98:99], v8 offset:61440
  v_mfma_f32_16x16x32_bf16 v[140:143], v[64:67], a[236:239], v[140:143]
  buffer_load_dwordx4 a[212:215], v3, s[8:11], s28 offen sc1
  v_mfma_f32_16x16x32_bf16 v[156:159], v[68:71], a[236:239], v[156:159]
  ds_read_b64_tr_b16 v[100:101], v9 offset:57344
  v_mfma_f32_16x16x32_bf16 v[152:155], v[68:71], a[232:235], v[152:155]
  buffer_load_dwordx4 a[216:219], v4, s[8:11], s28 offen sc1
  v_mfma_f32_16x16x32_bf16 v[148:151], v[68:71], a[228:231], v[148:151]
  ds_read_b64_tr_b16 v[102:103], v9 offset:61440
  v_mfma_f32_16x16x32_bf16 v[144:147], v[68:71], a[224:227], v[144:147]
  v_mfma_f32_16x16x32_bf16 v[160:163], v[72:75], a[224:227], v[160:163]
  ds_read_b64_tr_b16 v[104:105], v11 offset:57344
  v_mfma_f32_16x16x32_bf16 v[164:167], v[72:75], a[228:231], v[164:167]
  buffer_load_dwordx4 a[220:223], v5, s[8:11], s28 offen sc1
  v_mfma_f32_16x16x32_bf16 v[168:171], v[72:75], a[232:235], v[168:171]
  ds_read_b64_tr_b16 v[106:107], v11 offset:61440
  v_mfma_f32_16x16x32_bf16 v[172:175], v[72:75], a[236:239], v[172:175]
  s_add_u32 s28, s28, 1024
  v_mfma_f32_16x16x32_bf16 v[188:191], v[76:79], a[236:239], v[188:191]
  ds_read_b64_tr_b16 v[108:109], v12 offset:57344
  v_mfma_f32_16x16x32_bf16 v[184:187], v[76:79], a[232:235], v[184:187]
  ds_read_b64_tr_b16 v[110:111], v12 offset:61440
  v_mfma_f32_16x16x32_bf16 v[180:183], v[76:79], a[228:231], v[180:183]
  s_add_u32 m0, s68, 32768
  v_mfma_f32_16x16x32_bf16 v[176:179], v[76:79], a[224:227], v[176:179]
  v_mfma_f32_16x16x32_bf16 v[192:195], v[80:83], a[224:227], v[192:195]
  ds_read_b64_tr_b16 v[112:113], v13 offset:57344
  v_mfma_f32_16x16x32_bf16 v[196:199], v[80:83], a[228:231], v[196:199]
  buffer_load_dwordx4 v10, s[12:15], s29 offen lds
  v_mfma_f32_16x16x32_bf16 v[200:203], v[80:83], a[232:235], v[200:203]
  ds_read_b64_tr_b16 v[114:115], v13 offset:61440
  v_mfma_f32_16x16x32_bf16 v[204:207], v[80:83], a[236:239], v[204:207]
  ds_read_b64_tr_b16 v[116:117], v14 offset:57344
  v_mfma_f32_16x16x32_bf16 v[220:223], v[84:87], a[236:239], v[220:223]
  s_add_u32 s29, s29, 32768
  v_mfma_f32_16x16x32_bf16 v[216:219], v[84:87], a[232:235], v[216:219]
  ds_read_b64_tr_b16 v[118:119], v14 offset:61440
  v_mfma_f32_16x16x32_bf16 v[212:215], v[84:87], a[228:231], v[212:215]
  s_add_u32 m0, s68, 36864
  v_mfma_f32_16x16x32_bf16 v[208:211], v[84:87], a[224:227], v[208:211]
  v_mfma_f32_16x16x32_bf16 v[224:227], v[88:91], a[224:227], v[224:227]
  ds_read_b64_tr_b16 v[120:121], v15 offset:57344
  v_mfma_f32_16x16x32_bf16 v[228:231], v[88:91], a[228:231], v[228:231]
  ds_read_b64_tr_b16 v[122:123], v15 offset:61440
  v_mfma_f32_16x16x32_bf16 v[232:235], v[88:91], a[232:235], v[232:235]
  buffer_load_dwordx4 v10, s[12:15], s29 offen lds
  v_mfma_f32_16x16x32_bf16 v[236:239], v[88:91], a[236:239], v[236:239]
  ds_read_b64_tr_b16 v[124:125], v62 offset:57344
  v_mfma_f32_16x16x32_bf16 v[252:255], v[92:95], a[236:239], v[252:255]
  s_add_u32 s29, s29, 32768
  v_mfma_f32_16x16x32_bf16 v[248:251], v[92:95], a[232:235], v[248:251]
  ds_read_b64_tr_b16 v[126:127], v62 offset:61440
  v_mfma_f32_16x16x32_bf16 v[244:247], v[92:95], a[228:231], v[244:247]
  v_mfma_f32_16x16x32_bf16 v[240:243], v[92:95], a[224:227], v[240:243]
  s_cmp_ge_u32 s3, 2
  s_cbranch_scc1 L_parallel_sum__linear_kernel_hedgehog__glu_gated_reglu__prompt_kernel_g2_r1
  s_waitcnt vmcnt(12)
  v_accvgpr_read_b32 v22, a64
  v_accvgpr_read_b32 v23, a65
  v_accvgpr_read_b32 v24, a66
  v_accvgpr_read_b32 v25, a67
  v_accvgpr_read_b32 v30, a68
  v_accvgpr_read_b32 v31, a69
  v_accvgpr_read_b32 v32, a70
  v_accvgpr_read_b32 v33, a71
  v_pk_add_f32 v[22:23], v[22:23], v[30:31]
  v_pk_add_f32 v[24:25], v[24:25], v[32:33]
  v_accvgpr_read_b32 v26, a72
  v_accvgpr_read_b32 v27, a73
  v_accvgpr_read_b32 v28, a74
  v_accvgpr_read_b32 v29, a75
  v_pk_add_f32 v[22:23], v[22:23], v[26:27]
  v_pk_add_f32 v[24:25], v[24:25], v[28:29]
  v_accvgpr_read_b32 v30, a76
  v_accvgpr_read_b32 v31, a77
  v_accvgpr_read_b32 v32, a78
  v_accvgpr_read_b32 v33, a79
  v_pk_add_f32 v[22:23], v[22:23], v[30:31]
  v_pk_add_f32 v[24:25], v[24:25], v[32:33]
  v_accvgpr_read_b32 v26, a80
  v_accvgpr_read_b32 v27, a81
  v_accvgpr_read_b32 v28, a82
  v_accvgpr_read_b32 v29, a83
  v_pk_add_f32 v[22:23], v[22:23], v[26:27]
  v_pk_add_f32 v[24:25], v[24:25], v[28:29]
  v_accvgpr_read_b32 v30, a84
  v_accvgpr_read_b32 v31, a85
  v_accvgpr_read_b32 v32, a86
  v_accvgpr_read_b32 v33, a87
  v_pk_add_f32 v[22:23], v[22:23], v[30:31]
  v_pk_add_f32 v[24:25], v[24:25], v[32:33]
  v_accvgpr_read_b32 v26, a88
  v_accvgpr_read_b32 v27, a89
  v_accvgpr_read_b32 v28, a90
  v_accvgpr_read_b32 v29, a91
  v_pk_add_f32 v[22:23], v[22:23], v[26:27]
  v_pk_add_f32 v[24:25], v[24:25], v[28:29]
  v_accvgpr_read_b32 v30, a92
  v_accvgpr_read_b32 v31, a93
  v_accvgpr_read_b32 v32, a94
  v_accvgpr_read_b32 v33, a95
  v_pk_add_f32 v[22:23], v[22:23], v[30:31]
  v_pk_add_f32 v[24:25], v[24:25], v[32:33]
  v_cvt_pk_bf16_f32 v22, v22, v23
  v_cvt_pk_bf16_f32 v23, v24, v25
  s_add_u32 s20, s60, 0x2800000
  s_addc_u32 s21, s61, 0
  s_and_b32 s21, s21, 0xffff
  s_mov_b32 s22, 0x30000
  s_mov_b32 s23, 0x20000
  s_mul_i32 s69, s49, 6144
  buffer_store_dwordx2 v[22:23], v21, s[20:23], s69 offen sc1
L_parallel_sum__linear_kernel_hedgehog__glu_gated_reglu__prompt_kernel_g2_r1:
  s_waitcnt vmcnt(14) lgkmcnt(0)
  s_barrier
  v_mfma_f32_16x16x32_bf16 v[128:131], v[96:99], a[240:243], v[128:131]
  buffer_load_dwordx4 a[224:227], v2, s[8:11], s28 offen sc1
  v_mfma_f32_16x16x32_bf16 v[132:135], v[96:99], a[244:247], v[132:135]
  ds_read_b64_tr_b16 v[64:65], v8 offset:0
  v_mfma_f32_16x16x32_bf16 v[136:139], v[96:99], a[248:251], v[136:139]
  ds_read_b64_tr_b16 v[66:67], v8 offset:4096
  v_mfma_f32_16x16x32_bf16 v[140:143], v[96:99], a[252:255], v[140:143]
  buffer_load_dwordx4 a[228:231], v3, s[8:11], s28 offen sc1
  v_mfma_f32_16x16x32_bf16 v[156:159], v[100:103], a[252:255], v[156:159]
  ds_read_b64_tr_b16 v[68:69], v9 offset:0
  v_mfma_f32_16x16x32_bf16 v[152:155], v[100:103], a[248:251], v[152:155]
  buffer_load_dwordx4 a[232:235], v4, s[8:11], s28 offen sc1
  v_mfma_f32_16x16x32_bf16 v[148:151], v[100:103], a[244:247], v[148:151]
  ds_read_b64_tr_b16 v[70:71], v9 offset:4096
  v_mfma_f32_16x16x32_bf16 v[144:147], v[100:103], a[240:243], v[144:147]
  v_mfma_f32_16x16x32_bf16 v[160:163], v[104:107], a[240:243], v[160:163]
  ds_read_b64_tr_b16 v[72:73], v11 offset:0
  v_mfma_f32_16x16x32_bf16 v[164:167], v[104:107], a[244:247], v[164:167]
  buffer_load_dwordx4 a[236:239], v5, s[8:11], s28 offen sc1
  v_mfma_f32_16x16x32_bf16 v[168:171], v[104:107], a[248:251], v[168:171]
  ds_read_b64_tr_b16 v[74:75], v11 offset:4096
  v_mfma_f32_16x16x32_bf16 v[172:175], v[104:107], a[252:255], v[172:175]
  s_add_u32 s28, s28, 1024
  v_mfma_f32_16x16x32_bf16 v[188:191], v[108:111], a[252:255], v[188:191]
  ds_read_b64_tr_b16 v[76:77], v12 offset:0
  v_mfma_f32_16x16x32_bf16 v[184:187], v[108:111], a[248:251], v[184:187]
  ds_read_b64_tr_b16 v[78:79], v12 offset:4096
  v_mfma_f32_16x16x32_bf16 v[180:183], v[108:111], a[244:247], v[180:183]
  s_add_u32 m0, s68, 40960
  v_mfma_f32_16x16x32_bf16 v[176:179], v[108:111], a[240:243], v[176:179]
  v_mfma_f32_16x16x32_bf16 v[192:195], v[112:115], a[240:243], v[192:195]
  ds_read_b64_tr_b16 v[80:81], v13 offset:0
  v_mfma_f32_16x16x32_bf16 v[196:199], v[112:115], a[244:247], v[196:199]
  buffer_load_dwordx4 v10, s[12:15], s29 offen lds
  v_mfma_f32_16x16x32_bf16 v[200:203], v[112:115], a[248:251], v[200:203]
  ds_read_b64_tr_b16 v[82:83], v13 offset:4096
  v_mfma_f32_16x16x32_bf16 v[204:207], v[112:115], a[252:255], v[204:207]
  ds_read_b64_tr_b16 v[84:85], v14 offset:0
  v_mfma_f32_16x16x32_bf16 v[220:223], v[116:119], a[252:255], v[220:223]
  s_add_u32 s29, s29, 32768
  v_mfma_f32_16x16x32_bf16 v[216:219], v[116:119], a[248:251], v[216:219]
  ds_read_b64_tr_b16 v[86:87], v14 offset:4096
  v_mfma_f32_16x16x32_bf16 v[212:215], v[116:119], a[244:247], v[212:215]
  s_add_u32 m0, s68, 45056
  v_mfma_f32_16x16x32_bf16 v[208:211], v[116:119], a[240:243], v[208:211]
  v_mfma_f32_16x16x32_bf16 v[224:227], v[120:123], a[240:243], v[224:227]
  ds_read_b64_tr_b16 v[88:89], v15 offset:0
  v_mfma_f32_16x16x32_bf16 v[228:231], v[120:123], a[244:247], v[228:231]
  ds_read_b64_tr_b16 v[90:91], v15 offset:4096
  v_mfma_f32_16x16x32_bf16 v[232:235], v[120:123], a[248:251], v[232:235]
  buffer_load_dwordx4 v10, s[12:15], s29 offen lds
  v_mfma_f32_16x16x32_bf16 v[236:239], v[120:123], a[252:255], v[236:239]
  ds_read_b64_tr_b16 v[92:93], v62 offset:0
  v_mfma_f32_16x16x32_bf16 v[252:255], v[124:127], a[252:255], v[252:255]
  s_add_u32 s29, s29, 32768
  v_mfma_f32_16x16x32_bf16 v[248:251], v[124:127], a[248:251], v[248:251]
  ds_read_b64_tr_b16 v[94:95], v62 offset:4096
  v_mfma_f32_16x16x32_bf16 v[244:247], v[124:127], a[244:247], v[244:247]
  v_mfma_f32_16x16x32_bf16 v[240:243], v[124:127], a[240:243], v[240:243]
  s_waitcnt vmcnt(14) lgkmcnt(0)
  v_mfma_f32_16x16x32_bf16 v[128:131], v[64:67], a[192:195], v[128:131]
  buffer_load_dwordx4 a[240:243], v2, s[8:11], s28 offen sc1
  v_mfma_f32_16x16x32_bf16 v[132:135], v[64:67], a[196:199], v[132:135]
  ds_read_b64_tr_b16 v[96:97], v8 offset:8192
  v_mfma_f32_16x16x32_bf16 v[136:139], v[64:67], a[200:203], v[136:139]
  ds_read_b64_tr_b16 v[98:99], v8 offset:12288
  v_mfma_f32_16x16x32_bf16 v[140:143], v[64:67], a[204:207], v[140:143]
  buffer_load_dwordx4 a[244:247], v3, s[8:11], s28 offen sc1
  v_mfma_f32_16x16x32_bf16 v[156:159], v[68:71], a[204:207], v[156:159]
  ds_read_b64_tr_b16 v[100:101], v9 offset:8192
  v_mfma_f32_16x16x32_bf16 v[152:155], v[68:71], a[200:203], v[152:155]
  buffer_load_dwordx4 a[248:251], v4, s[8:11], s28 offen sc1
  v_mfma_f32_16x16x32_bf16 v[148:151], v[68:71], a[196:199], v[148:151]
  ds_read_b64_tr_b16 v[102:103], v9 offset:12288
  v_mfma_f32_16x16x32_bf16 v[144:147], v[68:71], a[192:195], v[144:147]
  v_mfma_f32_16x16x32_bf16 v[160:163], v[72:75], a[192:195], v[160:163]
  ds_read_b64_tr_b16 v[104:105], v11 offset:8192
  v_mfma_f32_16x16x32_bf16 v[164:167], v[72:75], a[196:199], v[164:167]
  buffer_load_dwordx4 a[252:255], v5, s[8:11], s28 offen sc1
  v_mfma_f32_16x16x32_bf16 v[168:171], v[72:75], a[200:203], v[168:171]
  ds_read_b64_tr_b16 v[106:107], v11 offset:12288
  v_mfma_f32_16x16x32_bf16 v[172:175], v[72:75], a[204:207], v[172:175]
  s_add_u32 s28, s28, 1024
  v_mfma_f32_16x16x32_bf16 v[188:191], v[76:79], a[204:207], v[188:191]
  ds_read_b64_tr_b16 v[108:109], v12 offset:8192
  v_mfma_f32_16x16x32_bf16 v[184:187], v[76:79], a[200:203], v[184:187]
  ds_read_b64_tr_b16 v[110:111], v12 offset:12288
  v_mfma_f32_16x16x32_bf16 v[180:183], v[76:79], a[196:199], v[180:183]
  s_add_u32 m0, s68, 49152
  v_mfma_f32_16x16x32_bf16 v[176:179], v[76:79], a[192:195], v[176:179]
  v_mfma_f32_16x16x32_bf16 v[192:195], v[80:83], a[192:195], v[192:195]
  ds_read_b64_tr_b16 v[112:113], v13 offset:8192
  v_mfma_f32_16x16x32_bf16 v[196:199], v[80:83], a[196:199], v[196:199]
  buffer_load_dwordx4 v10, s[12:15], s29 offen lds
  v_mfma_f32_16x16x32_bf16 v[200:203], v[80:83], a[200:203], v[200:203]
  ds_read_b64_tr_b16 v[114:115], v13 offset:12288
  v_mfma_f32_16x16x32_bf16 v[204:207], v[80:83], a[204:207], v[204:207]
  ds_read_b64_tr_b16 v[116:117], v14 offset:8192
  v_mfma_f32_16x16x32_bf16 v[220:223], v[84:87], a[204:207], v[220:223]
  s_add_u32 s29, s29, 32768
  v_mfma_f32_16x16x32_bf16 v[216:219], v[84:87], a[200:203], v[216:219]
  ds_read_b64_tr_b16 v[118:119], v14 offset:12288
  v_mfma_f32_16x16x32_bf16 v[212:215], v[84:87], a[196:199], v[212:215]
  s_add_u32 m0, s68, 53248
  v_mfma_f32_16x16x32_bf16 v[208:211], v[84:87], a[192:195], v[208:211]
  v_mfma_f32_16x16x32_bf16 v[224:227], v[88:91], a[192:195], v[224:227]
  ds_read_b64_tr_b16 v[120:121], v15 offset:8192
  v_mfma_f32_16x16x32_bf16 v[228:231], v[88:91], a[196:199], v[228:231]
  ds_read_b64_tr_b16 v[122:123], v15 offset:12288
  v_mfma_f32_16x16x32_bf16 v[232:235], v[88:91], a[200:203], v[232:235]
  buffer_load_dwordx4 v10, s[12:15], s29 offen lds
  v_mfma_f32_16x16x32_bf16 v[236:239], v[88:91], a[204:207], v[236:239]
  ds_read_b64_tr_b16 v[124:125], v62 offset:8192
  v_mfma_f32_16x16x32_bf16 v[252:255], v[92:95], a[204:207], v[252:255]
  s_add_u32 s29, s29, 32768
  v_mfma_f32_16x16x32_bf16 v[248:251], v[92:95], a[200:203], v[248:251]
  ds_read_b64_tr_b16 v[126:127], v62 offset:12288
  v_mfma_f32_16x16x32_bf16 v[244:247], v[92:95], a[196:199], v[244:247]
  v_mfma_f32_16x16x32_bf16 v[240:243], v[92:95], a[192:195], v[240:243]
  s_cmp_ge_u32 s3, 2
  s_cbranch_scc1 L_parallel_sum__linear_kernel_hedgehog__glu_gated_reglu__prompt_kernel_g2_rp
  s_waitcnt vmcnt(12)
  s_lshl_b32 s69, s49, 7
  s_add_u32 s69, s69, 45056
  v_mov_b32 v16, 1
  s_mov_b64 s[70:71], exec
  s_mov_b64 exec, 1
  buffer_atomic_add v16, v0, s[24:27], s69 offen sc1
  s_mov_b64 exec, s[70:71]
L_parallel_sum__linear_kernel_hedgehog__glu_gated_reglu__prompt_kernel_g2_rp:
  s_waitcnt vmcnt(14) lgkmcnt(0)
  s_barrier
  v_mfma_f32_16x16x32_bf16 v[128:131], v[96:99], a[208:211], v[128:131]
  buffer_load_dwordx4 a[192:195], v2, s[8:11], s28 offen sc1
  v_mfma_f32_16x16x32_bf16 v[132:135], v[96:99], a[212:215], v[132:135]
  ds_read_b64_tr_b16 v[64:65], v8 offset:16384
  v_mfma_f32_16x16x32_bf16 v[136:139], v[96:99], a[216:219], v[136:139]
  ds_read_b64_tr_b16 v[66:67], v8 offset:20480
  v_mfma_f32_16x16x32_bf16 v[140:143], v[96:99], a[220:223], v[140:143]
  buffer_load_dwordx4 a[196:199], v3, s[8:11], s28 offen sc1
  v_mfma_f32_16x16x32_bf16 v[156:159], v[100:103], a[220:223], v[156:159]
  ds_read_b64_tr_b16 v[68:69], v9 offset:16384
  v_mfma_f32_16x16x32_bf16 v[152:155], v[100:103], a[216:219], v[152:155]
  buffer_load_dwordx4 a[200:203], v4, s[8:11], s28 offen sc1
  v_mfma_f32_16x16x32_bf16 v[148:151], v[100:103], a[212:215], v[148:151]
  ds_read_b64_tr_b16 v[70:71], v9 offset:20480
  v_mfma_f32_16x16x32_bf16 v[144:147], v[100:103], a[208:211], v[144:147]
  v_mfma_f32_16x16x32_bf16 v[160:163], v[104:107], a[208:211], v[160:163]
  ds_read_b64_tr_b16 v[72:73], v11 offset:16384
  v_mfma_f32_16x16x32_bf16 v[164:167], v[104:107], a[212:215], v[164:167]
  buffer_load_dwordx4 a[204:207], v5, s[8:11], s28 offen sc1
  v_mfma_f32_16x16x32_bf16 v[168:171], v[104:107], a[216:219], v[168:171]
  ds_read_b64_tr_b16 v[74:75], v11 offset:20480
  v_mfma_f32_16x16x32_bf16 v[172:175], v[104:107], a[220:223], v[172:175]
  s_add_u32 s28, s28, 1024
  v_mfma_f32_16x16x32_bf16 v[188:191], v[108:111], a[220:223], v[188:191]
  ds_read_b64_tr_b16 v[76:77], v12 offset:16384
  v_mfma_f32_16x16x32_bf16 v[184:187], v[108:111], a[216:219], v[184:187]
  ds_read_b64_tr_b16 v[78:79], v12 offset:20480
  v_mfma_f32_16x16x32_bf16 v[180:183], v[108:111], a[212:215], v[180:183]
  s_add_u32 m0, s68, 57344
  v_mfma_f32_16x16x32_bf16 v[176:179], v[108:111], a[208:211], v[176:179]
  v_mfma_f32_16x16x32_bf16 v[192:195], v[112:115], a[208:211], v[192:195]
  ds_read_b64_tr_b16 v[80:81], v13 offset:16384
  v_mfma_f32_16x16x32_bf16 v[196:199], v[112:115], a[212:215], v[196:199]
  buffer_load_dwordx4 v10, s[12:15], s29 offen lds
  v_mfma_f32_16x16x32_bf16 v[200:203], v[112:115], a[216:219], v[200:203]
  ds_read_b64_tr_b16 v[82:83], v13 offset:20480
  v_mfma_f32_16x16x32_bf16 v[204:207], v[112:115], a[220:223], v[204:207]
  ds_read_b64_tr_b16 v[84:85], v14 offset:16384
  v_mfma_f32_16x16x32_bf16 v[220:223], v[116:119], a[220:223], v[220:223]
  s_add_u32 s29, s29, 32768
  v_mfma_f32_16x16x32_bf16 v[216:219], v[116:119], a[216:219], v[216:219]
  ds_read_b64_tr_b16 v[86:87], v14 offset:20480
  v_mfma_f32_16x16x32_bf16 v[212:215], v[116:119], a[212:215], v[212:215]
  s_add_u32 m0, s68, 61440
  v_mfma_f32_16x16x32_bf16 v[208:211], v[116:119], a[208:211], v[208:211]
  v_mfma_f32_16x16x32_bf16 v[224:227], v[120:123], a[208:211], v[224:227]
  ds_read_b64_tr_b16 v[88:89], v15 offset:16384
  v_mfma_f32_16x16x32_bf16 v[228:231], v[120:123], a[212:215], v[228:231]
  ds_read_b64_tr_b16 v[90:91], v15 offset:20480
  v_mfma_f32_16x16x32_bf16 v[232:235], v[120:123], a[216:219], v[232:235]
  buffer_load_dwordx4 v10, s[12:15], s29 offen lds
  v_mfma_f32_16x16x32_bf16 v[236:239], v[120:123], a[220:223], v[236:239]
  ds_read_b64_tr_b16 v[92:93], v62 offset:16384
  v_mfma_f32_16x16x32_bf16 v[252:255], v[124:127], a[220:223], v[252:255]
  s_add_u32 s29, s29, 32768
  v_mfma_f32_16x16x32_bf16 v[248:251], v[124:127], a[216:219], v[248:251]
  ds_read_b64_tr_b16 v[94:95], v62 offset:20480
  v_mfma_f32_16x16x32_bf16 v[244:247], v[124:127], a[212:215], v[244:247]
  v_mfma_f32_16x16x32_bf16 v[240:243], v[124:127], a[208:211], v[240:243]
  s_waitcnt vmcnt(14) lgkmcnt(0)
  v_mfma_f32_16x16x32_bf16 v[128:131], v[64:67], a[224:227], v[128:131]
  buffer_load_dwordx4 a[208:211], v2, s[8:11], s28 offen sc1
  v_mfma_f32_16x16x32_bf16 v[132:135], v[64:67], a[228:231], v[132:135]
  ds_read_b64_tr_b16 v[96:97], v8 offset:24576
  v_mfma_f32_16x16x32_bf16 v[136:139], v[64:67], a[232:235], v[136:139]
  ds_read_b64_tr_b16 v[98:99], v8 offset:28672
  v_mfma_f32_16x16x32_bf16 v[140:143], v[64:67], a[236:239], v[140:143]
  buffer_load_dwordx4 a[212:215], v3, s[8:11], s28 offen sc1
  v_mfma_f32_16x16x32_bf16 v[156:159], v[68:71], a[236:239], v[156:159]
  ds_read_b64_tr_b16 v[100:101], v9 offset:24576
  v_mfma_f32_16x16x32_bf16 v[152:155], v[68:71], a[232:235], v[152:155]
  buffer_load_dwordx4 a[216:219], v4, s[8:11], s28 offen sc1
  v_mfma_f32_16x16x32_bf16 v[148:151], v[68:71], a[228:231], v[148:151]
  ds_read_b64_tr_b16 v[102:103], v9 offset:28672
  v_mfma_f32_16x16x32_bf16 v[144:147], v[68:71], a[224:227], v[144:147]
  v_mfma_f32_16x16x32_bf16 v[160:163], v[72:75], a[224:227], v[160:163]
  ds_read_b64_tr_b16 v[104:105], v11 offset:24576
  v_mfma_f32_16x16x32_bf16 v[164:167], v[72:75], a[228:231], v[164:167]
  buffer_load_dwordx4 a[220:223], v5, s[8:11], s28 offen sc1
  v_mfma_f32_16x16x32_bf16 v[168:171], v[72:75], a[232:235], v[168:171]
  ds_read_b64_tr_b16 v[106:107], v11 offset:28672
  v_mfma_f32_16x16x32_bf16 v[172:175], v[72:75], a[236:239], v[172:175]
  s_add_u32 s28, s28, 1024
  v_mfma_f32_16x16x32_bf16 v[188:191], v[76:79], a[236:239], v[188:191]
  ds_read_b64_tr_b16 v[108:109], v12 offset:24576
  v_mfma_f32_16x16x32_bf16 v[184:187], v[76:79], a[232:235], v[184:187]
  ds_read_b64_tr_b16 v[110:111], v12 offset:28672
  v_mfma_f32_16x16x32_bf16 v[180:183], v[76:79], a[228:231], v[180:183]
  s_add_u32 m0, s68, 0
  v_mfma_f32_16x16x32_bf16 v[176:179], v[76:79], a[224:227], v[176:179]
  v_mfma_f32_16x16x32_bf16 v[192:195], v[80:83], a[224:227], v[192:195]
  ds_read_b64_tr_b16 v[112:113], v13 offset:24576
  v_mfma_f32_16x16x32_bf16 v[196:199], v[80:83], a[228:231], v[196:199]
  buffer_load_dwordx4 v10, s[12:15], s29 offen lds
  v_mfma_f32_16x16x32_bf16 v[200:203], v[80:83], a[232:235], v[200:203]
  ds_read_b64_tr_b16 v[114:115], v13 offset:28672
  v_mfma_f32_16x16x32_bf16 v[204:207], v[80:83], a[236:239], v[204:207]
  ds_read_b64_tr_b16 v[116:117], v14 offset:24576
  v_mfma_f32_16x16x32_bf16 v[220:223], v[84:87], a[236:239], v[220:223]
  s_add_u32 s29, s29, 32768
  v_mfma_f32_16x16x32_bf16 v[216:219], v[84:87], a[232:235], v[216:219]
  ds_read_b64_tr_b16 v[118:119], v14 offset:28672
  v_mfma_f32_16x16x32_bf16 v[212:215], v[84:87], a[228:231], v[212:215]
  s_add_u32 m0, s68, 4096
  v_mfma_f32_16x16x32_bf16 v[208:211], v[84:87], a[224:227], v[208:211]
  v_mfma_f32_16x16x32_bf16 v[224:227], v[88:91], a[224:227], v[224:227]
  ds_read_b64_tr_b16 v[120:121], v15 offset:24576
  v_mfma_f32_16x16x32_bf16 v[228:231], v[88:91], a[228:231], v[228:231]
  ds_read_b64_tr_b16 v[122:123], v15 offset:28672
  v_mfma_f32_16x16x32_bf16 v[232:235], v[88:91], a[232:235], v[232:235]
  buffer_load_dwordx4 v10, s[12:15], s29 offen lds
  v_mfma_f32_16x16x32_bf16 v[236:239], v[88:91], a[236:239], v[236:239]
  ds_read_b64_tr_b16 v[124:125], v62 offset:24576
  v_mfma_f32_16x16x32_bf16 v[252:255], v[92:95], a[236:239], v[252:255]
  s_add_u32 s29, s29, 32768
  v_mfma_f32_16x16x32_bf16 v[248:251], v[92:95], a[232:235], v[248:251]
  ds_read_b64_tr_b16 v[126:127], v62 offset:28672
  v_mfma_f32_16x16x32_bf16 v[244:247], v[92:95], a[228:231], v[244:247]
  v_mfma_f32_16x16x32_bf16 v[240:243], v[92:95], a[224:227], v[240:243]
  s_waitcnt vmcnt(14) lgkmcnt(0)
  s_barrier
  v_mfma_f32_16x16x32_bf16 v[128:131], v[96:99], a[240:243], v[128:131]
  buffer_load_dwordx4 a[224:227], v2, s[8:11], s28 offen sc1
  v_mfma_f32_16x16x32_bf16 v[132:135], v[96:99], a[244:247], v[132:135]
  ds_read_b64_tr_b16 v[64:65], v8 offset:32768
  v_mfma_f32_16x16x32_bf16 v[136:139], v[96:99], a[248:251], v[136:139]
  ds_read_b64_tr_b16 v[66:67], v8 offset:36864
  v_mfma_f32_16x16x32_bf16 v[140:143], v[96:99], a[252:255], v[140:143]
  buffer_load_dwordx4 a[228:231], v3, s[8:11], s28 offen sc1
  v_mfma_f32_16x16x32_bf16 v[156:159], v[100:103], a[252:255], v[156:159]
  ds_read_b64_tr_b16 v[68:69], v9 offset:32768
  v_mfma_f32_16x16x32_bf16 v[152:155], v[100:103], a[248:251], v[152:155]
  buffer_load_dwordx4 a[232:235], v4, s[8:11], s28 offen sc1
  v_mfma_f32_16x16x32_bf16 v[148:151], v[100:103], a[244:247], v[148:151]
  ds_read_b64_tr_b16 v[70:71], v9 offset:36864
  v_mfma_f32_16x16x32_bf16 v[144:147], v[100:103], a[240:243], v[144:147]
  v_mfma_f32_16x16x32_bf16 v[160:163], v[104:107], a[240:243], v[160:163]
  ds_read_b64_tr_b16 v[72:73], v11 offset:32768
  v_mfma_f32_16x16x32_bf16 v[164:167], v[104:107], a[244:247], v[164:167]
  buffer_load_dwordx4 a[236:239], v5, s[8:11], s28 offen sc1
  v_mfma_f32_16x16x32_bf16 v[168:171], v[104:107], a[248:251], v[168:171]
  ds_read_b64_tr_b16 v[74:75], v11 offset:36864
  v_mfma_f32_16x16x32_bf16 v[172:175], v[104:107], a[252:255], v[172:175]
  s_add_u32 s28, s28, 1024
  v_mfma_f32_16x16x32_bf16 v[188:191], v[108:111], a[252:255], v[188:191]
  ds_read_b64_tr_b16 v[76:77], v12 offset:32768
  v_mfma_f32_16x16x32_bf16 v[184:187], v[108:111], a[248:251], v[184:187]
  ds_read_b64_tr_b16 v[78:79], v12 offset:36864
  v_mfma_f32_16x16x32_bf16 v[180:183], v[108:111], a[244:247], v[180:183]
  s_add_u32 m0, s68, 8192
  v_mfma_f32_16x16x32_bf16 v[176:179], v[108:111], a[240:243], v[176:179]
  v_mfma_f32_16x16x32_bf16 v[192:195], v[112:115], a[240:243], v[192:195]
  ds_read_b64_tr_b16 v[80:81], v13 offset:32768
  v_mfma_f32_16x16x32_bf16 v[196:199], v[112:115], a[244:247], v[196:199]
  buffer_load_dwordx4 v10, s[12:15], s29 offen lds
  v_mfma_f32_16x16x32_bf16 v[200:203], v[112:115], a[248:251], v[200:203]
  ds_read_b64_tr_b16 v[82:83], v13 offset:36864
  v_mfma_f32_16x16x32_bf16 v[204:207], v[112:115], a[252:255], v[204:207]
  ds_read_b64_tr_b16 v[84:85], v14 offset:32768
  v_mfma_f32_16x16x32_bf16 v[220:223], v[116:119], a[252:255], v[220:223]
  s_add_u32 s29, s29, 32768
  v_mfma_f32_16x16x32_bf16 v[216:219], v[116:119], a[248:251], v[216:219]
  ds_read_b64_tr_b16 v[86:87], v14 offset:36864
  v_mfma_f32_16x16x32_bf16 v[212:215], v[116:119], a[244:247], v[212:215]
  s_add_u32 m0, s68, 12288
  v_mfma_f32_16x16x32_bf16 v[208:211], v[116:119], a[240:243], v[208:211]
  v_mfma_f32_16x16x32_bf16 v[224:227], v[120:123], a[240:243], v[224:227]
  ds_read_b64_tr_b16 v[88:89], v15 offset:32768
  v_mfma_f32_16x16x32_bf16 v[228:231], v[120:123], a[244:247], v[228:231]
  ds_read_b64_tr_b16 v[90:91], v15 offset:36864
  v_mfma_f32_16x16x32_bf16 v[232:235], v[120:123], a[248:251], v[232:235]
  buffer_load_dwordx4 v10, s[12:15], s29 offen lds
  v_mfma_f32_16x16x32_bf16 v[236:239], v[120:123], a[252:255], v[236:239]
  ds_read_b64_tr_b16 v[92:93], v62 offset:32768
  v_mfma_f32_16x16x32_bf16 v[252:255], v[124:127], a[252:255], v[252:255]
  s_add_u32 s29, s29, 32768
  v_mfma_f32_16x16x32_bf16 v[248:251], v[124:127], a[248:251], v[248:251]
  ds_read_b64_tr_b16 v[94:95], v62 offset:36864
  v_mfma_f32_16x16x32_bf16 v[244:247], v[124:127], a[244:247], v[244:247]
  v_mfma_f32_16x16x32_bf16 v[240:243], v[124:127], a[240:243], v[240:243]
  s_waitcnt vmcnt(14) lgkmcnt(0)
  v_mfma_f32_16x16x32_bf16 v[128:131], v[64:67], a[192:195], v[128:131]
  s_lshl_b32 s69, s49, 7
  v_mfma_f32_16x16x32_bf16 v[132:135], v[64:67], a[196:199], v[132:135]
  s_add_u32 s69, s69, 45056
  v_mfma_f32_16x16x32_bf16 v[136:139], v[64:67], a[200:203], v[136:139]
  buffer_load_dword v17, v0, s[24:27], s69 offen sc1
  v_mfma_f32_16x16x32_bf16 v[140:143], v[64:67], a[204:207], v[140:143]
  ds_read_b64_tr_b16 v[96:97], v8 offset:40960
  v_mfma_f32_16x16x32_bf16 v[156:159], v[68:71], a[204:207], v[156:159]
  ds_read_b64_tr_b16 v[98:99], v8 offset:45056
  v_mfma_f32_16x16x32_bf16 v[152:155], v[68:71], a[200:203], v[152:155]
  buffer_load_dwordx4 a[240:243], v2, s[8:11], s28 offen sc1
  v_mfma_f32_16x16x32_bf16 v[148:151], v[68:71], a[196:199], v[148:151]
  ds_read_b64_tr_b16 v[100:101], v9 offset:40960
  v_mfma_f32_16x16x32_bf16 v[144:147], v[68:71], a[192:195], v[144:147]
  buffer_load_dwordx4 a[244:247], v3, s[8:11], s28 offen sc1
  v_mfma_f32_16x16x32_bf16 v[160:163], v[72:75], a[192:195], v[160:163]
  ds_read_b64_tr_b16 v[102:103], v9 offset:45056
  v_mfma_f32_16x16x32_bf16 v[164:167], v[72:75], a[196:199], v[164:167]
  buffer_load_dwordx4 a[248:251], v4, s[8:11], s28 offen sc1
  v_mfma_f32_16x16x32_bf16 v[168:171], v[72:75], a[200:203], v[168:171]
  ds_read_b64_tr_b16 v[104:105], v11 offset:40960
  v_mfma_f32_16x16x32_bf16 v[172:175], v[72:75], a[204:207], v[172:175]
  ds_read_b64_tr_b16 v[106:107], v11 offset:45056
  v_mfma_f32_16x16x32_bf16 v[188:191], v[76:79], a[204:207], v[188:191]
  buffer_load_dwordx4 a[252:255], v5, s[8:11], s28 offen sc1
  v_mfma_f32_16x16x32_bf16 v[184:187], v[76:79], a[200:203], v[184:187]
  ds_read_b64_tr_b16 v[108:109], v12 offset:40960
  v_mfma_f32_16x16x32_bf16 v[180:183], v[76:79], a[196:199], v[180:183]
  s_add_u32 s28, s28, 1024
  v_mfma_f32_16x16x32_bf16 v[176:179], v[76:79], a[192:195], v[176:179]
  ds_read_b64_tr_b16 v[110:111], v12 offset:45056
  v_mfma_f32_16x16x32_bf16 v[192:195], v[80:83], a[192:195], v[192:195]
  s_add_u32 m0, s68, 16384
  v_mfma_f32_16x16x32_bf16 v[196:199], v[80:83], a[196:199], v[196:199]
  ds_read_b64_tr_b16 v[112:113], v13 offset:40960
  v_mfma_f32_16x16x32_bf16 v[200:203], v[80:83], a[200:203], v[200:203]
  ds_read_b64_tr_b16 v[114:115], v13 offset:45056
  v_mfma_f32_16x16x32_bf16 v[204:207], v[80:83], a[204:207], v[204:207]
  buffer_load_dwordx4 v10, s[12:15], s29 offen lds
  v_mfma_f32_16x16x32_bf16 v[220:223], v[84:87], a[204:207], v[220:223]
  ds_read_b64_tr_b16 v[116:117], v14 offset:40960
  v_mfma_f32_16x16x32_bf16 v[216:219], v[84:87], a[200:203], v[216:219]
  s_add_u32 s29, s29, 32768
  v_mfma_f32_16x16x32_bf16 v[212:215], v[84:87], a[196:199], v[212:215]
  ds_read_b64_tr_b16 v[118:119], v14 offset:45056
  v_mfma_f32_16x16x32_bf16 v[208:211], v[84:87], a[192:195], v[208:211]
  s_add_u32 m0, s68, 20480
  v_mfma_f32_16x16x32_bf16 v[224:227], v[88:91], a[192:195], v[224:227]
  ds_read_b64_tr_b16 v[120:121], v15 offset:40960
  v_mfma_f32_16x16x32_bf16 v[228:231], v[88:91], a[196:199], v[228:231]
  ds_read_b64_tr_b16 v[122:123], v15 offset:45056
  v_mfma_f32_16x16x32_bf16 v[232:235], v[88:91], a[200:203], v[232:235]
  buffer_load_dwordx4 v10, s[12:15], s29 offen lds
  v_mfma_f32_16x16x32_bf16 v[236:239], v[88:91], a[204:207], v[236:239]
  ds_read_b64_tr_b16 v[124:125], v62 offset:40960
  v_mfma_f32_16x16x32_bf16 v[252:255], v[92:95], a[204:207], v[252:255]
  s_add_u32 s29, s29, 32768
  v_mfma_f32_16x16x32_bf16 v[248:251], v[92:95], a[200:203], v[248:251]
  ds_read_b64_tr_b16 v[126:127], v62 offset:45056
  v_mfma_f32_16x16x32_bf16 v[244:247], v[92:95], a[196:199], v[244:247]
  v_mfma_f32_16x16x32_bf16 v[240:243], v[92:95], a[192:195], v[240:243]
  s_waitcnt vmcnt(15) lgkmcnt(0)
  s_barrier
  v_mfma_f32_16x16x32_bf16 v[128:131], v[96:99], a[208:211], v[128:131]
  buffer_load_dwordx4 a[192:195], v2, s[8:11], s28 offen sc1
  v_mfma_f32_16x16x32_bf16 v[132:135], v[96:99], a[212:215], v[132:135]
  ds_read_b64_tr_b16 v[64:65], v8 offset:49152
  v_mfma_f32_16x16x32_bf16 v[136:139], v[96:99], a[216:219], v[136:139]
  ds_read_b64_tr_b16 v[66:67], v8 offset:53248
  v_mfma_f32_16x16x32_bf16 v[140:143], v[96:99], a[220:223], v[140:143]
  buffer_load_dwordx4 a[196:199], v3, s[8:11], s28 offen sc1
  v_mfma_f32_16x16x32_bf16 v[156:159], v[100:103], a[220:223], v[156:159]
  ds_read_b64_tr_b16 v[68:69], v9 offset:49152
  v_mfma_f32_16x16x32_bf16 v[152:155], v[100:103], a[216:219], v[152:155]
  buffer_load_dwordx4 a[200:203], v4, s[8:11], s28 offen sc1
  v_mfma_f32_16x16x32_bf16 v[148:151], v[100:103], a[212:215], v[148:151]
  ds_read_b64_tr_b16 v[70:71], v9 offset:53248
  v_mfma_f32_16x16x32_bf16 v[144:147], v[100:103], a[208:211], v[144:147]
  v_mfma_f32_16x16x32_bf16 v[160:163], v[104:107], a[208:211], v[160:163]
  ds_read_b64_tr_b16 v[72:73], v11 offset:49152
  v_mfma_f32_16x16x32_bf16 v[164:167], v[104:107], a[212:215], v[164:167]
  buffer_load_dwordx4 a[204:207], v5, s[8:11], s28 offen sc1
  v_mfma_f32_16x16x32_bf16 v[168:171], v[104:107], a[216:219], v[168:171]
  ds_read_b64_tr_b16 v[74:75], v11 offset:53248
  v_mfma_f32_16x16x32_bf16 v[172:175], v[104:107], a[220:223], v[172:175]
  s_add_u32 s28, s28, 1024
  v_mfma_f32_16x16x32_bf16 v[188:191], v[108:111], a[220:223], v[188:191]
  ds_read_b64_tr_b16 v[76:77], v12 offset:49152
  v_mfma_f32_16x16x32_bf16 v[184:187], v[108:111], a[216:219], v[184:187]
  ds_read_b64_tr_b16 v[78:79], v12 offset:53248
  v_mfma_f32_16x16x32_bf16 v[180:183], v[108:111], a[212:215], v[180:183]
  s_add_u32 m0, s68, 24576
  v_mfma_f32_16x16x32_bf16 v[176:179], v[108:111], a[208:211], v[176:179]
  v_mfma_f32_16x16x32_bf16 v[192:195], v[112:115], a[208:211], v[192:195]
  ds_read_b64_tr_b16 v[80:81], v13 offset:49152
  v_mfma_f32_16x16x32_bf16 v[196:199], v[112:115], a[212:215], v[196:199]
  buffer_load_dwordx4 v10, s[12:15], s29 offen lds
  v_mfma_f32_16x16x32_bf16 v[200:203], v[112:115], a[216:219], v[200:203]
  ds_read_b64_tr_b16 v[82:83], v13 offset:53248
  v_mfma_f32_16x16x32_bf16 v[204:207], v[112:115], a[220:223], v[204:207]
  ds_read_b64_tr_b16 v[84:85], v14 offset:49152
  v_mfma_f32_16x16x32_bf16 v[220:223], v[116:119], a[220:223], v[220:223]
  s_add_u32 s29, s29, 32768
  v_mfma_f32_16x16x32_bf16 v[216:219], v[116:119], a[216:219], v[216:219]
  ds_read_b64_tr_b16 v[86:87], v14 offset:53248
  v_mfma_f32_16x16x32_bf16 v[212:215], v[116:119], a[212:215], v[212:215]
  s_add_u32 m0, s68, 28672
  v_mfma_f32_16x16x32_bf16 v[208:211], v[116:119], a[208:211], v[208:211]
  v_mfma_f32_16x16x32_bf16 v[224:227], v[120:123], a[208:211], v[224:227]
  ds_read_b64_tr_b16 v[88:89], v15 offset:49152
  v_mfma_f32_16x16x32_bf16 v[228:231], v[120:123], a[212:215], v[228:231]
  ds_read_b64_tr_b16 v[90:91], v15 offset:53248
  v_mfma_f32_16x16x32_bf16 v[232:235], v[120:123], a[216:219], v[232:235]
  buffer_load_dwordx4 v10, s[12:15], s29 offen lds
  v_mfma_f32_16x16x32_bf16 v[236:239], v[120:123], a[220:223], v[236:239]
  ds_read_b64_tr_b16 v[92:93], v62 offset:49152
  v_mfma_f32_16x16x32_bf16 v[252:255], v[124:127], a[220:223], v[252:255]
  s_add_u32 s29, s29, 32768
  v_mfma_f32_16x16x32_bf16 v[248:251], v[124:127], a[216:219], v[248:251]
  ds_read_b64_tr_b16 v[94:95], v62 offset:53248
  v_mfma_f32_16x16x32_bf16 v[244:247], v[124:127], a[212:215], v[244:247]
  v_mfma_f32_16x16x32_bf16 v[240:243], v[124:127], a[208:211], v[240:243]
  s_waitcnt vmcnt(12)
  v_readfirstlane_b32 s70, v17
  s_nop 3
  s_cmp_ge_u32 s70, 16
  s_cbranch_scc1 L_parallel_sum__linear_kernel_hedgehog__glu_gated_reglu__prompt_kernel_g2_l2_ok
  s_mov_b32 s71, 0
L_parallel_sum__linear_kernel_hedgehog__glu_gated_reglu__prompt_kernel_g2_l2:
  buffer_load_dword v17, v0, s[24:27], s69 offen sc1
  s_waitcnt vmcnt(0)
  v_readfirstlane_b32 s70, v17
  s_add_u32 s71, s71, 1
  s_nop 2
  s_cmp_ge_u32 s70, 16
  s_cbranch_scc1 L_parallel_sum__linear_kernel_hedgehog__glu_gated_reglu__prompt_kernel_g2_l2_ok
  s_cmp_ge_u32 s71, 1048576
  s_cbranch_scc1 L_parallel_sum__linear_kernel_hedgehog__glu_gated_reglu__prompt_kernel_g2_l2_ok
  s_sleep 1
  s_branch L_parallel_sum__linear_kernel_hedgehog__glu_gated_reglu__prompt_kernel_g2_l2
L_parallel_sum__linear_kernel_hedgehog__glu_gated_reglu__prompt_kernel_g2_l2_ok:
  s_add_u32 s20, s60, 0x2800000
  s_addc_u32 s21, s61, 0
  s_and_b32 s21, s21, 0xffff
  s_mov_b32 s22, 0x30000
  s_mov_b32 s23, 0x20000
  s_mul_i32 s70, s49, 6144
  v_lshlrev_b32 v42, 3, v1
  v_and_b32 v43, 48, v1
  v_lshlrev_b32 v43, 3, v43
  s_add_u32 s71, s70, 4096
  buffer_load_dwordx2 v[18:19], v42, s[20:23], s70 offen offset:0 sc1
  buffer_load_dwordx2 v[20:21], v42, s[20:23], s70 offen offset:1024 sc1
  buffer_load_dwordx2 v[22:23], v42, s[20:23], s70 offen offset:512 sc1
  buffer_load_dwordx2 v[24:25], v42, s[20:23], s70 offen offset:1536 sc1
  buffer_load_dwordx2 v[26:27], v42, s[20:23], s70 offen offset:2048 sc1
  buffer_load_dwordx2 v[28:29], v42, s[20:23], s70 offen offset:3072 sc1
  buffer_load_dwordx2 v[30:31], v42, s[20:23], s70 offen offset:2560 sc1
  buffer_load_dwordx2 v[32:33], v42, s[20:23], s70 offen offset:3584 sc1
  buffer_load_dwordx2 v[34:35], v43, s[20:23], s71 offen offset:0 sc1
  buffer_load_dwordx2 v[36:37], v43, s[20:23], s71 offen offset:512 sc1
  buffer_load_dwordx2 v[38:39], v43, s[20:23], s71 offen offset:1024 sc1
  buffer_load_dwordx2 v[40:41], v43, s[20:23], s71 offen offset:1536 sc1
  s_bitcmp1_b32 s3, 0
  s_cbranch_scc1 L_parallel_sum__linear_kernel_hedgehog__glu_gated_reglu__prompt_kernel_g2_ph
  s_lshl_b32 s70, s3, 12
  v_add_u32 v44, s70, v2
  v_add_u32 v44, 65536, v44
  ds_read_b128 a[0:3], v44 offset:0
  ds_read_b128 a[4:7], v44 offset:1024
  ds_read_b128 a[8:11], v44 offset:2048
  ds_read_b128 a[12:15], v44 offset:3072
  ds_read_b128 a[16:19], v44 offset:4096
  ds_read_b128 a[20:23], v44 offset:5120
  ds_read_b128 a[24:27], v44 offset:6144
  ds_read_b128 a[28:31], v44 offset:7168
  s_add_u32 s76, s76, 589824
L_parallel_sum__linear_kernel_hedgehog__glu_gated_reglu__prompt_kernel_g2_ph:
  s_waitcnt vmcnt(27) lgkmcnt(0)
  v_mfma_f32_16x16x32_bf16 v[128:131], v[64:67], a[224:227], v[128:131]
  buffer_load_dwordx4 a[208:211], v2, s[8:11], s28 offen sc1
  v_mfma_f32_16x16x32_bf16 v[132:135], v[64:67], a[228:231], v[132:135]
  ds_read_b64_tr_b16 v[96:97], v8 offset:57344
  v_mfma_f32_16x16x32_bf16 v[136:139], v[64:67], a[232:235], v[136:139]
  ds_read_b64_tr_b16 v[98:99], v8 offset:61440
  v_mfma_f32_16x16x32_bf16 v[140:143], v[64:67], a[236:239], v[140:143]
  buffer_load_dwordx4 a[212:215], v3, s[8:11], s28 offen sc1
  v_mfma_f32_16x16x32_bf16 v[156:159], v[68:71], a[236:239], v[156:159]
  ds_read_b64_tr_b16 v[100:101], v9 offset:57344
  v_mfma_f32_16x16x32_bf16 v[152:155], v[68:71], a[232:235], v[152:155]
  buffer_load_dwordx4 a[216:219], v4, s[8:11], s28 offen sc1
  v_mfma_f32_16x16x32_bf16 v[148:151], v[68:71], a[228:231], v[148:151]
  ds_read_b64_tr_b16 v[102:103], v9 offset:61440
  v_mfma_f32_16x16x32_bf16 v[144:147], v[68:71], a[224:227], v[144:147]
  v_mfma_f32_16x16x32_bf16 v[160:163], v[72:75], a[224:227], v[160:163]
  ds_read_b64_tr_b16 v[104:105], v11 offset:57344
  v_mfma_f32_16x16x32_bf16 v[164:167], v[72:75], a[228:231], v[164:167]
  buffer_load_dwordx4 a[220:223], v5, s[8:11], s28 offen sc1
  v_mfma_f32_16x16x32_bf16 v[168:171], v[72:75], a[232:235], v[168:171]
  ds_read_b64_tr_b16 v[106:107], v11 offset:61440
  v_mfma_f32_16x16x32_bf16 v[172:175], v[72:75], a[236:239], v[172:175]
  s_add_u32 s28, s28, 1024
  v_mfma_f32_16x16x32_bf16 v[188:191], v[76:79], a[236:239], v[188:191]
  ds_read_b64_tr_b16 v[108:109], v12 offset:57344
  v_mfma_f32_16x16x32_bf16 v[184:187], v[76:79], a[232:235], v[184:187]
  ds_read_b64_tr_b16 v[110:111], v12 offset:61440
  v_mfma_f32_16x16x32_bf16 v[180:183], v[76:79], a[228:231], v[180:183]
  s_add_u32 m0, s68, 32768
  v_mfma_f32_16x16x32_bf16 v[176:179], v[76:79], a[224:227], v[176:179]
  v_mfma_f32_16x16x32_bf16 v[192:195], v[80:83], a[224:227], v[192:195]
  ds_read_b64_tr_b16 v[112:113], v13 offset:57344
  v_mfma_f32_16x16x32_bf16 v[196:199], v[80:83], a[228:231], v[196:199]
  buffer_load_dwordx4 v10, s[12:15], s29 offen lds
  v_mfma_f32_16x16x32_bf16 v[200:203], v[80:83], a[232:235], v[200:203]
  ds_read_b64_tr_b16 v[114:115], v13 offset:61440
  v_mfma_f32_16x16x32_bf16 v[204:207], v[80:83], a[236:239], v[204:207]
  ds_read_b64_tr_b16 v[116:117], v14 offset:57344
  v_mfma_f32_16x16x32_bf16 v[220:223], v[84:87], a[236:239], v[220:223]
  s_add_u32 s29, s29, 32768
  v_mfma_f32_16x16x32_bf16 v[216:219], v[84:87], a[232:235], v[216:219]
  ds_read_b64_tr_b16 v[118:119], v14 offset:61440
  v_mfma_f32_16x16x32_bf16 v[212:215], v[84:87], a[228:231], v[212:215]
  s_add_u32 m0, s68, 36864
  v_mfma_f32_16x16x32_bf16 v[208:211], v[84:87], a[224:227], v[208:211]
  v_mfma_f32_16x16x32_bf16 v[224:227], v[88:91], a[224:227], v[224:227]
  ds_read_b64_tr_b16 v[120:121], v15 offset:57344
  v_mfma_f32_16x16x32_bf16 v[228:231], v[88:91], a[228:231], v[228:231]
  ds_read_b64_tr_b16 v[122:123], v15 offset:61440
  v_mfma_f32_16x16x32_bf16 v[232:235], v[88:91], a[232:235], v[232:235]
  buffer_load_dwordx4 v10, s[12:15], s29 offen lds
  v_mfma_f32_16x16x32_bf16 v[236:239], v[88:91], a[236:239], v[236:239]
  ds_read_b64_tr_b16 v[124:125], v62 offset:57344
  v_mfma_f32_16x16x32_bf16 v[252:255], v[92:95], a[236:239], v[252:255]
  s_add_u32 s29, s29, 32768
  v_mfma_f32_16x16x32_bf16 v[248:251], v[92:95], a[232:235], v[248:251]
  ds_read_b64_tr_b16 v[126:127], v62 offset:61440
  v_mfma_f32_16x16x32_bf16 v[244:247], v[92:95], a[228:231], v[244:247]
  v_mfma_f32_16x16x32_bf16 v[240:243], v[92:95], a[224:227], v[240:243]
  s_waitcnt vmcnt(6) lgkmcnt(0)
  v_mfma_f32_16x16x32_bf16 v[64:67], v[18:21], a[0:3], 0
  v_mfma_f32_16x16x32_bf16 v[68:71], v[22:25], a[0:3], 0
  v_mfma_f32_16x16x32_bf16 v[42:45], v[34:37], a[0:3], 0
  v_mfma_f32_16x16x32_bf16 v[72:75], v[18:21], a[8:11], 0
  v_mfma_f32_16x16x32_bf16 v[76:79], v[22:25], a[8:11], 0
  v_mfma_f32_16x16x32_bf16 v[46:49], v[34:37], a[8:11], 0
  v_mfma_f32_16x16x32_bf16 v[80:83], v[18:21], a[16:19], 0
  v_mfma_f32_16x16x32_bf16 v[84:87], v[22:25], a[16:19], 0
  v_mfma_f32_16x16x32_bf16 v[50:53], v[34:37], a[16:19], 0
  v_mfma_f32_16x16x32_bf16 v[88:91], v[18:21], a[24:27], 0
  v_mfma_f32_16x16x32_bf16 v[92:95], v[22:25], a[24:27], 0
  v_mfma_f32_16x16x32_bf16 v[54:57], v[34:37], a[24:27], 0
  v_mfma_f32_16x16x32_bf16 v[64:67], v[26:29], a[4:7], v[64:67]
  v_mfma_f32_16x16x32_bf16 v[68:71], v[30:33], a[4:7], v[68:71]
  v_mfma_f32_16x16x32_bf16 v[42:45], v[38:41], a[4:7], v[42:45]
  v_mfma_f32_16x16x32_bf16 v[72:75], v[26:29], a[12:15], v[72:75]
  v_mfma_f32_16x16x32_bf16 v[76:79], v[30:33], a[12:15], v[76:79]
  v_mfma_f32_16x16x32_bf16 v[46:49], v[38:41], a[12:15], v[46:49]
  v_mfma_f32_16x16x32_bf16 v[80:83], v[26:29], a[20:23], v[80:83]
  v_mfma_f32_16x16x32_bf16 v[84:87], v[30:33], a[20:23], v[84:87]
  v_mfma_f32_16x16x32_bf16 v[50:53], v[38:41], a[20:23], v[50:53]
  v_mfma_f32_16x16x32_bf16 v[88:91], v[26:29], a[28:31], v[88:91]
  v_mfma_f32_16x16x32_bf16 v[92:95], v[30:33], a[28:31], v[92:95]
  v_mfma_f32_16x16x32_bf16 v[54:57], v[38:41], a[28:31], v[54:57]
  v_add_f32 v42, 0x358637bd, v42
  s_nop 0
  v_add_f32 v46, 0x358637bd, v46
  s_nop 1
  v_add_f32 v50, 0x358637bd, v50
  s_nop 1
  v_add_f32 v54, 0x358637bd, v54
  v_rcp_f32 v42, v42
  v_rcp_f32 v46, v46
  v_rcp_f32 v50, v50
  v_rcp_f32 v54, v54
  v_pk_mul_f32 v[64:65], v[64:65], v[42:43] op_sel_hi:[1,0]
  v_pk_mul_f32 v[66:67], v[66:67], v[42:43] op_sel_hi:[1,0]
  v_pk_mul_f32 v[68:69], v[68:69], v[42:43] op_sel_hi:[1,0]
  v_pk_mul_f32 v[70:71], v[70:71], v[42:43] op_sel_hi:[1,0]
  v_pk_mul_f32 v[72:73], v[72:73], v[46:47] op_sel_hi:[1,0]
  v_pk_mul_f32 v[74:75], v[74:75], v[46:47] op_sel_hi:[1,0]
  v_pk_mul_f32 v[76:77], v[76:77], v[46:47] op_sel_hi:[1,0]
  v_pk_mul_f32 v[78:79], v[78:79], v[46:47] op_sel_hi:[1,0]
  v_pk_mul_f32 v[80:81], v[80:81], v[50:51] op_sel_hi:[1,0]
  v_pk_mul_f32 v[82:83], v[82:83], v[50:51] op_sel_hi:[1,0]
  v_pk_mul_f32 v[84:85], v[84:85], v[50:51] op_sel_hi:[1,0]
  v_pk_mul_f32 v[86:87], v[86:87], v[50:51] op_sel_hi:[1,0]
  v_pk_mul_f32 v[88:89], v[88:89], v[54:55] op_sel_hi:[1,0]
  v_pk_mul_f32 v[90:91], v[90:91], v[54:55] op_sel_hi:[1,0]
  v_pk_mul_f32 v[92:93], v[92:93], v[54:55] op_sel_hi:[1,0]
  v_pk_mul_f32 v[94:95], v[94:95], v[54:55] op_sel_hi:[1,0]
  s_mov_b32 s70, s76
  v_cvt_pk_bf16_f32 v18, v64, v65
  v_cvt_pk_bf16_f32 v19, v66, v67
  v_cvt_pk_bf16_f32 v20, v68, v69
  v_cvt_pk_bf16_f32 v21, v70, v71
  buffer_store_dwordx4 v[18:21], v2, s[8:11], s70 offen sc1
  s_add_u32 s70, s70, 147456
  v_cvt_pk_bf16_f32 v22, v72, v73
  v_cvt_pk_bf16_f32 v23, v74, v75
  v_cvt_pk_bf16_f32 v24, v76, v77
  v_cvt_pk_bf16_f32 v25, v78, v79
  buffer_store_dwordx4 v[22:25], v2, s[8:11], s70 offen sc1
  s_add_u32 s70, s70, 147456
  v_cvt_pk_bf16_f32 v26, v80, v81
  v_cvt_pk_bf16_f32 v27, v82, v83
  v_cvt_pk_bf16_f32 v28, v84, v85
  v_cvt_pk_bf16_f32 v29, v86, v87
  buffer_store_dwordx4 v[26:29], v2, s[8:11], s70 offen sc1
  s_add_u32 s70, s70, 147456
  v_cvt_pk_bf16_f32 v30, v88, v89
  v_cvt_pk_bf16_f32 v31, v90, v91
  v_cvt_pk_bf16_f32 v32, v92, v93
  v_cvt_pk_bf16_f32 v33, v94, v95
  buffer_store_dwordx4 v[30:33], v2, s[8:11], s70 offen sc1
  s_add_u32 s70, s70, 147456
  s_waitcnt vmcnt(30) lgkmcnt(0)
  s_barrier
  v_mfma_f32_16x16x32_bf16 v[128:131], v[96:99], a[240:243], v[128:131]
  buffer_load_dwordx4 a[224:227], v2, s[8:11], s28 offen sc1
  v_mfma_f32_16x16x32_bf16 v[132:135], v[96:99], a[244:247], v[132:135]
  ds_read_b64_tr_b16 v[64:65], v8 offset:0
  v_mfma_f32_16x16x32_bf16 v[136:139], v[96:99], a[248:251], v[136:139]
  ds_read_b64_tr_b16 v[66:67], v8 offset:4096
  v_mfma_f32_16x16x32_bf16 v[140:143], v[96:99], a[252:255], v[140:143]
  buffer_load_dwordx4 a[228:231], v3, s[8:11], s28 offen sc1
  v_mfma_f32_16x16x32_bf16 v[156:159], v[100:103], a[252:255], v[156:159]
  ds_read_b64_tr_b16 v[68:69], v9 offset:0
  v_mfma_f32_16x16x32_bf16 v[152:155], v[100:103], a[248:251], v[152:155]
  buffer_load_dwordx4 a[232:235], v4, s[8:11], s28 offen sc1
  v_mfma_f32_16x16x32_bf16 v[148:151], v[100:103], a[244:247], v[148:151]
  ds_read_b64_tr_b16 v[70:71], v9 offset:4096
  v_mfma_f32_16x16x32_bf16 v[144:147], v[100:103], a[240:243], v[144:147]
  v_mfma_f32_16x16x32_bf16 v[160:163], v[104:107], a[240:243], v[160:163]
  ds_read_b64_tr_b16 v[72:73], v11 offset:0
  v_mfma_f32_16x16x32_bf16 v[164:167], v[104:107], a[244:247], v[164:167]
  buffer_load_dwordx4 a[236:239], v5, s[8:11], s28 offen sc1
  v_mfma_f32_16x16x32_bf16 v[168:171], v[104:107], a[248:251], v[168:171]
  ds_read_b64_tr_b16 v[74:75], v11 offset:4096
  v_mfma_f32_16x16x32_bf16 v[172:175], v[104:107], a[252:255], v[172:175]
  s_add_u32 s28, s28, 1024
  v_mfma_f32_16x16x32_bf16 v[188:191], v[108:111], a[252:255], v[188:191]
  ds_read_b64_tr_b16 v[76:77], v12 offset:0
  v_mfma_f32_16x16x32_bf16 v[184:187], v[108:111], a[248:251], v[184:187]
  ds_read_b64_tr_b16 v[78:79], v12 offset:4096
  v_mfma_f32_16x16x32_bf16 v[180:183], v[108:111], a[244:247], v[180:183]
  s_add_u32 m0, s68, 40960
  v_mfma_f32_16x16x32_bf16 v[176:179], v[108:111], a[240:243], v[176:179]
  v_mfma_f32_16x16x32_bf16 v[192:195], v[112:115], a[240:243], v[192:195]
  ds_read_b64_tr_b16 v[80:81], v13 offset:0
  v_mfma_f32_16x16x32_bf16 v[196:199], v[112:115], a[244:247], v[196:199]
  buffer_load_dwordx4 v10, s[12:15], s29 offen lds
  v_mfma_f32_16x16x32_bf16 v[200:203], v[112:115], a[248:251], v[200:203]
  ds_read_b64_tr_b16 v[82:83], v13 offset:4096
  v_mfma_f32_16x16x32_bf16 v[204:207], v[112:115], a[252:255], v[204:207]
  ds_read_b64_tr_b16 v[84:85], v14 offset:0
  v_mfma_f32_16x16x32_bf16 v[220:223], v[116:119], a[252:255], v[220:223]
  s_add_u32 s29, s29, 32768
  v_mfma_f32_16x16x32_bf16 v[216:219], v[116:119], a[248:251], v[216:219]
  ds_read_b64_tr_b16 v[86:87], v14 offset:4096
  v_mfma_f32_16x16x32_bf16 v[212:215], v[116:119], a[244:247], v[212:215]
  s_add_u32 m0, s68, 45056
  v_mfma_f32_16x16x32_bf16 v[208:211], v[116:119], a[240:243], v[208:211]
  v_mfma_f32_16x16x32_bf16 v[224:227], v[120:123], a[240:243], v[224:227]
  ds_read_b64_tr_b16 v[88:89], v15 offset:0
  v_mfma_f32_16x16x32_bf16 v[228:231], v[120:123], a[244:247], v[228:231]
  ds_read_b64_tr_b16 v[90:91], v15 offset:4096
  v_mfma_f32_16x16x32_bf16 v[232:235], v[120:123], a[248:251], v[232:235]
  buffer_load_dwordx4 v10, s[12:15], s29 offen lds
  v_mfma_f32_16x16x32_bf16 v[236:239], v[120:123], a[252:255], v[236:239]
  ds_read_b64_tr_b16 v[92:93], v62 offset:0
  v_mfma_f32_16x16x32_bf16 v[252:255], v[124:127], a[252:255], v[252:255]
  s_add_u32 s29, s29, 32768
  v_mfma_f32_16x16x32_bf16 v[248:251], v[124:127], a[248:251], v[248:251]
  ds_read_b64_tr_b16 v[94:95], v62 offset:4096
  v_mfma_f32_16x16x32_bf16 v[244:247], v[124:127], a[244:247], v[244:247]
  v_mfma_f32_16x16x32_bf16 v[240:243], v[124:127], a[240:243], v[240:243]
  s_waitcnt vmcnt(30) lgkmcnt(0)
  v_mfma_f32_16x16x32_bf16 v[128:131], v[64:67], a[192:195], v[128:131]
  buffer_load_dwordx4 a[240:243], v2, s[8:11], s28 offen sc1
  v_mfma_f32_16x16x32_bf16 v[132:135], v[64:67], a[196:199], v[132:135]
  ds_read_b64_tr_b16 v[96:97], v8 offset:8192
  v_mfma_f32_16x16x32_bf16 v[136:139], v[64:67], a[200:203], v[136:139]
  ds_read_b64_tr_b16 v[98:99], v8 offset:12288
  v_mfma_f32_16x16x32_bf16 v[140:143], v[64:67], a[204:207], v[140:143]
  buffer_load_dwordx4 a[244:247], v3, s[8:11], s28 offen sc1
  v_mfma_f32_16x16x32_bf16 v[156:159], v[68:71], a[204:207], v[156:159]
  ds_read_b64_tr_b16 v[100:101], v9 offset:8192
  v_mfma_f32_16x16x32_bf16 v[152:155], v[68:71], a[200:203], v[152:155]
  buffer_load_dwordx4 a[248:251], v4, s[8:11], s28 offen sc1
  v_mfma_f32_16x16x32_bf16 v[148:151], v[68:71], a[196:199], v[148:151]
  ds_read_b64_tr_b16 v[102:103], v9 offset:12288
  v_mfma_f32_16x16x32_bf16 v[144:147], v[68:71], a[192:195], v[144:147]
  v_mfma_f32_16x16x32_bf16 v[160:163], v[72:75], a[192:195], v[160:163]
  ds_read_b64_tr_b16 v[104:105], v11 offset:8192
  v_mfma_f32_16x16x32_bf16 v[164:167], v[72:75], a[196:199], v[164:167]
  buffer_load_dwordx4 a[252:255], v5, s[8:11], s28 offen sc1
  v_mfma_f32_16x16x32_bf16 v[168:171], v[72:75], a[200:203], v[168:171]
  ds_read_b64_tr_b16 v[106:107], v11 offset:12288
  v_mfma_f32_16x16x32_bf16 v[172:175], v[72:75], a[204:207], v[172:175]
  s_add_u32 s28, s28, 1024
  v_mfma_f32_16x16x32_bf16 v[188:191], v[76:79], a[204:207], v[188:191]
  ds_read_b64_tr_b16 v[108:109], v12 offset:8192
  v_mfma_f32_16x16x32_bf16 v[184:187], v[76:79], a[200:203], v[184:187]
  ds_read_b64_tr_b16 v[110:111], v12 offset:12288
  v_mfma_f32_16x16x32_bf16 v[180:183], v[76:79], a[196:199], v[180:183]
  s_add_u32 m0, s68, 49152
  v_mfma_f32_16x16x32_bf16 v[176:179], v[76:79], a[192:195], v[176:179]
  v_mfma_f32_16x16x32_bf16 v[192:195], v[80:83], a[192:195], v[192:195]
  ds_read_b64_tr_b16 v[112:113], v13 offset:8192
  v_mfma_f32_16x16x32_bf16 v[196:199], v[80:83], a[196:199], v[196:199]
  buffer_load_dwordx4 v10, s[12:15], s29 offen lds
  v_mfma_f32_16x16x32_bf16 v[200:203], v[80:83], a[200:203], v[200:203]
  ds_read_b64_tr_b16 v[114:115], v13 offset:12288
  v_mfma_f32_16x16x32_bf16 v[204:207], v[80:83], a[204:207], v[204:207]
  ds_read_b64_tr_b16 v[116:117], v14 offset:8192
  v_mfma_f32_16x16x32_bf16 v[220:223], v[84:87], a[204:207], v[220:223]
  s_add_u32 s29, s29, 32768
  v_mfma_f32_16x16x32_bf16 v[216:219], v[84:87], a[200:203], v[216:219]
  ds_read_b64_tr_b16 v[118:119], v14 offset:12288
  v_mfma_f32_16x16x32_bf16 v[212:215], v[84:87], a[196:199], v[212:215]
  s_add_u32 m0, s68, 53248
  v_mfma_f32_16x16x32_bf16 v[208:211], v[84:87], a[192:195], v[208:211]
  v_mfma_f32_16x16x32_bf16 v[224:227], v[88:91], a[192:195], v[224:227]
  ds_read_b64_tr_b16 v[120:121], v15 offset:8192
  v_mfma_f32_16x16x32_bf16 v[228:231], v[88:91], a[196:199], v[228:231]
  ds_read_b64_tr_b16 v[122:123], v15 offset:12288
  v_mfma_f32_16x16x32_bf16 v[232:235], v[88:91], a[200:203], v[232:235]
  buffer_load_dwordx4 v10, s[12:15], s29 offen lds
  v_mfma_f32_16x16x32_bf16 v[236:239], v[88:91], a[204:207], v[236:239]
  ds_read_b64_tr_b16 v[124:125], v62 offset:8192
  v_mfma_f32_16x16x32_bf16 v[252:255], v[92:95], a[204:207], v[252:255]
  s_add_u32 s29, s29, 32768
  v_mfma_f32_16x16x32_bf16 v[248:251], v[92:95], a[200:203], v[248:251]
  ds_read_b64_tr_b16 v[126:127], v62 offset:12288
  v_mfma_f32_16x16x32_bf16 v[244:247], v[92:95], a[196:199], v[244:247]
  v_mfma_f32_16x16x32_bf16 v[240:243], v[92:95], a[192:195], v[240:243]
  s_waitcnt vmcnt(12)
  v_mov_b32 v16, 1
  s_mov_b64 s[70:71], exec
  s_mov_b64 exec, 1
  buffer_atomic_add v16, v0, s[24:27], s85 offen sc1
  s_mov_b64 exec, s[70:71]
  s_waitcnt vmcnt(19) lgkmcnt(0)
  s_barrier
  v_mfma_f32_16x16x32_bf16 v[128:131], v[96:99], a[208:211], v[128:131]
  buffer_load_dwordx4 a[192:195], v2, s[8:11], s28 offen sc1
  v_mfma_f32_16x16x32_bf16 v[132:135], v[96:99], a[212:215], v[132:135]
  ds_read_b64_tr_b16 v[64:65], v8 offset:16384
  v_mfma_f32_16x16x32_bf16 v[136:139], v[96:99], a[216:219], v[136:139]
  ds_read_b64_tr_b16 v[66:67], v8 offset:20480
  v_mfma_f32_16x16x32_bf16 v[140:143], v[96:99], a[220:223], v[140:143]
  buffer_load_dwordx4 a[196:199], v3, s[8:11], s28 offen sc1
  v_mfma_f32_16x16x32_bf16 v[156:159], v[100:103], a[220:223], v[156:159]
  ds_read_b64_tr_b16 v[68:69], v9 offset:16384
  v_mfma_f32_16x16x32_bf16 v[152:155], v[100:103], a[216:219], v[152:155]
  buffer_load_dwordx4 a[200:203], v4, s[8:11], s28 offen sc1
  v_mfma_f32_16x16x32_bf16 v[148:151], v[100:103], a[212:215], v[148:151]
  ds_read_b64_tr_b16 v[70:71], v9 offset:20480
  v_mfma_f32_16x16x32_bf16 v[144:147], v[100:103], a[208:211], v[144:147]
  v_mfma_f32_16x16x32_bf16 v[160:163], v[104:107], a[208:211], v[160:163]
  ds_read_b64_tr_b16 v[72:73], v11 offset:16384
  v_mfma_f32_16x16x32_bf16 v[164:167], v[104:107], a[212:215], v[164:167]
  buffer_load_dwordx4 a[204:207], v5, s[8:11], s28 offen sc1
  v_mfma_f32_16x16x32_bf16 v[168:171], v[104:107], a[216:219], v[168:171]
  ds_read_b64_tr_b16 v[74:75], v11 offset:20480
  v_mfma_f32_16x16x32_bf16 v[172:175], v[104:107], a[220:223], v[172:175]
  s_add_u32 s28, s28, 1024
  v_mfma_f32_16x16x32_bf16 v[188:191], v[108:111], a[220:223], v[188:191]
  ds_read_b64_tr_b16 v[76:77], v12 offset:16384
  v_mfma_f32_16x16x32_bf16 v[184:187], v[108:111], a[216:219], v[184:187]
  ds_read_b64_tr_b16 v[78:79], v12 offset:20480
  v_mfma_f32_16x16x32_bf16 v[180:183], v[108:111], a[212:215], v[180:183]
  s_add_u32 m0, s68, 57344
  v_mfma_f32_16x16x32_bf16 v[176:179], v[108:111], a[208:211], v[176:179]
  v_mfma_f32_16x16x32_bf16 v[192:195], v[112:115], a[208:211], v[192:195]
  ds_read_b64_tr_b16 v[80:81], v13 offset:16384
  v_mfma_f32_16x16x32_bf16 v[196:199], v[112:115], a[212:215], v[196:199]
  buffer_load_dwordx4 v10, s[12:15], s29 offen lds
  v_mfma_f32_16x16x32_bf16 v[200:203], v[112:115], a[216:219], v[200:203]
  ds_read_b64_tr_b16 v[82:83], v13 offset:20480
  v_mfma_f32_16x16x32_bf16 v[204:207], v[112:115], a[220:223], v[204:207]
  ds_read_b64_tr_b16 v[84:85], v14 offset:16384
  v_mfma_f32_16x16x32_bf16 v[220:223], v[116:119], a[220:223], v[220:223]
  s_add_u32 s29, s29, 32768
  v_mfma_f32_16x16x32_bf16 v[216:219], v[116:119], a[216:219], v[216:219]
  ds_read_b64_tr_b16 v[86:87], v14 offset:20480
  v_mfma_f32_16x16x32_bf16 v[212:215], v[116:119], a[212:215], v[212:215]
  s_add_u32 m0, s68, 61440
  v_mfma_f32_16x16x32_bf16 v[208:211], v[116:119], a[208:211], v[208:211]
  v_mfma_f32_16x16x32_bf16 v[224:227], v[120:123], a[208:211], v[224:227]
  ds_read_b64_tr_b16 v[88:89], v15 offset:16384
  v_mfma_f32_16x16x32_bf16 v[228:231], v[120:123], a[212:215], v[228:231]
  ds_read_b64_tr_b16 v[90:91], v15 offset:20480
  v_mfma_f32_16x16x32_bf16 v[232:235], v[120:123], a[216:219], v[232:235]
  buffer_load_dwordx4 v10, s[12:15], s29 offen lds
  v_mfma_f32_16x16x32_bf16 v[236:239], v[120:123], a[220:223], v[236:239]
  ds_read_b64_tr_b16 v[92:93], v62 offset:16384
  v_mfma_f32_16x16x32_bf16 v[252:255], v[124:127], a[220:223], v[252:255]
  s_add_u32 s29, s29, 32768
  v_mfma_f32_16x16x32_bf16 v[248:251], v[124:127], a[216:219], v[248:251]
  ds_read_b64_tr_b16 v[94:95], v62 offset:20480
  v_mfma_f32_16x16x32_bf16 v[244:247], v[124:127], a[212:215], v[244:247]
  v_mfma_f32_16x16x32_bf16 v[240:243], v[124:127], a[208:211], v[240:243]
  s_waitcnt vmcnt(15) lgkmcnt(0)
  v_mfma_f32_16x16x32_bf16 v[128:131], v[64:67], a[224:227], v[128:131]
  buffer_load_dwordx4 a[208:211], v2, s[8:11], s28 offen sc1
  v_mfma_f32_16x16x32_bf16 v[132:135], v[64:67], a[228:231], v[132:135]
  ds_read_b64_tr_b16 v[96:97], v8 offset:24576
  v_mfma_f32_16x16x32_bf16 v[136:139], v[64:67], a[232:235], v[136:139]
  ds_read_b64_tr_b16 v[98:99], v8 offset:28672
  v_mfma_f32_16x16x32_bf16 v[140:143], v[64:67], a[236:239], v[140:143]
  buffer_load_dwordx4 a[212:215], v3, s[8:11], s28 offen sc1
  v_mfma_f32_16x16x32_bf16 v[156:159], v[68:71], a[236:239], v[156:159]
  ds_read_b64_tr_b16 v[100:101], v9 offset:24576
  v_mfma_f32_16x16x32_bf16 v[152:155], v[68:71], a[232:235], v[152:155]
  buffer_load_dwordx4 a[216:219], v4, s[8:11], s28 offen sc1
  v_mfma_f32_16x16x32_bf16 v[148:151], v[68:71], a[228:231], v[148:151]
  ds_read_b64_tr_b16 v[102:103], v9 offset:28672
  v_mfma_f32_16x16x32_bf16 v[144:147], v[68:71], a[224:227], v[144:147]
  v_mfma_f32_16x16x32_bf16 v[160:163], v[72:75], a[224:227], v[160:163]
  ds_read_b64_tr_b16 v[104:105], v11 offset:24576
  v_mfma_f32_16x16x32_bf16 v[164:167], v[72:75], a[228:231], v[164:167]
  buffer_load_dwordx4 a[220:223], v5, s[8:11], s28 offen sc1
  v_mfma_f32_16x16x32_bf16 v[168:171], v[72:75], a[232:235], v[168:171]
  ds_read_b64_tr_b16 v[106:107], v11 offset:28672
  v_mfma_f32_16x16x32_bf16 v[172:175], v[72:75], a[236:239], v[172:175]
  s_add_u32 s28, s28, 1024
  v_mfma_f32_16x16x32_bf16 v[188:191], v[76:79], a[236:239], v[188:191]
  ds_read_b64_tr_b16 v[108:109], v12 offset:24576
  v_mfma_f32_16x16x32_bf16 v[184:187], v[76:79], a[232:235], v[184:187]
  ds_read_b64_tr_b16 v[110:111], v12 offset:28672
  v_mfma_f32_16x16x32_bf16 v[180:183], v[76:79], a[228:231], v[180:183]
  s_add_u32 m0, s68, 0
  v_mfma_f32_16x16x32_bf16 v[176:179], v[76:79], a[224:227], v[176:179]
  v_mfma_f32_16x16x32_bf16 v[192:195], v[80:83], a[224:227], v[192:195]
  ds_read_b64_tr_b16 v[112:113], v13 offset:24576
  v_mfma_f32_16x16x32_bf16 v[196:199], v[80:83], a[228:231], v[196:199]
  buffer_load_dwordx4 v10, s[12:15], s29 offen lds
  v_mfma_f32_16x16x32_bf16 v[200:203], v[80:83], a[232:235], v[200:203]
  ds_read_b64_tr_b16 v[114:115], v13 offset:28672
  v_mfma_f32_16x16x32_bf16 v[204:207], v[80:83], a[236:239], v[204:207]
  ds_read_b64_tr_b16 v[116:117], v14 offset:24576
  v_mfma_f32_16x16x32_bf16 v[220:223], v[84:87], a[236:239], v[220:223]
  s_add_u32 s29, s29, 32768
  v_mfma_f32_16x16x32_bf16 v[216:219], v[84:87], a[232:235], v[216:219]
  ds_read_b64_tr_b16 v[118:119], v14 offset:28672
  v_mfma_f32_16x16x32_bf16 v[212:215], v[84:87], a[228:231], v[212:215]
  s_add_u32 m0, s68, 4096
  v_mfma_f32_16x16x32_bf16 v[208:211], v[84:87], a[224:227], v[208:211]
  v_mfma_f32_16x16x32_bf16 v[224:227], v[88:91], a[224:227], v[224:227]
  ds_read_b64_tr_b16 v[120:121], v15 offset:24576
  v_mfma_f32_16x16x32_bf16 v[228:231], v[88:91], a[228:231], v[228:231]
  ds_read_b64_tr_b16 v[122:123], v15 offset:28672
  v_mfma_f32_16x16x32_bf16 v[232:235], v[88:91], a[232:235], v[232:235]
  buffer_load_dwordx4 v10, s[12:15], s29 offen lds
  v_mfma_f32_16x16x32_bf16 v[236:239], v[88:91], a[236:239], v[236:239]
  ds_read_b64_tr_b16 v[124:125], v62 offset:24576
  v_mfma_f32_16x16x32_bf16 v[252:255], v[92:95], a[236:239], v[252:255]
  s_add_u32 s29, s29, 32768
  v_mfma_f32_16x16x32_bf16 v[248:251], v[92:95], a[232:235], v[248:251]
  ds_read_b64_tr_b16 v[126:127], v62 offset:28672
  v_mfma_f32_16x16x32_bf16 v[244:247], v[92:95], a[228:231], v[244:247]
  v_mfma_f32_16x16x32_bf16 v[240:243], v[92:95], a[224:227], v[240:243]
  s_waitcnt vmcnt(15) lgkmcnt(0)
  s_barrier
  v_mfma_f32_16x16x32_bf16 v[128:131], v[96:99], a[240:243], v[128:131]
  buffer_load_dwordx4 a[224:227], v2, s[8:11], s28 offen sc1
  v_mfma_f32_16x16x32_bf16 v[132:135], v[96:99], a[244:247], v[132:135]
  ds_read_b64_tr_b16 v[64:65], v8 offset:32768
  v_mfma_f32_16x16x32_bf16 v[136:139], v[96:99], a[248:251], v[136:139]
  ds_read_b64_tr_b16 v[66:67], v8 offset:36864
  v_mfma_f32_16x16x32_bf16 v[140:143], v[96:99], a[252:255], v[140:143]
  buffer_load_dwordx4 a[228:231], v3, s[8:11], s28 offen sc1
  v_mfma_f32_16x16x32_bf16 v[156:159], v[100:103], a[252:255], v[156:159]
  ds_read_b64_tr_b16 v[68:69], v9 offset:32768
  v_mfma_f32_16x16x32_bf16 v[152:155], v[100:103], a[248:251], v[152:155]
  buffer_load_dwordx4 a[232:235], v4, s[8:11], s28 offen sc1
  v_mfma_f32_16x16x32_bf16 v[148:151], v[100:103], a[244:247], v[148:151]
  ds_read_b64_tr_b16 v[70:71], v9 offset:36864
  v_mfma_f32_16x16x32_bf16 v[144:147], v[100:103], a[240:243], v[144:147]
  v_mfma_f32_16x16x32_bf16 v[160:163], v[104:107], a[240:243], v[160:163]
  ds_read_b64_tr_b16 v[72:73], v11 offset:32768
  v_mfma_f32_16x16x32_bf16 v[164:167], v[104:107], a[244:247], v[164:167]
  buffer_load_dwordx4 a[236:239], v5, s[8:11], s28 offen sc1
  v_mfma_f32_16x16x32_bf16 v[168:171], v[104:107], a[248:251], v[168:171]
  ds_read_b64_tr_b16 v[74:75], v11 offset:36864
  v_mfma_f32_16x16x32_bf16 v[172:175], v[104:107], a[252:255], v[172:175]
  s_add_u32 s28, s28, 1024
  v_mfma_f32_16x16x32_bf16 v[188:191], v[108:111], a[252:255], v[188:191]
  ds_read_b64_tr_b16 v[76:77], v12 offset:32768
  v_mfma_f32_16x16x32_bf16 v[184:187], v[108:111], a[248:251], v[184:187]
  ds_read_b64_tr_b16 v[78:79], v12 offset:36864
  v_mfma_f32_16x16x32_bf16 v[180:183], v[108:111], a[244:247], v[180:183]
  s_add_u32 m0, s68, 8192
  v_mfma_f32_16x16x32_bf16 v[176:179], v[108:111], a[240:243], v[176:179]
  v_mfma_f32_16x16x32_bf16 v[192:195], v[112:115], a[240:243], v[192:195]
  ds_read_b64_tr_b16 v[80:81], v13 offset:32768
  v_mfma_f32_16x16x32_bf16 v[196:199], v[112:115], a[244:247], v[196:199]
  buffer_load_dwordx4 v10, s[12:15], s29 offen lds
  v_mfma_f32_16x16x32_bf16 v[200:203], v[112:115], a[248:251], v[200:203]
  ds_read_b64_tr_b16 v[82:83], v13 offset:36864
  v_mfma_f32_16x16x32_bf16 v[204:207], v[112:115], a[252:255], v[204:207]
  ds_read_b64_tr_b16 v[84:85], v14 offset:32768
  v_mfma_f32_16x16x32_bf16 v[220:223], v[116:119], a[252:255], v[220:223]
  s_add_u32 s29, s29, 32768
  v_mfma_f32_16x16x32_bf16 v[216:219], v[116:119], a[248:251], v[216:219]
  ds_read_b64_tr_b16 v[86:87], v14 offset:36864
  v_mfma_f32_16x16x32_bf16 v[212:215], v[116:119], a[244:247], v[212:215]
  s_add_u32 m0, s68, 12288
  v_mfma_f32_16x16x32_bf16 v[208:211], v[116:119], a[240:243], v[208:211]
  v_mfma_f32_16x16x32_bf16 v[224:227], v[120:123], a[240:243], v[224:227]
  ds_read_b64_tr_b16 v[88:89], v15 offset:32768
  v_mfma_f32_16x16x32_bf16 v[228:231], v[120:123], a[244:247], v[228:231]
  ds_read_b64_tr_b16 v[90:91], v15 offset:36864
  v_mfma_f32_16x16x32_bf16 v[232:235], v[120:123], a[248:251], v[232:235]
  buffer_load_dwordx4 v10, s[12:15], s29 offen lds
  v_mfma_f32_16x16x32_bf16 v[236:239], v[120:123], a[252:255], v[236:239]
  ds_read_b64_tr_b16 v[92:93], v62 offset:32768
  v_mfma_f32_16x16x32_bf16 v[252:255], v[124:127], a[252:255], v[252:255]
  s_add_u32 s29, s29, 32768
  v_mfma_f32_16x16x32_bf16 v[248:251], v[124:127], a[248:251], v[248:251]
  ds_read_b64_tr_b16 v[94:95], v62 offset:36864
  v_mfma_f32_16x16x32_bf16 v[244:247], v[124:127], a[244:247], v[244:247]
  v_mfma_f32_16x16x32_bf16 v[240:243], v[124:127], a[240:243], v[240:243]
  s_waitcnt vmcnt(14) lgkmcnt(0)
  v_mfma_f32_16x16x32_bf16 v[128:131], v[64:67], a[192:195], v[128:131]
  buffer_load_dwordx4 a[240:243], v2, s[8:11], s28 offen sc1
  v_mfma_f32_16x16x32_bf16 v[132:135], v[64:67], a[196:199], v[132:135]
  ds_read_b64_tr_b16 v[96:97], v8 offset:40960
  v_mfma_f32_16x16x32_bf16 v[136:139], v[64:67], a[200:203], v[136:139]
  ds_read_b64_tr_b16 v[98:99], v8 offset:45056
  v_mfma_f32_16x16x32_bf16 v[140:143], v[64:67], a[204:207], v[140:143]
  buffer_load_dwordx4 a[244:247], v3, s[8:11], s28 offen sc1
  v_mfma_f32_16x16x32_bf16 v[156:159], v[68:71], a[204:207], v[156:159]
  ds_read_b64_tr_b16 v[100:101], v9 offset:40960
  v_mfma_f32_16x16x32_bf16 v[152:155], v[68:71], a[200:203], v[152:155]
  buffer_load_dwordx4 a[248:251], v4, s[8:11], s28 offen sc1
  v_mfma_f32_16x16x32_bf16 v[148:151], v[68:71], a[196:199], v[148:151]
  ds_read_b64_tr_b16 v[102:103], v9 offset:45056
  v_mfma_f32_16x16x32_bf16 v[144:147], v[68:71], a[192:195], v[144:147]
  v_mfma_f32_16x16x32_bf16 v[160:163], v[72:75], a[192:195], v[160:163]
  ds_read_b64_tr_b16 v[104:105], v11 offset:40960
  v_mfma_f32_16x16x32_bf16 v[164:167], v[72:75], a[196:199], v[164:167]
  buffer_load_dwordx4 a[252:255], v5, s[8:11], s28 offen sc1
  v_mfma_f32_16x16x32_bf16 v[168:171], v[72:75], a[200:203], v[168:171]
  ds_read_b64_tr_b16 v[106:107], v11 offset:45056
  v_mfma_f32_16x16x32_bf16 v[172:175], v[72:75], a[204:207], v[172:175]
  s_add_u32 s28, s28, 1024
  v_mfma_f32_16x16x32_bf16 v[188:191], v[76:79], a[204:207], v[188:191]
  ds_read_b64_tr_b16 v[108:109], v12 offset:40960
  v_mfma_f32_16x16x32_bf16 v[184:187], v[76:79], a[200:203], v[184:187]
  ds_read_b64_tr_b16 v[110:111], v12 offset:45056
  v_mfma_f32_16x16x32_bf16 v[180:183], v[76:79], a[196:199], v[180:183]
  s_add_u32 m0, s68, 16384
  v_mfma_f32_16x16x32_bf16 v[176:179], v[76:79], a[192:195], v[176:179]
  v_mfma_f32_16x16x32_bf16 v[192:195], v[80:83], a[192:195], v[192:195]
  ds_read_b64_tr_b16 v[112:113], v13 offset:40960
  v_mfma_f32_16x16x32_bf16 v[196:199], v[80:83], a[196:199], v[196:199]
  buffer_load_dwordx4 v10, s[12:15], s29 offen lds
  v_mfma_f32_16x16x32_bf16 v[200:203], v[80:83], a[200:203], v[200:203]
  ds_read_b64_tr_b16 v[114:115], v13 offset:45056
  v_mfma_f32_16x16x32_bf16 v[204:207], v[80:83], a[204:207], v[204:207]
  ds_read_b64_tr_b16 v[116:117], v14 offset:40960
  v_mfma_f32_16x16x32_bf16 v[220:223], v[84:87], a[204:207], v[220:223]
  s_add_u32 s29, s29, 32768
  v_mfma_f32_16x16x32_bf16 v[216:219], v[84:87], a[200:203], v[216:219]
  ds_read_b64_tr_b16 v[118:119], v14 offset:45056
  v_mfma_f32_16x16x32_bf16 v[212:215], v[84:87], a[196:199], v[212:215]
  s_add_u32 m0, s68, 20480
  v_mfma_f32_16x16x32_bf16 v[208:211], v[84:87], a[192:195], v[208:211]
  v_mfma_f32_16x16x32_bf16 v[224:227], v[88:91], a[192:195], v[224:227]
  ds_read_b64_tr_b16 v[120:121], v15 offset:40960
  v_mfma_f32_16x16x32_bf16 v[228:231], v[88:91], a[196:199], v[228:231]
  ds_read_b64_tr_b16 v[122:123], v15 offset:45056
  v_mfma_f32_16x16x32_bf16 v[232:235], v[88:91], a[200:203], v[232:235]
  buffer_load_dwordx4 v10, s[12:15], s29 offen lds
  v_mfma_f32_16x16x32_bf16 v[236:239], v[88:91], a[204:207], v[236:239]
  ds_read_b64_tr_b16 v[124:125], v62 offset:40960
  v_mfma_f32_16x16x32_bf16 v[252:255], v[92:95], a[204:207], v[252:255]
  s_add_u32 s29, s29, 32768
  v_mfma_f32_16x16x32_bf16 v[248:251], v[92:95], a[200:203], v[248:251]
  ds_read_b64_tr_b16 v[126:127], v62 offset:45056
  v_mfma_f32_16x16x32_bf16 v[244:247], v[92:95], a[196:199], v[244:247]
  v_mfma_f32_16x16x32_bf16 v[240:243], v[92:95], a[192:195], v[240:243]
  s_waitcnt vmcnt(14) lgkmcnt(0)
  s_barrier
  v_mfma_f32_16x16x32_bf16 v[128:131], v[96:99], a[208:211], v[128:131]
  buffer_load_dwordx4 a[192:195], v2, s[8:11], s28 offen sc1
  v_mfma_f32_16x16x32_bf16 v[132:135], v[96:99], a[212:215], v[132:135]
  ds_read_b64_tr_b16 v[64:65], v8 offset:49152
  v_mfma_f32_16x16x32_bf16 v[136:139], v[96:99], a[216:219], v[136:139]
  ds_read_b64_tr_b16 v[66:67], v8 offset:53248
  v_mfma_f32_16x16x32_bf16 v[140:143], v[96:99], a[220:223], v[140:143]
  buffer_load_dwordx4 a[196:199], v3, s[8:11], s28 offen sc1
  v_mfma_f32_16x16x32_bf16 v[156:159], v[100:103], a[220:223], v[156:159]
  ds_read_b64_tr_b16 v[68:69], v9 offset:49152
  v_mfma_f32_16x16x32_bf16 v[152:155], v[100:103], a[216:219], v[152:155]
  buffer_load_dwordx4 a[200:203], v4, s[8:11], s28 offen sc1
  v_mfma_f32_16x16x32_bf16 v[148:151], v[100:103], a[212:215], v[148:151]
  ds_read_b64_tr_b16 v[70:71], v9 offset:53248
  v_mfma_f32_16x16x32_bf16 v[144:147], v[100:103], a[208:211], v[144:147]
  v_mfma_f32_16x16x32_bf16 v[160:163], v[104:107], a[208:211], v[160:163]
  ds_read_b64_tr_b16 v[72:73], v11 offset:49152
  v_mfma_f32_16x16x32_bf16 v[164:167], v[104:107], a[212:215], v[164:167]
  buffer_load_dwordx4 a[204:207], v5, s[8:11], s28 offen sc1
  v_mfma_f32_16x16x32_bf16 v[168:171], v[104:107], a[216:219], v[168:171]
  ds_read_b64_tr_b16 v[74:75], v11 offset:53248
  v_mfma_f32_16x16x32_bf16 v[172:175], v[104:107], a[220:223], v[172:175]
  s_add_u32 s28, s28, 1024
  v_mfma_f32_16x16x32_bf16 v[188:191], v[108:111], a[220:223], v[188:191]
  ds_read_b64_tr_b16 v[76:77], v12 offset:49152
  v_mfma_f32_16x16x32_bf16 v[184:187], v[108:111], a[216:219], v[184:187]
  ds_read_b64_tr_b16 v[78:79], v12 offset:53248
  v_mfma_f32_16x16x32_bf16 v[180:183], v[108:111], a[212:215], v[180:183]
  s_add_u32 m0, s68, 24576
  v_mfma_f32_16x16x32_bf16 v[176:179], v[108:111], a[208:211], v[176:179]
  v_mfma_f32_16x16x32_bf16 v[192:195], v[112:115], a[208:211], v[192:195]
  ds_read_b64_tr_b16 v[80:81], v13 offset:49152
  v_mfma_f32_16x16x32_bf16 v[196:199], v[112:115], a[212:215], v[196:199]
  buffer_load_dwordx4 v10, s[12:15], s29 offen lds
  v_mfma_f32_16x16x32_bf16 v[200:203], v[112:115], a[216:219], v[200:203]
  ds_read_b64_tr_b16 v[82:83], v13 offset:53248
  v_mfma_f32_16x16x32_bf16 v[204:207], v[112:115], a[220:223], v[204:207]
  ds_read_b64_tr_b16 v[84:85], v14 offset:49152
  v_mfma_f32_16x16x32_bf16 v[220:223], v[116:119], a[220:223], v[220:223]
  s_add_u32 s29, s29, 32768
  v_mfma_f32_16x16x32_bf16 v[216:219], v[116:119], a[216:219], v[216:219]
  ds_read_b64_tr_b16 v[86:87], v14 offset:53248
  v_mfma_f32_16x16x32_bf16 v[212:215], v[116:119], a[212:215], v[212:215]
  s_add_u32 m0, s68, 28672
  v_mfma_f32_16x16x32_bf16 v[208:211], v[116:119], a[208:211], v[208:211]
  v_mfma_f32_16x16x32_bf16 v[224:227], v[120:123], a[208:211], v[224:227]
  ds_read_b64_tr_b16 v[88:89], v15 offset:49152
  v_mfma_f32_16x16x32_bf16 v[228:231], v[120:123], a[212:215], v[228:231]
  ds_read_b64_tr_b16 v[90:91], v15 offset:53248
  v_mfma_f32_16x16x32_bf16 v[232:235], v[120:123], a[216:219], v[232:235]
  buffer_load_dwordx4 v10, s[12:15], s29 offen lds
  v_mfma_f32_16x16x32_bf16 v[236:239], v[120:123], a[220:223], v[236:239]
  ds_read_b64_tr_b16 v[92:93], v62 offset:49152
  v_mfma_f32_16x16x32_bf16 v[252:255], v[124:127], a[220:223], v[252:255]
  s_add_u32 s29, s29, 32768
  v_mfma_f32_16x16x32_bf16 v[248:251], v[124:127], a[216:219], v[248:251]
  ds_read_b64_tr_b16 v[94:95], v62 offset:53248
  v_mfma_f32_16x16x32_bf16 v[244:247], v[124:127], a[212:215], v[244:247]
  v_mfma_f32_16x16x32_bf16 v[240:243], v[124:127], a[208:211], v[240:243]
  s_waitcnt vmcnt(14) lgkmcnt(0)
  v_mfma_f32_16x16x32_bf16 v[128:131], v[64:67], a[224:227], v[128:131]
  buffer_load_dwordx4 a[208:211], v2, s[8:11], s28 offen sc1
  v_mfma_f32_16x16x32_bf16 v[132:135], v[64:67], a[228:231], v[132:135]
  ds_read_b64_tr_b16 v[96:97], v8 offset:57344
  v_mfma_f32_16x16x32_bf16 v[136:139], v[64:67], a[232:235], v[136:139]
  ds_read_b64_tr_b16 v[98:99], v8 offset:61440
  v_mfma_f32_16x16x32_bf16 v[140:143], v[64:67], a[236:239], v[140:143]
  buffer_load_dwordx4 a[212:215], v3, s[8:11], s28 offen sc1
  v_mfma_f32_16x16x32_bf16 v[156:159], v[68:71], a[236:239], v[156:159]
  ds_read_b64_tr_b16 v[100:101], v9 offset:57344
  v_mfma_f32_16x16x32_bf16 v[152:155], v[68:71], a[232:235], v[152:155]
  buffer_load_dwordx4 a[216:219], v4, s[8:11], s28 offen sc1
  v_mfma_f32_16x16x32_bf16 v[148:151], v[68:71], a[228:231], v[148:151]
  ds_read_b64_tr_b16 v[102:103], v9 offset:61440
  v_mfma_f32_16x16x32_bf16 v[144:147], v[68:71], a[224:227], v[144:147]
  buffer_load_dwordx4 a[220:223], v5, s[8:11], s28 offen sc1
  v_mfma_f32_16x16x32_bf16 v[160:163], v[72:75], a[224:227], v[160:163]
  ds_read_b64_tr_b16 v[104:105], v11 offset:57344
  v_mfma_f32_16x16x32_bf16 v[164:167], v[72:75], a[228:231], v[164:167]
  ds_read_b64_tr_b16 v[106:107], v11 offset:61440
  v_mfma_f32_16x16x32_bf16 v[168:171], v[72:75], a[232:235], v[168:171]
  s_add_u32 s28, s28, 1024
  v_mfma_f32_16x16x32_bf16 v[172:175], v[72:75], a[236:239], v[172:175]
  ds_read_b64_tr_b16 v[108:109], v12 offset:57344
  v_mfma_f32_16x16x32_bf16 v[188:191], v[76:79], a[236:239], v[188:191]
  s_mov_b32 s12, s46
  v_mfma_f32_16x16x32_bf16 v[184:187], v[76:79], a[232:235], v[184:187]
  s_mov_b32 s13, s66
  v_mfma_f32_16x16x32_bf16 v[180:183], v[76:79], a[228:231], v[180:183]
  s_mov_b32 s14, s67
  v_mfma_f32_16x16x32_bf16 v[176:179], v[76:79], a[224:227], v[176:179]
  s_mov_b32 s29, s65
  v_mfma_f32_16x16x32_bf16 v[192:195], v[80:83], a[224:227], v[192:195]
  ds_read_b64_tr_b16 v[110:111], v12 offset:61440
  v_mfma_f32_16x16x32_bf16 v[196:199], v[80:83], a[228:231], v[196:199]
  s_add_u32 m0, s68, 32768
  v_mfma_f32_16x16x32_bf16 v[200:203], v[80:83], a[232:235], v[200:203]
  ds_read_b64_tr_b16 v[112:113], v13 offset:57344
  v_mfma_f32_16x16x32_bf16 v[204:207], v[80:83], a[236:239], v[204:207]
  ds_read_b64_tr_b16 v[114:115], v13 offset:61440
  v_mfma_f32_16x16x32_bf16 v[220:223], v[84:87], a[236:239], v[220:223]
  buffer_load_dwordx4 v10, s[12:15], s29 offen lds
  v_mfma_f32_16x16x32_bf16 v[216:219], v[84:87], a[232:235], v[216:219]
  ds_read_b64_tr_b16 v[116:117], v14 offset:57344
  v_mfma_f32_16x16x32_bf16 v[212:215], v[84:87], a[228:231], v[212:215]
  s_add_u32 s29, s29, 32768
  v_mfma_f32_16x16x32_bf16 v[208:211], v[84:87], a[224:227], v[208:211]
  ds_read_b64_tr_b16 v[118:119], v14 offset:61440
  v_mfma_f32_16x16x32_bf16 v[224:227], v[88:91], a[224:227], v[224:227]
  s_add_u32 m0, s68, 36864
  v_mfma_f32_16x16x32_bf16 v[228:231], v[88:91], a[228:231], v[228:231]
  ds_read_b64_tr_b16 v[120:121], v15 offset:57344
  v_mfma_f32_16x16x32_bf16 v[232:235], v[88:91], a[232:235], v[232:235]
  ds_read_b64_tr_b16 v[122:123], v15 offset:61440
  v_mfma_f32_16x16x32_bf16 v[236:239], v[88:91], a[236:239], v[236:239]
  buffer_load_dwordx4 v10, s[12:15], s29 offen lds
  v_mfma_f32_16x16x32_bf16 v[252:255], v[92:95], a[236:239], v[252:255]
  ds_read_b64_tr_b16 v[124:125], v62 offset:57344
  v_mfma_f32_16x16x32_bf16 v[248:251], v[92:95], a[232:235], v[248:251]
  s_add_u32 s29, s29, 32768
  v_mfma_f32_16x16x32_bf16 v[244:247], v[92:95], a[228:231], v[244:247]
  ds_read_b64_tr_b16 v[126:127], v62 offset:61440
  v_mfma_f32_16x16x32_bf16 v[240:243], v[92:95], a[224:227], v[240:243]
  s_waitcnt vmcnt(14) lgkmcnt(0)
  s_barrier
  v_mfma_f32_16x16x32_bf16 v[128:131], v[96:99], a[240:243], v[128:131]
  buffer_load_dword v6, v0, s[24:27], s35 offen sc1
  v_mfma_f32_16x16x32_bf16 v[132:135], v[96:99], a[244:247], v[132:135]
  ds_read_b64_tr_b16 v[64:65], v8 offset:0
  v_mfma_f32_16x16x32_bf16 v[136:139], v[96:99], a[248:251], v[136:139]
  ds_read_b64_tr_b16 v[66:67], v8 offset:4096
  v_mfma_f32_16x16x32_bf16 v[140:143], v[96:99], a[252:255], v[140:143]
  buffer_load_dwordx4 a[224:227], v2, s[8:11], s28 offen sc1
  v_mfma_f32_16x16x32_bf16 v[156:159], v[100:103], a[252:255], v[156:159]
  ds_read_b64_tr_b16 v[68:69], v9 offset:0
  v_mfma_f32_16x16x32_bf16 v[152:155], v[100:103], a[248:251], v[152:155]
  buffer_load_dwordx4 a[228:231], v3, s[8:11], s28 offen sc1
  v_mfma_f32_16x16x32_bf16 v[148:151], v[100:103], a[244:247], v[148:151]
  ds_read_b64_tr_b16 v[70:71], v9 offset:4096
  v_mfma_f32_16x16x32_bf16 v[144:147], v[100:103], a[240:243], v[144:147]
  buffer_load_dwordx4 a[232:235], v4, s[8:11], s28 offen sc1
  v_mfma_f32_16x16x32_bf16 v[160:163], v[104:107], a[240:243], v[160:163]
  ds_read_b64_tr_b16 v[72:73], v11 offset:0
  v_mfma_f32_16x16x32_bf16 v[164:167], v[104:107], a[244:247], v[164:167]
  ds_read_b64_tr_b16 v[74:75], v11 offset:4096
  v_mfma_f32_16x16x32_bf16 v[168:171], v[104:107], a[248:251], v[168:171]
  v_mfma_f32_16x16x32_bf16 v[172:175], v[104:107], a[252:255], v[172:175]
  buffer_load_dwordx4 a[236:239], v5, s[8:11], s28 offen sc1
  v_mfma_f32_16x16x32_bf16 v[188:191], v[108:111], a[252:255], v[188:191]
  ds_read_b64_tr_b16 v[76:77], v12 offset:0
  v_mfma_f32_16x16x32_bf16 v[184:187], v[108:111], a[248:251], v[184:187]
  s_add_u32 s28, s28, 1024
  v_mfma_f32_16x16x32_bf16 v[180:183], v[108:111], a[244:247], v[180:183]
  ds_read_b64_tr_b16 v[78:79], v12 offset:4096
  v_mfma_f32_16x16x32_bf16 v[176:179], v[108:111], a[240:243], v[176:179]
  s_add_u32 m0, s68, 40960
  v_mfma_f32_16x16x32_bf16 v[192:195], v[112:115], a[240:243], v[192:195]
  ds_read_b64_tr_b16 v[80:81], v13 offset:0
  v_mfma_f32_16x16x32_bf16 v[196:199], v[112:115], a[244:247], v[196:199]
  ds_read_b64_tr_b16 v[82:83], v13 offset:4096
  v_mfma_f32_16x16x32_bf16 v[200:203], v[112:115], a[248:251], v[200:203]
  buffer_load_dwordx4 v10, s[12:15], s29 offen lds
  v_mfma_f32_16x16x32_bf16 v[204:207], v[112:115], a[252:255], v[204:207]
  ds_read_b64_tr_b16 v[84:85], v14 offset:0
  v_mfma_f32_16x16x32_bf16 v[220:223], v[116:119], a[252:255], v[220:223]
  v_mfma_f32_16x16x32_bf16 v[216:219], v[116:119], a[248:251], v[216:219]
  s_add_u32 s29, s29, 32768
  v_mfma_f32_16x16x32_bf16 v[212:215], v[116:119], a[244:247], v[212:215]
  ds_read_b64_tr_b16 v[86:87], v14 offset:4096
  v_mfma_f32_16x16x32_bf16 v[208:211], v[116:119], a[240:243], v[208:211]
  s_add_u32 m0, s68, 45056
  v_mfma_f32_16x16x32_bf16 v[224:227], v[120:123], a[240:243], v[224:227]
  ds_read_b64_tr_b16 v[88:89], v15 offset:0
  v_mfma_f32_16x16x32_bf16 v[228:231], v[120:123], a[244:247], v[228:231]
  ds_read_b64_tr_b16 v[90:91], v15 offset:4096
  v_mfma_f32_16x16x32_bf16 v[232:235], v[120:123], a[248:251], v[232:235]
  buffer_load_dwordx4 v10, s[12:15], s29 offen lds
  v_mfma_f32_16x16x32_bf16 v[236:239], v[120:123], a[252:255], v[236:239]
  ds_read_b64_tr_b16 v[92:93], v62 offset:0
  v_mfma_f32_16x16x32_bf16 v[252:255], v[124:127], a[252:255], v[252:255]
  s_add_u32 s29, s29, 32768
  v_mfma_f32_16x16x32_bf16 v[248:251], v[124:127], a[248:251], v[248:251]
  ds_read_b64_tr_b16 v[94:95], v62 offset:4096
  v_mfma_f32_16x16x32_bf16 v[244:247], v[124:127], a[244:247], v[244:247]
  v_mfma_f32_16x16x32_bf16 v[240:243], v[124:127], a[240:243], v[240:243]
  s_waitcnt vmcnt(15) lgkmcnt(0)
  v_mfma_f32_16x16x32_bf16 v[128:131], v[64:67], a[192:195], v[128:131]
  buffer_load_dwordx4 a[240:243], v2, s[8:11], s28 offen sc1
  v_mfma_f32_16x16x32_bf16 v[132:135], v[64:67], a[196:199], v[132:135]
  ds_read_b64_tr_b16 v[96:97], v8 offset:8192
  v_mfma_f32_16x16x32_bf16 v[136:139], v[64:67], a[200:203], v[136:139]
  ds_read_b64_tr_b16 v[98:99], v8 offset:12288
  v_mfma_f32_16x16x32_bf16 v[140:143], v[64:67], a[204:207], v[140:143]
  buffer_load_dwordx4 a[244:247], v3, s[8:11], s28 offen sc1
  v_mfma_f32_16x16x32_bf16 v[156:159], v[68:71], a[204:207], v[156:159]
  ds_read_b64_tr_b16 v[100:101], v9 offset:8192
  v_mfma_f32_16x16x32_bf16 v[152:155], v[68:71], a[200:203], v[152:155]
  buffer_load_dwordx4 a[248:251], v4, s[8:11], s28 offen sc1
  v_mfma_f32_16x16x32_bf16 v[148:151], v[68:71], a[196:199], v[148:151]
  ds_read_b64_tr_b16 v[102:103], v9 offset:12288
  v_mfma_f32_16x16x32_bf16 v[144:147], v[68:71], a[192:195], v[144:147]
  v_mfma_f32_16x16x32_bf16 v[160:163], v[72:75], a[192:195], v[160:163]
  ds_read_b64_tr_b16 v[104:105], v11 offset:8192
  v_mfma_f32_16x16x32_bf16 v[164:167], v[72:75], a[196:199], v[164:167]
  buffer_load_dwordx4 a[252:255], v5, s[8:11], s28 offen sc1
  v_mfma_f32_16x16x32_bf16 v[168:171], v[72:75], a[200:203], v[168:171]
  ds_read_b64_tr_b16 v[106:107], v11 offset:12288
  v_mfma_f32_16x16x32_bf16 v[172:175], v[72:75], a[204:207], v[172:175]
  s_add_u32 s28, s28, 1024
  v_mfma_f32_16x16x32_bf16 v[188:191], v[76:79], a[204:207], v[188:191]
  ds_read_b64_tr_b16 v[108:109], v12 offset:8192
  v_mfma_f32_16x16x32_bf16 v[184:187], v[76:79], a[200:203], v[184:187]
  ds_read_b64_tr_b16 v[110:111], v12 offset:12288
  v_mfma_f32_16x16x32_bf16 v[180:183], v[76:79], a[196:199], v[180:183]
  s_add_u32 m0, s68, 49152
  v_mfma_f32_16x16x32_bf16 v[176:179], v[76:79], a[192:195], v[176:179]
  v_mfma_f32_16x16x32_bf16 v[192:195], v[80:83], a[192:195], v[192:195]
  ds_read_b64_tr_b16 v[112:113], v13 offset:8192
  v_mfma_f32_16x16x32_bf16 v[196:199], v[80:83], a[196:199], v[196:199]
  buffer_load_dwordx4 v10, s[12:15], s29 offen lds
  v_mfma_f32_16x16x32_bf16 v[200:203], v[80:83], a[200:203], v[200:203]
  ds_read_b64_tr_b16 v[114:115], v13 offset:12288
  v_mfma_f32_16x16x32_bf16 v[204:207], v[80:83], a[204:207], v[204:207]
  ds_read_b64_tr_b16 v[116:117], v14 offset:8192
  v_mfma_f32_16x16x32_bf16 v[220:223], v[84:87], a[204:207], v[220:223]
  s_add_u32 s29, s29, 32768
  v_mfma_f32_16x16x32_bf16 v[216:219], v[84:87], a[200:203], v[216:219]
  ds_read_b64_tr_b16 v[118:119], v14 offset:12288
  v_mfma_f32_16x16x32_bf16 v[212:215], v[84:87], a[196:199], v[212:215]
  s_add_u32 m0, s68, 53248
  v_mfma_f32_16x16x32_bf16 v[208:211], v[84:87], a[192:195], v[208:211]
  v_mfma_f32_16x16x32_bf16 v[224:227], v[88:91], a[192:195], v[224:227]
  ds_read_b64_tr_b16 v[120:121], v15 offset:8192
  v_mfma_f32_16x16x32_bf16 v[228:231], v[88:91], a[196:199], v[228:231]
  ds_read_b64_tr_b16 v[122:123], v15 offset:12288
  v_mfma_f32_16x16x32_bf16 v[232:235], v[88:91], a[200:203], v[232:235]
  buffer_load_dwordx4 v10, s[12:15], s29 offen lds
  v_mfma_f32_16x16x32_bf16 v[236:239], v[88:91], a[204:207], v[236:239]
  ds_read_b64_tr_b16 v[124:125], v62 offset:8192
  v_mfma_f32_16x16x32_bf16 v[252:255], v[92:95], a[204:207], v[252:255]
  s_add_u32 s29, s29, 32768
  v_mfma_f32_16x16x32_bf16 v[248:251], v[92:95], a[200:203], v[248:251]
  ds_read_b64_tr_b16 v[126:127], v62 offset:12288
  v_mfma_f32_16x16x32_bf16 v[244:247], v[92:95], a[196:199], v[244:247]
  v_mfma_f32_16x16x32_bf16 v[240:243], v[92:95], a[192:195], v[240:243]
  s_waitcnt vmcnt(12) lgkmcnt(0)
  s_barrier
  v_readfirstlane_b32 s70, v6
  s_nop 3
  s_cmp_ge_u32 s70, 32
  s_cbranch_scc1 L_parallel_sum__linear_kernel_hedgehog__glu_gated_reglu__prompt_kernel_g2_of_ok
  s_mov_b32 s71, 0
L_parallel_sum__linear_kernel_hedgehog__glu_gated_reglu__prompt_kernel_g2_of:
  buffer_load_dword v6, v0, s[24:27], s35 offen sc1
  s_waitcnt vmcnt(0)
  v_readfirstlane_b32 s70, v6
  s_add_u32 s71, s71, 1
  s_nop 2
  s_cmp_ge_u32 s70, 32
  s_cbranch_scc1 L_parallel_sum__linear_kernel_hedgehog__glu_gated_reglu__prompt_kernel_g2_of_ok
  s_cmp_ge_u32 s71, 1048576
  s_cbranch_scc1 L_parallel_sum__linear_kernel_hedgehog__glu_gated_reglu__prompt_kernel_g2_of_ok
  s_sleep 1
  s_branch L_parallel_sum__linear_kernel_hedgehog__glu_gated_reglu__prompt_kernel_g2_of
L_parallel_sum__linear_kernel_hedgehog__glu_gated_reglu__prompt_kernel_g2_of_ok:
  v_mfma_f32_16x16x32_bf16 v[128:131], v[96:99], a[208:211], v[128:131]
  s_add_u32 s28, s28, s34
  v_mfma_f32_16x16x32_bf16 v[132:135], v[96:99], a[212:215], v[132:135]
  ds_read_b64_tr_b16 v[64:65], v8 offset:16384
  v_mfma_f32_16x16x32_bf16 v[136:139], v[96:99], a[216:219], v[136:139]
  ds_read_b64_tr_b16 v[66:67], v8 offset:20480
  v_mfma_f32_16x16x32_bf16 v[140:143], v[96:99], a[220:223], v[140:143]
  buffer_load_dwordx4 a[192:195], v2, s[8:11], s28 offen sc1
  v_mfma_f32_16x16x32_bf16 v[156:159], v[100:103], a[220:223], v[156:159]
  ds_read_b64_tr_b16 v[68:69], v9 offset:16384
  v_mfma_f32_16x16x32_bf16 v[152:155], v[100:103], a[216:219], v[152:155]
  buffer_load_dwordx4 a[196:199], v3, s[8:11], s28 offen sc1
  v_mfma_f32_16x16x32_bf16 v[148:151], v[100:103], a[212:215], v[148:151]
  ds_read_b64_tr_b16 v[70:71], v9 offset:20480
  v_mfma_f32_16x16x32_bf16 v[144:147], v[100:103], a[208:211], v[144:147]
  buffer_load_dwordx4 a[200:203], v4, s[8:11], s28 offen sc1
  v_mfma_f32_16x16x32_bf16 v[160:163], v[104:107], a[208:211], v[160:163]
  ds_read_b64_tr_b16 v[72:73], v11 offset:16384
  v_mfma_f32_16x16x32_bf16 v[164:167], v[104:107], a[212:215], v[164:167]
  ds_read_b64_tr_b16 v[74:75], v11 offset:20480
  v_mfma_f32_16x16x32_bf16 v[168:171], v[104:107], a[216:219], v[168:171]
  v_mfma_f32_16x16x32_bf16 v[172:175], v[104:107], a[220:223], v[172:175]
  buffer_load_dwordx4 a[204:207], v5, s[8:11], s28 offen sc1
  v_mfma_f32_16x16x32_bf16 v[188:191], v[108:111], a[220:223], v[188:191]
  ds_read_b64_tr_b16 v[76:77], v12 offset:16384
  v_mfma_f32_16x16x32_bf16 v[184:187], v[108:111], a[216:219], v[184:187]
  s_add_u32 s28, s28, 1024
  v_mfma_f32_16x16x32_bf16 v[180:183], v[108:111], a[212:215], v[180:183]
  ds_read_b64_tr_b16 v[78:79], v12 offset:20480
  v_mfma_f32_16x16x32_bf16 v[176:179], v[108:111], a[208:211], v[176:179]
  s_add_u32 m0, s68, 57344
  v_mfma_f32_16x16x32_bf16 v[192:195], v[112:115], a[208:211], v[192:195]
  ds_read_b64_tr_b16 v[80:81], v13 offset:16384
  v_mfma_f32_16x16x32_bf16 v[196:199], v[112:115], a[212:215], v[196:199]
  ds_read_b64_tr_b16 v[82:83], v13 offset:20480
  v_mfma_f32_16x16x32_bf16 v[200:203], v[112:115], a[216:219], v[200:203]
  buffer_load_dwordx4 v10, s[12:15], s29 offen lds
  v_mfma_f32_16x16x32_bf16 v[204:207], v[112:115], a[220:223], v[204:207]
  ds_read_b64_tr_b16 v[84:85], v14 offset:16384
  v_mfma_f32_16x16x32_bf16 v[220:223], v[116:119], a[220:223], v[220:223]
  v_mfma_f32_16x16x32_bf16 v[216:219], v[116:119], a[216:219], v[216:219]
  s_add_u32 s29, s29, 32768
  v_mfma_f32_16x16x32_bf16 v[212:215], v[116:119], a[212:215], v[212:215]
  ds_read_b64_tr_b16 v[86:87], v14 offset:20480
  v_mfma_f32_16x16x32_bf16 v[208:211], v[116:119], a[208:211], v[208:211]
  s_add_u32 m0, s68, 61440
  v_mfma_f32_16x16x32_bf16 v[224:227], v[120:123], a[208:211], v[224:227]
  ds_read_b64_tr_b16 v[88:89], v15 offset:16384
  v_mfma_f32_16x16x32_bf16 v[228:231], v[120:123], a[212:215], v[228:231]
  ds_read_b64_tr_b16 v[90:91], v15 offset:20480
  v_mfma_f32_16x16x32_bf16 v[232:235], v[120:123], a[216:219], v[232:235]
  buffer_load_dwordx4 v10, s[12:15], s29 offen lds
  v_mfma_f32_16x16x32_bf16 v[236:239], v[120:123], a[220:223], v[236:239]
  ds_read_b64_tr_b16 v[92:93], v62 offset:16384
  v_mfma_f32_16x16x32_bf16 v[252:255], v[124:127], a[220:223], v[252:255]
  s_add_u32 s29, s29, 32768
  v_mfma_f32_16x16x32_bf16 v[248:251], v[124:127], a[216:219], v[248:251]
  ds_read_b64_tr_b16 v[94:95], v62 offset:20480
  v_mfma_f32_16x16x32_bf16 v[244:247], v[124:127], a[212:215], v[244:247]
  v_mfma_f32_16x16x32_bf16 v[240:243], v[124:127], a[208:211], v[240:243]
  s_waitcnt vmcnt(14) lgkmcnt(0)
  v_mfma_f32_16x16x32_bf16 v[128:131], v[64:67], a[224:227], v[128:131]
  buffer_load_dwordx4 a[208:211], v2, s[8:11], s28 offen sc1
  v_mfma_f32_16x16x32_bf16 v[132:135], v[64:67], a[228:231], v[132:135]
  ds_read_b64_tr_b16 v[96:97], v8 offset:24576
  v_mfma_f32_16x16x32_bf16 v[136:139], v[64:67], a[232:235], v[136:139]
  ds_read_b64_tr_b16 v[98:99], v8 offset:28672
  v_mfma_f32_16x16x32_bf16 v[140:143], v[64:67], a[236:239], v[140:143]
  buffer_load_dwordx4 a[212:215], v3, s[8:11], s28 offen sc1
  v_mfma_f32_16x16x32_bf16 v[156:159], v[68:71], a[236:239], v[156:159]
  ds_read_b64_tr_b16 v[100:101], v9 offset:24576
  v_mfma_f32_16x16x32_bf16 v[152:155], v[68:71], a[232:235], v[152:155]
  buffer_load_dwordx4 a[216:219], v4, s[8:11], s28 offen sc1
  v_mfma_f32_16x16x32_bf16 v[148:151], v[68:71], a[228:231], v[148:151]
  ds_read_b64_tr_b16 v[102:103], v9 offset:28672
  v_mfma_f32_16x16x32_bf16 v[144:147], v[68:71], a[224:227], v[144:147]
  v_mfma_f32_16x16x32_bf16 v[160:163], v[72:75], a[224:227], v[160:163]
  ds_read_b64_tr_b16 v[104:105], v11 offset:24576
  v_mfma_f32_16x16x32_bf16 v[164:167], v[72:75], a[228:231], v[164:167]
  buffer_load_dwordx4 a[220:223], v5, s[8:11], s28 offen sc1
  v_mfma_f32_16x16x32_bf16 v[168:171], v[72:75], a[232:235], v[168:171]
  ds_read_b64_tr_b16 v[106:107], v11 offset:28672
  v_mfma_f32_16x16x32_bf16 v[172:175], v[72:75], a[236:239], v[172:175]
  s_add_u32 s28, s28, 1024
  v_mfma_f32_16x16x32_bf16 v[188:191], v[76:79], a[236:239], v[188:191]
  ds_read_b64_tr_b16 v[108:109], v12 offset:24576
  v_mfma_f32_16x16x32_bf16 v[184:187], v[76:79], a[232:235], v[184:187]
  ds_read_b64_tr_b16 v[110:111], v12 offset:28672
  v_mfma_f32_16x16x32_bf16 v[180:183], v[76:79], a[228:231], v[180:183]
  s_add_u32 m0, s68, 0
  v_mfma_f32_16x16x32_bf16 v[176:179], v[76:79], a[224:227], v[176:179]
  v_mfma_f32_16x16x32_bf16 v[192:195], v[80:83], a[224:227], v[192:195]
  ds_read_b64_tr_b16 v[112:113], v13 offset:24576
  v_mfma_f32_16x16x32_bf16 v[196:199], v[80:83], a[228:231], v[196:199]
  buffer_load_dwordx4 v10, s[12:15], s29 offen lds
  v_mfma_f32_16x16x32_bf16 v[200:203], v[80:83], a[232:235], v[200:203]
  ds_read_b64_tr_b16 v[114:115], v13 offset:28672
  v_mfma_f32_16x16x32_bf16 v[204:207], v[80:83], a[236:239], v[204:207]
  ds_read_b64_tr_b16 v[116:117], v14 offset:24576
  v_mfma_f32_16x16x32_bf16 v[220:223], v[84:87], a[236:239], v[220:223]
  s_add_u32 s29, s29, 32768
  v_mfma_f32_16x16x32_bf16 v[216:219], v[84:87], a[232:235], v[216:219]
  ds_read_b64_tr_b16 v[118:119], v14 offset:28672
  v_mfma_f32_16x16x32_bf16 v[212:215], v[84:87], a[228:231], v[212:215]
  s_add_u32 m0, s68, 4096
  v_mfma_f32_16x16x32_bf16 v[208:211], v[84:87], a[224:227], v[208:211]
  v_mfma_f32_16x16x32_bf16 v[224:227], v[88:91], a[224:227], v[224:227]
  ds_read_b64_tr_b16 v[120:121], v15 offset:24576
  v_mfma_f32_16x16x32_bf16 v[228:231], v[88:91], a[228:231], v[228:231]
  ds_read_b64_tr_b16 v[122:123], v15 offset:28672
  v_mfma_f32_16x16x32_bf16 v[232:235], v[88:91], a[232:235], v[232:235]
  buffer_load_dwordx4 v10, s[12:15], s29 offen lds
  v_mfma_f32_16x16x32_bf16 v[236:239], v[88:91], a[236:239], v[236:239]
  ds_read_b64_tr_b16 v[124:125], v62 offset:24576
  v_mfma_f32_16x16x32_bf16 v[252:255], v[92:95], a[236:239], v[252:255]
  s_add_u32 s29, s29, 32768
  v_mfma_f32_16x16x32_bf16 v[248:251], v[92:95], a[232:235], v[248:251]
  ds_read_b64_tr_b16 v[126:127], v62 offset:28672
  v_mfma_f32_16x16x32_bf16 v[244:247], v[92:95], a[228:231], v[244:247]
  v_mfma_f32_16x16x32_bf16 v[240:243], v[92:95], a[224:227], v[240:243]
  s_waitcnt vmcnt(14) lgkmcnt(0)
  s_barrier
  v_mfma_f32_16x16x32_bf16 v[128:131], v[96:99], a[240:243], v[128:131]
  buffer_load_dwordx4 a[224:227], v2, s[8:11], s28 offen sc1
  v_mfma_f32_16x16x32_bf16 v[132:135], v[96:99], a[244:247], v[132:135]
  ds_read_b64_tr_b16 v[64:65], v8 offset:32768
  v_mfma_f32_16x16x32_bf16 v[136:139], v[96:99], a[248:251], v[136:139]
  ds_read_b64_tr_b16 v[66:67], v8 offset:36864
  v_mfma_f32_16x16x32_bf16 v[140:143], v[96:99], a[252:255], v[140:143]
  buffer_load_dwordx4 a[228:231], v3, s[8:11], s28 offen sc1
  v_mfma_f32_16x16x32_bf16 v[156:159], v[100:103], a[252:255], v[156:159]
  ds_read_b64_tr_b16 v[68:69], v9 offset:32768
  v_mfma_f32_16x16x32_bf16 v[152:155], v[100:103], a[248:251], v[152:155]
  buffer_load_dwordx4 a[232:235], v4, s[8:11], s28 offen sc1
  v_mfma_f32_16x16x32_bf16 v[148:151], v[100:103], a[244:247], v[148:151]
  ds_read_b64_tr_b16 v[70:71], v9 offset:36864
  v_mfma_f32_16x16x32_bf16 v[144:147], v[100:103], a[240:243], v[144:147]
  v_mfma_f32_16x16x32_bf16 v[160:163], v[104:107], a[240:243], v[160:163]
  ds_read_b64_tr_b16 v[72:73], v11 offset:32768
  v_mfma_f32_16x16x32_bf16 v[164:167], v[104:107], a[244:247], v[164:167]
  buffer_load_dwordx4 a[236:239], v5, s[8:11], s28 offen sc1
  v_mfma_f32_16x16x32_bf16 v[168:171], v[104:107], a[248:251], v[168:171]
  ds_read_b64_tr_b16 v[74:75], v11 offset:36864
  v_mfma_f32_16x16x32_bf16 v[172:175], v[104:107], a[252:255], v[172:175]
  s_add_u32 s28, s28, 1024
  v_mfma_f32_16x16x32_bf16 v[188:191], v[108:111], a[252:255], v[188:191]
  ds_read_b64_tr_b16 v[76:77], v12 offset:32768
  v_mfma_f32_16x16x32_bf16 v[184:187], v[108:111], a[248:251], v[184:187]
  ds_read_b64_tr_b16 v[78:79], v12 offset:36864
  v_mfma_f32_16x16x32_bf16 v[180:183], v[108:111], a[244:247], v[180:183]
  s_add_u32 m0, s68, 8192
  v_mfma_f32_16x16x32_bf16 v[176:179], v[108:111], a[240:243], v[176:179]
  v_mfma_f32_16x16x32_bf16 v[192:195], v[112:115], a[240:243], v[192:195]
  ds_read_b64_tr_b16 v[80:81], v13 offset:32768
  v_mfma_f32_16x16x32_bf16 v[196:199], v[112:115], a[244:247], v[196:199]
  buffer_load_dwordx4 v10, s[12:15], s29 offen lds
  v_mfma_f32_16x16x32_bf16 v[200:203], v[112:115], a[248:251], v[200:203]
  ds_read_b64_tr_b16 v[82:83], v13 offset:36864
  v_mfma_f32_16x16x32_bf16 v[204:207], v[112:115], a[252:255], v[204:207]
  ds_read_b64_tr_b16 v[84:85], v14 offset:32768
  v_mfma_f32_16x16x32_bf16 v[220:223], v[116:119], a[252:255], v[220:223]
  s_add_u32 s29, s29, 32768
  v_mfma_f32_16x16x32_bf16 v[216:219], v[116:119], a[248:251], v[216:219]
  ds_read_b64_tr_b16 v[86:87], v14 offset:36864
  v_mfma_f32_16x16x32_bf16 v[212:215], v[116:119], a[244:247], v[212:215]
  s_add_u32 m0, s68, 12288
  v_mfma_f32_16x16x32_bf16 v[208:211], v[116:119], a[240:243], v[208:211]
  v_mfma_f32_16x16x32_bf16 v[224:227], v[120:123], a[240:243], v[224:227]
  ds_read_b64_tr_b16 v[88:89], v15 offset:32768
  v_mfma_f32_16x16x32_bf16 v[228:231], v[120:123], a[244:247], v[228:231]
  ds_read_b64_tr_b16 v[90:91], v15 offset:36864
  v_mfma_f32_16x16x32_bf16 v[232:235], v[120:123], a[248:251], v[232:235]
  buffer_load_dwordx4 v10, s[12:15], s29 offen lds
  v_mfma_f32_16x16x32_bf16 v[236:239], v[120:123], a[252:255], v[236:239]
  ds_read_b64_tr_b16 v[92:93], v62 offset:32768
  v_mfma_f32_16x16x32_bf16 v[252:255], v[124:127], a[252:255], v[252:255]
  s_add_u32 s29, s29, 32768
  v_mfma_f32_16x16x32_bf16 v[248:251], v[124:127], a[248:251], v[248:251]
  ds_read_b64_tr_b16 v[94:95], v62 offset:36864
  v_mfma_f32_16x16x32_bf16 v[244:247], v[124:127], a[244:247], v[244:247]
  v_mfma_f32_16x16x32_bf16 v[240:243], v[124:127], a[240:243], v[240:243]
  s_waitcnt vmcnt(14) lgkmcnt(0)
  v_mfma_f32_16x16x32_bf16 v[128:131], v[64:67], a[192:195], v[128:131]
  buffer_load_dwordx4 a[240:243], v2, s[8:11], s28 offen sc1
  v_mfma_f32_16x16x32_bf16 v[132:135], v[64:67], a[196:199], v[132:135]
  ds_read_b64_tr_b16 v[96:97], v8 offset:40960
  v_mfma_f32_16x16x32_bf16 v[136:139], v[64:67], a[200:203], v[136:139]
  ds_read_b64_tr_b16 v[98:99], v8 offset:45056
  v_mfma_f32_16x16x32_bf16 v[140:143], v[64:67], a[204:207], v[140:143]
  buffer_load_dwordx4 a[244:247], v3, s[8:11], s28 offen sc1
  v_mfma_f32_16x16x32_bf16 v[156:159], v[68:71], a[204:207], v[156:159]
  ds_read_b64_tr_b16 v[100:101], v9 offset:40960
  v_mfma_f32_16x16x32_bf16 v[152:155], v[68:71], a[200:203], v[152:155]
  buffer_load_dwordx4 a[248:251], v4, s[8:11], s28 offen sc1
  v_mfma_f32_16x16x32_bf16 v[148:151], v[68:71], a[196:199], v[148:151]
  ds_read_b64_tr_b16 v[102:103], v9 offset:45056
  v_mfma_f32_16x16x32_bf16 v[144:147], v[68:71], a[192:195], v[144:147]
  v_mfma_f32_16x16x32_bf16 v[160:163], v[72:75], a[192:195], v[160:163]
  ds_read_b64_tr_b16 v[104:105], v11 offset:40960
  v_mfma_f32_16x16x32_bf16 v[164:167], v[72:75], a[196:199], v[164:167]
  buffer_load_dwordx4 a[252:255], v5, s[8:11], s28 offen sc1
  v_mfma_f32_16x16x32_bf16 v[168:171], v[72:75], a[200:203], v[168:171]
  ds_read_b64_tr_b16 v[106:107], v11 offset:45056
  v_mfma_f32_16x16x32_bf16 v[172:175], v[72:75], a[204:207], v[172:175]
  s_add_u32 s28, s28, 1024
  v_mfma_f32_16x16x32_bf16 v[188:191], v[76:79], a[204:207], v[188:191]
  ds_read_b64_tr_b16 v[108:109], v12 offset:40960
  v_mfma_f32_16x16x32_bf16 v[184:187], v[76:79], a[200:203], v[184:187]
  ds_read_b64_tr_b16 v[110:111], v12 offset:45056
  v_mfma_f32_16x16x32_bf16 v[180:183], v[76:79], a[196:199], v[180:183]
  s_add_u32 m0, s68, 16384
  v_mfma_f32_16x16x32_bf16 v[176:179], v[76:79], a[192:195], v[176:179]
  v_mfma_f32_16x16x32_bf16 v[192:195], v[80:83], a[192:195], v[192:195]
  ds_read_b64_tr_b16 v[112:113], v13 offset:40960
  v_mfma_f32_16x16x32_bf16 v[196:199], v[80:83], a[196:199], v[196:199]
  buffer_load_dwordx4 v10, s[12:15], s29 offen lds
  v_mfma_f32_16x16x32_bf16 v[200:203], v[80:83], a[200:203], v[200:203]
  ds_read_b64_tr_b16 v[114:115], v13 offset:45056
  v_mfma_f32_16x16x32_bf16 v[204:207], v[80:83], a[204:207], v[204:207]
  ds_read_b64_tr_b16 v[116:117], v14 offset:40960
  v_mfma_f32_16x16x32_bf16 v[220:223], v[84:87], a[204:207], v[220:223]
  s_add_u32 s29, s29, 32768
  v_mfma_f32_16x16x32_bf16 v[216:219], v[84:87], a[200:203], v[216:219]
  ds_read_b64_tr_b16 v[118:119], v14 offset:45056
  v_mfma_f32_16x16x32_bf16 v[212:215], v[84:87], a[196:199], v[212:215]
  s_add_u32 m0, s68, 20480
  v_mfma_f32_16x16x32_bf16 v[208:211], v[84:87], a[192:195], v[208:211]
  v_mfma_f32_16x16x32_bf16 v[224:227], v[88:91], a[192:195], v[224:227]
  ds_read_b64_tr_b16 v[120:121], v15 offset:40960
  v_mfma_f32_16x16x32_bf16 v[228:231], v[88:91], a[196:199], v[228:231]
  ds_read_b64_tr_b16 v[122:123], v15 offset:45056
  v_mfma_f32_16x16x32_bf16 v[232:235], v[88:91], a[200:203], v[232:235]
  buffer_load_dwordx4 v10, s[12:15], s29 offen lds
  v_mfma_f32_16x16x32_bf16 v[236:239], v[88:91], a[204:207], v[236:239]
  ds_read_b64_tr_b16 v[124:125], v62 offset:40960
  v_mfma_f32_16x16x32_bf16 v[252:255], v[92:95], a[204:207], v[252:255]
  s_add_u32 s29, s29, 32768
  v_mfma_f32_16x16x32_bf16 v[248:251], v[92:95], a[200:203], v[248:251]
  ds_read_b64_tr_b16 v[126:127], v62 offset:45056
  v_mfma_f32_16x16x32_bf16 v[244:247], v[92:95], a[196:199], v[244:247]
  v_mfma_f32_16x16x32_bf16 v[240:243], v[92:95], a[192:195], v[240:243]
  s_waitcnt vmcnt(14) lgkmcnt(0)
  s_barrier
  v_mfma_f32_16x16x32_bf16 v[128:131], v[96:99], a[208:211], v[128:131]
  buffer_load_dwordx4 a[192:195], v2, s[8:11], s28 offen sc1
  v_mfma_f32_16x16x32_bf16 v[132:135], v[96:99], a[212:215], v[132:135]
  ds_read_b64_tr_b16 v[64:65], v8 offset:49152
  v_mfma_f32_16x16x32_bf16 v[136:139], v[96:99], a[216:219], v[136:139]
  ds_read_b64_tr_b16 v[66:67], v8 offset:53248
  v_mfma_f32_16x16x32_bf16 v[140:143], v[96:99], a[220:223], v[140:143]
  buffer_load_dwordx4 a[196:199], v3, s[8:11], s28 offen sc1
  v_mfma_f32_16x16x32_bf16 v[156:159], v[100:103], a[220:223], v[156:159]
  ds_read_b64_tr_b16 v[68:69], v9 offset:49152
  v_mfma_f32_16x16x32_bf16 v[152:155], v[100:103], a[216:219], v[152:155]
  buffer_load_dwordx4 a[200:203], v4, s[8:11], s28 offen sc1
  v_mfma_f32_16x16x32_bf16 v[148:151], v[100:103], a[212:215], v[148:151]
  ds_read_b64_tr_b16 v[70:71], v9 offset:53248
  v_mfma_f32_16x16x32_bf16 v[144:147], v[100:103], a[208:211], v[144:147]
  v_mfma_f32_16x16x32_bf16 v[160:163], v[104:107], a[208:211], v[160:163]
  ds_read_b64_tr_b16 v[72:73], v11 offset:49152
  v_mfma_f32_16x16x32_bf16 v[164:167], v[104:107], a[212:215], v[164:167]
  buffer_load_dwordx4 a[204:207], v5, s[8:11], s28 offen sc1
  v_mfma_f32_16x16x32_bf16 v[168:171], v[104:107], a[216:219], v[168:171]
  ds_read_b64_tr_b16 v[74:75], v11 offset:53248
  v_mfma_f32_16x16x32_bf16 v[172:175], v[104:107], a[220:223], v[172:175]
  s_add_u32 s28, s28, 1024
  v_mfma_f32_16x16x32_bf16 v[188:191], v[108:111], a[220:223], v[188:191]
  ds_read_b64_tr_b16 v[76:77], v12 offset:49152
  v_mfma_f32_16x16x32_bf16 v[184:187], v[108:111], a[216:219], v[184:187]
  ds_read_b64_tr_b16 v[78:79], v12 offset:53248
  v_mfma_f32_16x16x32_bf16 v[180:183], v[108:111], a[212:215], v[180:183]
  s_add_u32 m0, s68, 24576
  v_mfma_f32_16x16x32_bf16 v[176:179], v[108:111], a[208:211], v[176:179]
  v_mfma_f32_16x16x32_bf16 v[192:195], v[112:115], a[208:211], v[192:195]
  ds_read_b64_tr_b16 v[80:81], v13 offset:49152
  v_mfma_f32_16x16x32_bf16 v[196:199], v[112:115], a[212:215], v[196:199]
  buffer_load_dwordx4 v10, s[12:15], s29 offen lds
  v_mfma_f32_16x16x32_bf16 v[200:203], v[112:115], a[216:219], v[200:203]
  ds_read_b64_tr_b16 v[82:83], v13 offset:53248
  v_mfma_f32_16x16x32_bf16 v[204:207], v[112:115], a[220:223], v[204:207]
  ds_read_b64_tr_b16 v[84:85], v14 offset:49152
  v_mfma_f32_16x16x32_bf16 v[220:223], v[116:119], a[220:223], v[220:223]
  s_add_u32 s29, s29, 32768
  v_mfma_f32_16x16x32_bf16 v[216:219], v[116:119], a[216:219], v[216:219]
  ds_read_b64_tr_b16 v[86:87], v14 offset:53248
  v_mfma_f32_16x16x32_bf16 v[212:215], v[116:119], a[212:215], v[212:215]
  s_add_u32 m0, s68, 28672
  v_mfma_f32_16x16x32_bf16 v[208:211], v[116:119], a[208:211], v[208:211]
  v_mfma_f32_16x16x32_bf16 v[224:227], v[120:123], a[208:211], v[224:227]
  ds_read_b64_tr_b16 v[88:89], v15 offset:49152
  v_mfma_f32_16x16x32_bf16 v[228:231], v[120:123], a[212:215], v[228:231]
  ds_read_b64_tr_b16 v[90:91], v15 offset:53248
  v_mfma_f32_16x16x32_bf16 v[232:235], v[120:123], a[216:219], v[232:235]
  buffer_load_dwordx4 v10, s[12:15], s29 offen lds
  v_mfma_f32_16x16x32_bf16 v[236:239], v[120:123], a[220:223], v[236:239]
  ds_read_b64_tr_b16 v[92:93], v62 offset:49152
  v_mfma_f32_16x16x32_bf16 v[252:255], v[124:127], a[220:223], v[252:255]
  s_add_u32 s29, s29, 32768
  v_mfma_f32_16x16x32_bf16 v[248:251], v[124:127], a[216:219], v[248:251]
  ds_read_b64_tr_b16 v[94:95], v62 offset:53248
  v_mfma_f32_16x16x32_bf16 v[244:247], v[124:127], a[212:215], v[244:247]
  v_mfma_f32_16x16x32_bf16 v[240:243], v[124:127], a[208:211], v[240:243]
  s_waitcnt vmcnt(14) lgkmcnt(0)
  v_mfma_f32_16x16x32_bf16 v[128:131], v[64:67], a[224:227], v[128:131]
  buffer_load_dwordx4 a[208:211], v2, s[8:11], s28 offen sc1
  v_mfma_f32_16x16x32_bf16 v[132:135], v[64:67], a[228:231], v[132:135]
  ds_read_b64_tr_b16 v[96:97], v8 offset:57344
  v_mfma_f32_16x16x32_bf16 v[136:139], v[64:67], a[232:235], v[136:139]
  ds_read_b64_tr_b16 v[98:99], v8 offset:61440
  v_mfma_f32_16x16x32_bf16 v[140:143], v[64:67], a[236:239], v[140:143]
  v_mfma_f32_16x16x32_bf16 v[156:159], v[68:71], a[236:239], v[156:159]
  ds_read_b64_tr_b16 v[100:101], v9 offset:57344
  v_mfma_f32_16x16x32_bf16 v[152:155], v[68:71], a[232:235], v[152:155]
  ds_read_b64_tr_b16 v[102:103], v9 offset:61440
  v_mfma_f32_16x16x32_bf16 v[148:151], v[68:71], a[228:231], v[148:151]
  v_mfma_f32_16x16x32_bf16 v[144:147], v[68:71], a[224:227], v[144:147]
  buffer_load_dwordx4 a[212:215], v3, s[8:11], s28 offen sc1
  v_mfma_f32_16x16x32_bf16 v[160:163], v[72:75], a[224:227], v[160:163]
  ds_read_b64_tr_b16 v[104:105], v11 offset:57344
  v_mfma_f32_16x16x32_bf16 v[164:167], v[72:75], a[228:231], v[164:167]
  v_mfma_f32_16x16x32_bf16 v[168:171], v[72:75], a[232:235], v[168:171]
  ds_read_b64_tr_b16 v[106:107], v11 offset:61440
  v_mfma_f32_16x16x32_bf16 v[172:175], v[72:75], a[236:239], v[172:175]
  ds_read_b64_tr_b16 v[108:109], v12 offset:57344
  v_mfma_f32_16x16x32_bf16 v[188:191], v[76:79], a[236:239], v[188:191]
  v_mfma_f32_16x16x32_bf16 v[184:187], v[76:79], a[232:235], v[184:187]
  buffer_load_dwordx4 a[216:219], v4, s[8:11], s28 offen sc1
  v_mfma_f32_16x16x32_bf16 v[180:183], v[76:79], a[228:231], v[180:183]
  ds_read_b64_tr_b16 v[110:111], v12 offset:61440
  v_mfma_f32_16x16x32_bf16 v[176:179], v[76:79], a[224:227], v[176:179]
  v_mfma_f32_16x16x32_bf16 v[192:195], v[80:83], a[224:227], v[192:195]
  ds_read_b64_tr_b16 v[112:113], v13 offset:57344
  v_mfma_f32_16x16x32_bf16 v[196:199], v[80:83], a[228:231], v[196:199]
  ds_read_b64_tr_b16 v[114:115], v13 offset:61440
  v_mfma_f32_16x16x32_bf16 v[200:203], v[80:83], a[232:235], v[200:203]
  v_mfma_f32_16x16x32_bf16 v[204:207], v[80:83], a[236:239], v[204:207]
  buffer_load_dwordx4 a[220:223], v5, s[8:11], s28 offen sc1
  v_mfma_f32_16x16x32_bf16 v[220:223], v[84:87], a[236:239], v[220:223]
  ds_read_b64_tr_b16 v[116:117], v14 offset:57344
  v_mfma_f32_16x16x32_bf16 v[216:219], v[84:87], a[232:235], v[216:219]
  v_mfma_f32_16x16x32_bf16 v[212:215], v[84:87], a[228:231], v[212:215]
  ds_read_b64_tr_b16 v[118:119], v14 offset:61440
  v_mfma_f32_16x16x32_bf16 v[208:211], v[84:87], a[224:227], v[208:211]
  ds_read_b64_tr_b16 v[120:121], v15 offset:57344
  v_mfma_f32_16x16x32_bf16 v[224:227], v[88:91], a[224:227], v[224:227]
  v_mfma_f32_16x16x32_bf16 v[228:231], v[88:91], a[228:231], v[228:231]
  s_add_u32 s28, s28, 1024
  v_mfma_f32_16x16x32_bf16 v[232:235], v[88:91], a[232:235], v[232:235]
  ds_read_b64_tr_b16 v[122:123], v15 offset:61440
  v_mfma_f32_16x16x32_bf16 v[236:239], v[88:91], a[236:239], v[236:239]
  v_mfma_f32_16x16x32_bf16 v[252:255], v[92:95], a[236:239], v[252:255]
  ds_read_b64_tr_b16 v[124:125], v62 offset:57344
  v_mfma_f32_16x16x32_bf16 v[248:251], v[92:95], a[232:235], v[248:251]
  ds_read_b64_tr_b16 v[126:127], v62 offset:61440
  v_mfma_f32_16x16x32_bf16 v[244:247], v[92:95], a[228:231], v[244:247]
  v_mfma_f32_16x16x32_bf16 v[240:243], v[92:95], a[224:227], v[240:243]
  s_waitcnt vmcnt(12) lgkmcnt(0)
  s_barrier
  v_mfma_f32_16x16x32_bf16 v[128:131], v[96:99], a[240:243], v[128:131]
  buffer_load_dwordx4 a[224:227], v2, s[8:11], s28 offen sc1
  v_mfma_f32_16x16x32_bf16 v[132:135], v[96:99], a[244:247], v[132:135]
  ds_read_b64_tr_b16 v[64:65], v8 offset:0
  v_mfma_f32_16x16x32_bf16 v[136:139], v[96:99], a[248:251], v[136:139]
  ds_read_b64_tr_b16 v[66:67], v8 offset:4096
  v_mfma_f32_16x16x32_bf16 v[140:143], v[96:99], a[252:255], v[140:143]
  v_mfma_f32_16x16x32_bf16 v[156:159], v[100:103], a[252:255], v[156:159]
  ds_read_b64_tr_b16 v[68:69], v9 offset:0
  v_mfma_f32_16x16x32_bf16 v[152:155], v[100:103], a[248:251], v[152:155]
  ds_read_b64_tr_b16 v[70:71], v9 offset:4096
  v_mfma_f32_16x16x32_bf16 v[148:151], v[100:103], a[244:247], v[148:151]
  v_mfma_f32_16x16x32_bf16 v[144:147], v[100:103], a[240:243], v[144:147]
  buffer_load_dwordx4 a[228:231], v3, s[8:11], s28 offen sc1
  v_mfma_f32_16x16x32_bf16 v[160:163], v[104:107], a[240:243], v[160:163]
  ds_read_b64_tr_b16 v[72:73], v11 offset:0
  v_mfma_f32_16x16x32_bf16 v[164:167], v[104:107], a[244:247], v[164:167]
  v_mfma_f32_16x16x32_bf16 v[168:171], v[104:107], a[248:251], v[168:171]
  ds_read_b64_tr_b16 v[74:75], v11 offset:4096
  v_mfma_f32_16x16x32_bf16 v[172:175], v[104:107], a[252:255], v[172:175]
  ds_read_b64_tr_b16 v[76:77], v12 offset:0
  v_mfma_f32_16x16x32_bf16 v[188:191], v[108:111], a[252:255], v[188:191]
  v_mfma_f32_16x16x32_bf16 v[184:187], v[108:111], a[248:251], v[184:187]
  buffer_load_dwordx4 a[232:235], v4, s[8:11], s28 offen sc1
  v_mfma_f32_16x16x32_bf16 v[180:183], v[108:111], a[244:247], v[180:183]
  ds_read_b64_tr_b16 v[78:79], v12 offset:4096
  v_mfma_f32_16x16x32_bf16 v[176:179], v[108:111], a[240:243], v[176:179]
  v_mfma_f32_16x16x32_bf16 v[192:195], v[112:115], a[240:243], v[192:195]
  ds_read_b64_tr_b16 v[80:81], v13 offset:0
  v_mfma_f32_16x16x32_bf16 v[196:199], v[112:115], a[244:247], v[196:199]
  ds_read_b64_tr_b16 v[82:83], v13 offset:4096
  v_mfma_f32_16x16x32_bf16 v[200:203], v[112:115], a[248:251], v[200:203]
  v_mfma_f32_16x16x32_bf16 v[204:207], v[112:115], a[252:255], v[204:207]
  buffer_load_dwordx4 a[236:239], v5, s[8:11], s28 offen sc1
  v_mfma_f32_16x16x32_bf16 v[220:223], v[116:119], a[252:255], v[220:223]
  ds_read_b64_tr_b16 v[84:85], v14 offset:0
  v_mfma_f32_16x16x32_bf16 v[216:219], v[116:119], a[248:251], v[216:219]
  v_mfma_f32_16x16x32_bf16 v[212:215], v[116:119], a[244:247], v[212:215]
  ds_read_b64_tr_b16 v[86:87], v14 offset:4096
  v_mfma_f32_16x16x32_bf16 v[208:211], v[116:119], a[240:243], v[208:211]
  ds_read_b64_tr_b16 v[88:89], v15 offset:0
  v_mfma_f32_16x16x32_bf16 v[224:227], v[120:123], a[240:243], v[224:227]
  v_mfma_f32_16x16x32_bf16 v[228:231], v[120:123], a[244:247], v[228:231]
  s_add_u32 s28, s28, 1024
  v_mfma_f32_16x16x32_bf16 v[232:235], v[120:123], a[248:251], v[232:235]
  ds_read_b64_tr_b16 v[90:91], v15 offset:4096
  v_mfma_f32_16x16x32_bf16 v[236:239], v[120:123], a[252:255], v[236:239]
  v_mfma_f32_16x16x32_bf16 v[252:255], v[124:127], a[252:255], v[252:255]
  ds_read_b64_tr_b16 v[92:93], v62 offset:0
  v_mfma_f32_16x16x32_bf16 v[248:251], v[124:127], a[248:251], v[248:251]
  ds_read_b64_tr_b16 v[94:95], v62 offset:4096
  v_mfma_f32_16x16x32_bf16 v[244:247], v[124:127], a[244:247], v[244:247]
  v_mfma_f32_16x16x32_bf16 v[240:243], v[124:127], a[240:243], v[240:243]
  s_waitcnt vmcnt(10) lgkmcnt(0)
  v_mfma_f32_16x16x32_bf16 v[128:131], v[64:67], a[192:195], v[128:131]
  buffer_load_dwordx4 a[240:243], v2, s[8:11], s28 offen sc1
  v_mfma_f32_16x16x32_bf16 v[132:135], v[64:67], a[196:199], v[132:135]
  ds_read_b64_tr_b16 v[96:97], v8 offset:8192
  v_mfma_f32_16x16x32_bf16 v[136:139], v[64:67], a[200:203], v[136:139]
  ds_read_b64_tr_b16 v[98:99], v8 offset:12288
  v_mfma_f32_16x16x32_bf16 v[140:143], v[64:67], a[204:207], v[140:143]
  v_mfma_f32_16x16x32_bf16 v[156:159], v[68:71], a[204:207], v[156:159]
  ds_read_b64_tr_b16 v[100:101], v9 offset:8192
  v_mfma_f32_16x16x32_bf16 v[152:155], v[68:71], a[200:203], v[152:155]
  ds_read_b64_tr_b16 v[102:103], v9 offset:12288
  v_mfma_f32_16x16x32_bf16 v[148:151], v[68:71], a[196:199], v[148:151]
  v_mfma_f32_16x16x32_bf16 v[144:147], v[68:71], a[192:195], v[144:147]
  buffer_load_dwordx4 a[244:247], v3, s[8:11], s28 offen sc1
  v_mfma_f32_16x16x32_bf16 v[160:163], v[72:75], a[192:195], v[160:163]
  ds_read_b64_tr_b16 v[104:105], v11 offset:8192
  v_mfma_f32_16x16x32_bf16 v[164:167], v[72:75], a[196:199], v[164:167]
  v_mfma_f32_16x16x32_bf16 v[168:171], v[72:75], a[200:203], v[168:171]
  ds_read_b64_tr_b16 v[106:107], v11 offset:12288
  v_mfma_f32_16x16x32_bf16 v[172:175], v[72:75], a[204:207], v[172:175]
  ds_read_b64_tr_b16 v[108:109], v12 offset:8192
  v_mfma_f32_16x16x32_bf16 v[188:191], v[76:79], a[204:207], v[188:191]
  v_mfma_f32_16x16x32_bf16 v[184:187], v[76:79], a[200:203], v[184:187]
  buffer_load_dwordx4 a[248:251], v4, s[8:11], s28 offen sc1
  v_mfma_f32_16x16x32_bf16 v[180:183], v[76:79], a[196:199], v[180:183]
  ds_read_b64_tr_b16 v[110:111], v12 offset:12288
  v_mfma_f32_16x16x32_bf16 v[176:179], v[76:79], a[192:195], v[176:179]
  v_mfma_f32_16x16x32_bf16 v[192:195], v[80:83], a[192:195], v[192:195]
  ds_read_b64_tr_b16 v[112:113], v13 offset:8192
  v_mfma_f32_16x16x32_bf16 v[196:199], v[80:83], a[196:199], v[196:199]
  ds_read_b64_tr_b16 v[114:115], v13 offset:12288
  v_mfma_f32_16x16x32_bf16 v[200:203], v[80:83], a[200:203], v[200:203]
  v_mfma_f32_16x16x32_bf16 v[204:207], v[80:83], a[204:207], v[204:207]
  buffer_load_dwordx4 a[252:255], v5, s[8:11], s28 offen sc1
  v_mfma_f32_16x16x32_bf16 v[220:223], v[84:87], a[204:207], v[220:223]
  ds_read_b64_tr_b16 v[116:117], v14 offset:8192
  v_mfma_f32_16x16x32_bf16 v[216:219], v[84:87], a[200:203], v[216:219]
  v_mfma_f32_16x16x32_bf16 v[212:215], v[84:87], a[196:199], v[212:215]
  ds_read_b64_tr_b16 v[118:119], v14 offset:12288
  v_mfma_f32_16x16x32_bf16 v[208:211], v[84:87], a[192:195], v[208:211]
  ds_read_b64_tr_b16 v[120:121], v15 offset:8192
  v_mfma_f32_16x16x32_bf16 v[224:227], v[88:91], a[192:195], v[224:227]
  v_mfma_f32_16x16x32_bf16 v[228:231], v[88:91], a[196:199], v[228:231]
  s_add_u32 s28, s28, 1024
  v_mfma_f32_16x16x32_bf16 v[232:235], v[88:91], a[200:203], v[232:235]
  ds_read_b64_tr_b16 v[122:123], v15 offset:12288
  v_mfma_f32_16x16x32_bf16 v[236:239], v[88:91], a[204:207], v[236:239]
  v_mfma_f32_16x16x32_bf16 v[252:255], v[92:95], a[204:207], v[252:255]
  ds_read_b64_tr_b16 v[124:125], v62 offset:8192
  v_mfma_f32_16x16x32_bf16 v[248:251], v[92:95], a[200:203], v[248:251]
  ds_read_b64_tr_b16 v[126:127], v62 offset:12288
  v_mfma_f32_16x16x32_bf16 v[244:247], v[92:95], a[196:199], v[244:247]
  v_mfma_f32_16x16x32_bf16 v[240:243], v[92:95], a[192:195], v[240:243]
  s_waitcnt vmcnt(8) lgkmcnt(0)
  s_barrier
  v_mfma_f32_16x16x32_bf16 v[128:131], v[96:99], a[208:211], v[128:131]
  ds_read_b64_tr_b16 v[64:65], v8 offset:16384
  v_mfma_f32_16x16x32_bf16 v[132:135], v[96:99], a[212:215], v[132:135]
  ds_read_b64_tr_b16 v[66:67], v8 offset:20480
  v_mfma_f32_16x16x32_bf16 v[136:139], v[96:99], a[216:219], v[136:139]
  v_mfma_f32_16x16x32_bf16 v[140:143], v[96:99], a[220:223], v[140:143]
  ds_read_b64_tr_b16 v[68:69], v9 offset:16384
  v_mfma_f32_16x16x32_bf16 v[156:159], v[100:103], a[220:223], v[156:159]
  v_mfma_f32_16x16x32_bf16 v[152:155], v[100:103], a[216:219], v[152:155]
  ds_read_b64_tr_b16 v[70:71], v9 offset:20480
  v_mfma_f32_16x16x32_bf16 v[148:151], v[100:103], a[212:215], v[148:151]
  v_mfma_f32_16x16x32_bf16 v[144:147], v[100:103], a[208:211], v[144:147]
  ds_read_b64_tr_b16 v[72:73], v11 offset:16384
  v_mfma_f32_16x16x32_bf16 v[160:163], v[104:107], a[208:211], v[160:163]
  v_mfma_f32_16x16x32_bf16 v[164:167], v[104:107], a[212:215], v[164:167]
  ds_read_b64_tr_b16 v[74:75], v11 offset:20480
  v_mfma_f32_16x16x32_bf16 v[168:171], v[104:107], a[216:219], v[168:171]
  v_mfma_f32_16x16x32_bf16 v[172:175], v[104:107], a[220:223], v[172:175]
  ds_read_b64_tr_b16 v[76:77], v12 offset:16384
  v_mfma_f32_16x16x32_bf16 v[188:191], v[108:111], a[220:223], v[188:191]
  v_mfma_f32_16x16x32_bf16 v[184:187], v[108:111], a[216:219], v[184:187]
  ds_read_b64_tr_b16 v[78:79], v12 offset:20480
  v_mfma_f32_16x16x32_bf16 v[180:183], v[108:111], a[212:215], v[180:183]
  v_mfma_f32_16x16x32_bf16 v[176:179], v[108:111], a[208:211], v[176:179]
  ds_read_b64_tr_b16 v[80:81], v13 offset:16384
  v_mfma_f32_16x16x32_bf16 v[192:195], v[112:115], a[208:211], v[192:195]
  v_mfma_f32_16x16x32_bf16 v[196:199], v[112:115], a[212:215], v[196:199]
  ds_read_b64_tr_b16 v[82:83], v13 offset:20480
  v_mfma_f32_16x16x32_bf16 v[200:203], v[112:115], a[216:219], v[200:203]
  v_mfma_f32_16x16x32_bf16 v[204:207], v[112:115], a[220:223], v[204:207]
  ds_read_b64_tr_b16 v[84:85], v14 offset:16384
  v_mfma_f32_16x16x32_bf16 v[220:223], v[116:119], a[220:223], v[220:223]
  v_mfma_f32_16x16x32_bf16 v[216:219], v[116:119], a[216:219], v[216:219]
  ds_read_b64_tr_b16 v[86:87], v14 offset:20480
  v_mfma_f32_16x16x32_bf16 v[212:215], v[116:119], a[212:215], v[212:215]
  v_mfma_f32_16x16x32_bf16 v[208:211], v[116:119], a[208:211], v[208:211]
  ds_read_b64_tr_b16 v[88:89], v15 offset:16384
  v_mfma_f32_16x16x32_bf16 v[224:227], v[120:123], a[208:211], v[224:227]
  v_mfma_f32_16x16x32_bf16 v[228:231], v[120:123], a[212:215], v[228:231]
  ds_read_b64_tr_b16 v[90:91], v15 offset:20480
  v_mfma_f32_16x16x32_bf16 v[232:235], v[120:123], a[216:219], v[232:235]
  v_mfma_f32_16x16x32_bf16 v[236:239], v[120:123], a[220:223], v[236:239]
  ds_read_b64_tr_b16 v[92:93], v62 offset:16384
  v_mfma_f32_16x16x32_bf16 v[252:255], v[124:127], a[220:223], v[252:255]
  v_mfma_f32_16x16x32_bf16 v[248:251], v[124:127], a[216:219], v[248:251]
  ds_read_b64_tr_b16 v[94:95], v62 offset:20480
  v_mfma_f32_16x16x32_bf16 v[244:247], v[124:127], a[212:215], v[244:247]
  v_mfma_f32_16x16x32_bf16 v[240:243], v[124:127], a[208:211], v[240:243]
  s_waitcnt vmcnt(4) lgkmcnt(0)
  v_mfma_f32_16x16x32_bf16 v[128:131], v[64:67], a[224:227], v[128:131]
  ds_read_b64_tr_b16 v[96:97], v8 offset:24576
  v_mfma_f32_16x16x32_bf16 v[132:135], v[64:67], a[228:231], v[132:135]
  ds_read_b64_tr_b16 v[98:99], v8 offset:28672
  v_mfma_f32_16x16x32_bf16 v[136:139], v[64:67], a[232:235], v[136:139]
  v_mfma_f32_16x16x32_bf16 v[140:143], v[64:67], a[236:239], v[140:143]
  ds_read_b64_tr_b16 v[100:101], v9 offset:24576
  v_mfma_f32_16x16x32_bf16 v[156:159], v[68:71], a[236:239], v[156:159]
  v_mfma_f32_16x16x32_bf16 v[152:155], v[68:71], a[232:235], v[152:155]
  ds_read_b64_tr_b16 v[102:103], v9 offset:28672
  v_mfma_f32_16x16x32_bf16 v[148:151], v[68:71], a[228:231], v[148:151]
  v_mfma_f32_16x16x32_bf16 v[144:147], v[68:71], a[224:227], v[144:147]
  ds_read_b64_tr_b16 v[104:105], v11 offset:24576
  v_mfma_f32_16x16x32_bf16 v[160:163], v[72:75], a[224:227], v[160:163]
  v_mfma_f32_16x16x32_bf16 v[164:167], v[72:75], a[228:231], v[164:167]
  ds_read_b64_tr_b16 v[106:107], v11 offset:28672
  v_mfma_f32_16x16x32_bf16 v[168:171], v[72:75], a[232:235], v[168:171]
  v_mfma_f32_16x16x32_bf16 v[172:175], v[72:75], a[236:239], v[172:175]
  ds_read_b64_tr_b16 v[108:109], v12 offset:24576
  v_mfma_f32_16x16x32_bf16 v[188:191], v[76:79], a[236:239], v[188:191]
  v_mfma_f32_16x16x32_bf16 v[184:187], v[76:79], a[232:235], v[184:187]
  ds_read_b64_tr_b16 v[110:111], v12 offset:28672
  v_mfma_f32_16x16x32_bf16 v[180:183], v[76:79], a[228:231], v[180:183]
  v_mfma_f32_16x16x32_bf16 v[176:179], v[76:79], a[224:227], v[176:179]
  ds_read_b64_tr_b16 v[112:113], v13 offset:24576
  v_mfma_f32_16x16x32_bf16 v[192:195], v[80:83], a[224:227], v[192:195]
  v_mfma_f32_16x16x32_bf16 v[196:199], v[80:83], a[228:231], v[196:199]
  ds_read_b64_tr_b16 v[114:115], v13 offset:28672
  v_mfma_f32_16x16x32_bf16 v[200:203], v[80:83], a[232:235], v[200:203]
  v_mfma_f32_16x16x32_bf16 v[204:207], v[80:83], a[236:239], v[204:207]
  ds_read_b64_tr_b16 v[116:117], v14 offset:24576
  v_mfma_f32_16x16x32_bf16 v[220:223], v[84:87], a[236:239], v[220:223]
  v_mfma_f32_16x16x32_bf16 v[216:219], v[84:87], a[232:235], v[216:219]
  ds_read_b64_tr_b16 v[118:119], v14 offset:28672
  v_mfma_f32_16x16x32_bf16 v[212:215], v[84:87], a[228:231], v[212:215]
  v_mfma_f32_16x16x32_bf16 v[208:211], v[84:87], a[224:227], v[208:211]
  ds_read_b64_tr_b16 v[120:121], v15 offset:24576
  v_mfma_f32_16x16x32_bf16 v[224:227], v[88:91], a[224:227], v[224:227]
  v_mfma_f32_16x16x32_bf16 v[228:231], v[88:91], a[228:231], v[228:231]
  ds_read_b64_tr_b16 v[122:123], v15 offset:28672
  v_mfma_f32_16x16x32_bf16 v[232:235], v[88:91], a[232:235], v[232:235]
  v_mfma_f32_16x16x32_bf16 v[236:239], v[88:91], a[236:239], v[236:239]
  ds_read_b64_tr_b16 v[124:125], v62 offset:24576
  v_mfma_f32_16x16x32_bf16 v[252:255], v[92:95], a[236:239], v[252:255]
  v_mfma_f32_16x16x32_bf16 v[248:251], v[92:95], a[232:235], v[248:251]
  ds_read_b64_tr_b16 v[126:127], v62 offset:28672
  v_mfma_f32_16x16x32_bf16 v[244:247], v[92:95], a[228:231], v[244:247]
  v_mfma_f32_16x16x32_bf16 v[240:243], v[92:95], a[224:227], v[240:243]
  s_waitcnt vmcnt(0) lgkmcnt(0)
  s_barrier
  v_mfma_f32_16x16x32_bf16 v[128:131], v[96:99], a[240:243], v[128:131]
  v_mfma_f32_16x16x32_bf16 v[132:135], v[96:99], a[244:247], v[132:135]
  v_mfma_f32_16x16x32_bf16 v[136:139], v[96:99], a[248:251], v[136:139]
  v_mfma_f32_16x16x32_bf16 v[140:143], v[96:99], a[252:255], v[140:143]
  v_mfma_f32_16x16x32_bf16 v[156:159], v[100:103], a[252:255], v[156:159]
  v_mfma_f32_16x16x32_bf16 v[152:155], v[100:103], a[248:251], v[152:155]
  v_mfma_f32_16x16x32_bf16 v[148:151], v[100:103], a[244:247], v[148:151]
  v_mfma_f32_16x16x32_bf16 v[144:147], v[100:103], a[240:243], v[144:147]
  v_mfma_f32_16x16x32_bf16 v[160:163], v[104:107], a[240:243], v[160:163]
  v_mfma_f32_16x16x32_bf16 v[164:167], v[104:107], a[244:247], v[164:167]
  v_mfma_f32_16x16x32_bf16 v[168:171], v[104:107], a[248:251], v[168:171]
  v_mfma_f32_16x16x32_bf16 v[172:175], v[104:107], a[252:255], v[172:175]
  v_mfma_f32_16x16x32_bf16 v[188:191], v[108:111], a[252:255], v[188:191]
  v_mfma_f32_16x16x32_bf16 v[184:187], v[108:111], a[248:251], v[184:187]
  v_mfma_f32_16x16x32_bf16 v[180:183], v[108:111], a[244:247], v[180:183]
  v_mfma_f32_16x16x32_bf16 v[176:179], v[108:111], a[240:243], v[176:179]
  v_mfma_f32_16x16x32_bf16 v[192:195], v[112:115], a[240:243], v[192:195]
  v_mfma_f32_16x16x32_bf16 v[196:199], v[112:115], a[244:247], v[196:199]
  v_mfma_f32_16x16x32_bf16 v[200:203], v[112:115], a[248:251], v[200:203]
  v_mfma_f32_16x16x32_bf16 v[204:207], v[112:115], a[252:255], v[204:207]
  v_mfma_f32_16x16x32_bf16 v[220:223], v[116:119], a[252:255], v[220:223]
  v_mfma_f32_16x16x32_bf16 v[216:219], v[116:119], a[248:251], v[216:219]
  v_mfma_f32_16x16x32_bf16 v[212:215], v[116:119], a[244:247], v[212:215]
  v_mfma_f32_16x16x32_bf16 v[208:211], v[116:119], a[240:243], v[208:211]
  v_mfma_f32_16x16x32_bf16 v[224:227], v[120:123], a[240:243], v[224:227]
  v_mfma_f32_16x16x32_bf16 v[228:231], v[120:123], a[244:247], v[228:231]
  v_mfma_f32_16x16x32_bf16 v[232:235], v[120:123], a[248:251], v[232:235]
  v_mfma_f32_16x16x32_bf16 v[236:239], v[120:123], a[252:255], v[236:239]
  v_mfma_f32_16x16x32_bf16 v[252:255], v[124:127], a[252:255], v[252:255]
  v_mfma_f32_16x16x32_bf16 v[248:251], v[124:127], a[248:251], v[248:251]
  v_mfma_f32_16x16x32_bf16 v[244:247], v[124:127], a[244:247], v[244:247]
  v_mfma_f32_16x16x32_bf16 v[240:243], v[124:127], a[240:243], v[240:243]
  s_waitcnt lgkmcnt(0)
  s_nop 7
  s_waitcnt vmcnt(0)
  s_add_u32 s20, s60, 0x5000000
  s_addc_u32 s21, s61, 0
  s_and_b32 s21, s21, 0xffff
  s_mov_b32 s22, 0x2000000
  s_mov_b32 s23, 0x20000
  s_lshl_b32 s64, s4, 3
  s_add_u32 s64, s64, s5
  s_lshl_b32 s65, s64, 4
  s_add_u32 s65, s65, s6
  s_lshl_b32 s65, s65, 2
  s_add_u32 s65, s65, s3
  s_lshl_b32 s65, s65, 13
  v_lshlrev_b32 v61, 2, v1
  s_mov_b32 s8, s40
  s_and_b32 s9, s41, 0xffff
  s_mov_b32 s10, 0x400000
  s_mov_b32 s11, 0x20000
  s_mov_b32 s16, s56
  s_and_b32 s17, s57, 0xffff
  s_mov_b32 s18, 0x400000
  s_mov_b32 s19, 0x20000
  v_and_b32 v56, 15, v1
  v_lshlrev_b32 v56, 11, v56
  v_lshrrev_b32 v57, 4, v1
  v_lshl_add_u32 v58, v57, 3, v56
  v_and_b32 v59, 1, v57
  v_lshl_add_u32 v56, v59, 5, v56
  v_lshrrev_b32 v57, 1, v57
  v_lshl_add_u32 v56, v57, 4, v56
  s_lshl_b32 s28, s4, 8
  s_lshl_b32 s66, s3, 6
  s_add_u32 s28, s28, s66
  s_lshl_b32 s28, s28, 11
  s_lshl_b32 s66, s5, 8
  s_add_u32 s28, s28, s66
  s_lshl_b32 s66, s6, 6
  s_add_u32 s28, s28, s66
  s_mov_b32 s29, s28
  s_cmp_eq_u32 s6, 0
  s_cbranch_scc1 L_parallel_sum__linear_kernel_hedgehog__glu_gated_reglu__prompt_kernel_g2_own0
  v_max_f32_e64 v52, |v128|, |v129|
  v_max_f32_e64 v53, |v130|, |v131|
  v_max3_f32 v52, |v132|, |v133|, v52
  v_max3_f32 v53, |v134|, |v135|, v53
  v_max3_f32 v52, |v136|, |v137|, v52
  v_max3_f32 v53, |v138|, |v139|, v53
  v_max3_f32 v52, |v140|, |v141|, v52
  v_max3_f32 v53, |v142|, |v143|, v53
  v_max3_f32 v52, |v144|, |v145|, v52
  v_max3_f32 v53, |v146|, |v147|, v53
  v_max3_f32 v52, |v148|, |v149|, v52
  v_max3_f32 v53, |v150|, |v151|, v53
  v_max3_f32 v52, |v152|, |v153|, v52
  v_max3_f32 v53, |v154|, |v155|, v53
  v_max3_f32 v52, |v156|, |v157|, v52
  v_max3_f32 v53, |v158|, |v159|, v53
  v_max_f32 v52, v52, v53
  v_frexp_exp_i32_f32 v52, v52
  v_max_i32 v52, -100, v52
  v_sub_u32 v53, 15, v52
  v_ldexp_f32 v54, 1.0, v53
  v_subrev_u32 v53, 15, v52
  v_ldexp_f32 v55, 1.0, v53
  v_pk_mul_f32 v[128:129], v[128:129], v[54:55] op_sel_hi:[1,0]
  v_pk_mul_f32 v[130:131], v[130:131], v[54:55] op_sel_hi:[1,0]
  v_pk_mul_f32 v[144:145], v[144:145], v[54:55] op_sel_hi:[1,0]
  v_pk_mul_f32 v[146:147], v[146:147], v[54:55] op_sel_hi:[1,0]
  v_cvt_pk_f16_f32 v128, v128, v129
  v_cvt_pk_f16_f32 v129, v130, v131
  v_cvt_pk_f16_f32 v130, v144, v145
  v_cvt_pk_f16_f32 v131, v146, v147
  buffer_store_dwordx4 v[128:131], v2, s[20:23], s65 offen offset:0 sc1
  v_pk_mul_f32 v[132:133], v[132:133], v[54:55] op_sel_hi:[1,0]
  v_pk_mul_f32 v[134:135], v[134:135], v[54:55] op_sel_hi:[1,0]
  v_pk_mul_f32 v[148:149], v[148:149], v[54:55] op_sel_hi:[1,0]
  v_pk_mul_f32 v[150:151], v[150:151], v[54:55] op_sel_hi:[1,0]
  v_cvt_pk_f16_f32 v132, v132, v133
  v_cvt_pk_f16_f32 v133, v134, v135
  v_cvt_pk_f16_f32 v134, v148, v149
  v_cvt_pk_f16_f32 v135, v150, v151
  buffer_store_dwordx4 v[132:135], v2, s[20:23], s65 offen offset:1024 sc1
  v_pk_mul_f32 v[136:137], v[136:137], v[54:55] op_sel_hi:[1,0]
  v_pk_mul_f32 v[138:139], v[138:139], v[54:55] op_sel_hi:[1,0]
  v_pk_mul_f32 v[152:153], v[152:153], v[54:55] op_sel_hi:[1,0]
  v_pk_mul_f32 v[154:155], v[154:155], v[54:55] op_sel_hi:[1,0]
  v_cvt_pk_f16_f32 v136, v136, v137
  v_cvt_pk_f16_f32 v137, v138, v139
  v_cvt_pk_f16_f32 v138, v152, v153
  v_cvt_pk_f16_f32 v139, v154, v155
  buffer_store_dwordx4 v[136:139], v2, s[20:23], s65 offen offset:2048 sc1
  v_pk_mul_f32 v[140:141], v[140:141], v[54:55] op_sel_hi:[1,0]
  v_pk_mul_f32 v[142:143], v[142:143], v[54:55] op_sel_hi:[1,0]
  v_pk_mul_f32 v[156:157], v[156:157], v[54:55] op_sel_hi:[1,0]
  v_pk_mul_f32 v[158:159], v[158:159], v[54:55] op_sel_hi:[1,0]
  v_cvt_pk_f16_f32 v140, v140, v141
  v_cvt_pk_f16_f32 v141, v142, v143
  v_cvt_pk_f16_f32 v142, v156, v157
  v_cvt_pk_f16_f32 v143, v158, v159
  buffer_store_dwordx4 v[140:143], v2, s[20:23], s65 offen offset:3072 sc1
  s_add_u32 s66, s65, 4096
  buffer_store_dword v55, v61, s[20:23], s66 offen sc1
  s_branch L_parallel_sum__linear_kernel_hedgehog__glu_gated_reglu__prompt_kernel_g2_nxt0
L_parallel_sum__linear_kernel_hedgehog__glu_gated_reglu__prompt_kernel_g2_own0:
  v_pk_mov_b32 v[20:21], v[128:129], v[128:129] op_sel:[0,1]
  v_pk_mov_b32 v[22:23], v[130:131], v[130:131] op_sel:[0,1]
  v_pk_mov_b32 v[24:25], v[132:133], v[132:133] op_sel:[0,1]
  v_pk_mov_b32 v[26:27], v[134:135], v[134:135] op_sel:[0,1]
  v_pk_mov_b32 v[28:29], v[136:137], v[136:137] op_sel:[0,1]
  v_pk_mov_b32 v[30:31], v[138:139], v[138:139] op_sel:[0,1]
  v_pk_mov_b32 v[32:33], v[140:141], v[140:141] op_sel:[0,1]
  v_pk_mov_b32 v[34:35], v[142:143], v[142:143] op_sel:[0,1]
  v_pk_mov_b32 v[36:37], v[144:145], v[144:145] op_sel:[0,1]
  v_pk_mov_b32 v[38:39], v[146:147], v[146:147] op_sel:[0,1]
  v_pk_mov_b32 v[40:41], v[148:149], v[148:149] op_sel:[0,1]
  v_pk_mov_b32 v[42:43], v[150:151], v[150:151] op_sel:[0,1]
  v_pk_mov_b32 v[44:45], v[152:153], v[152:153] op_sel:[0,1]
  v_pk_mov_b32 v[46:47], v[154:155], v[154:155] op_sel:[0,1]
  v_pk_mov_b32 v[48:49], v[156:157], v[156:157] op_sel:[0,1]
  v_pk_mov_b32 v[50:51], v[158:159], v[158:159] op_sel:[0,1]
L_parallel_sum__linear_kernel_hedgehog__glu_gated_reglu__prompt_kernel_g2_nxt0:
  s_add_u32 s65, s65, 131072
  s_cmp_eq_u32 s6, 1
  s_cbranch_scc1 L_parallel_sum__linear_kernel_hedgehog__glu_gated_reglu__prompt_kernel_g2_own1
  v_max_f32_e64 v52, |v160|, |v161|
  v_max_f32_e64 v53, |v162|, |v163|
  v_max3_f32 v52, |v164|, |v165|, v52
  v_max3_f32 v53, |v166|, |v167|, v53
  v_max3_f32 v52, |v168|, |v169|, v52
  v_max3_f32 v53, |v170|, |v171|, v53
  v_max3_f32 v52, |v172|, |v173|, v52
  v_max3_f32 v53, |v174|, |v175|, v53
  v_max3_f32 v52, |v176|, |v177|, v52
  v_max3_f32 v53, |v178|, |v179|, v53
  v_max3_f32 v52, |v180|, |v181|, v52
  v_max3_f32 v53, |v182|, |v183|, v53
  v_max3_f32 v52, |v184|, |v185|, v52
  v_max3_f32 v53, |v186|, |v187|, v53
  v_max3_f32 v52, |v188|, |v189|, v52
  v_max3_f32 v53, |v190|, |v191|, v53
  v_max_f32 v52, v52, v53
  v_frexp_exp_i32_f32 v52, v52
  v_max_i32 v52, -100, v52
  v_sub_u32 v53, 15, v52
  v_ldexp_f32 v54, 1.0, v53
  v_subrev_u32 v53, 15, v52
  v_ldexp_f32 v55, 1.0, v53
  v_pk_mul_f32 v[160:161], v[160:161], v[54:55] op_sel_hi:[1,0]
  v_pk_mul_f32 v[162:163], v[162:163], v[54:55] op_sel_hi:[1,0]
  v_pk_mul_f32 v[176:177], v[176:177], v[54:55] op_sel_hi:[1,0]
  v_pk_mul_f32 v[178:179], v[178:179], v[54:55] op_sel_hi:[1,0]
  v_cvt_pk_f16_f32 v160, v160, v161
  v_cvt_pk_f16_f32 v161, v162, v163
  v_cvt_pk_f16_f32 v162, v176, v177
  v_cvt_pk_f16_f32 v163, v178, v179
  buffer_store_dwordx4 v[160:163], v2, s[20:23], s65 offen offset:0 sc1
  v_pk_mul_f32 v[164:165], v[164:165], v[54:55] op_sel_hi:[1,0]
  v_pk_mul_f32 v[166:167], v[166:167], v[54:55] op_sel_hi:[1,0]
  v_pk_mul_f32 v[180:181], v[180:181], v[54:55] op_sel_hi:[1,0]
  v_pk_mul_f32 v[182:183], v[182:183], v[54:55] op_sel_hi:[1,0]
  v_cvt_pk_f16_f32 v164, v164, v165
  v_cvt_pk_f16_f32 v165, v166, v167
  v_cvt_pk_f16_f32 v166, v180, v181
  v_cvt_pk_f16_f32 v167, v182, v183
  buffer_store_dwordx4 v[164:167], v2, s[20:23], s65 offen offset:1024 sc1
  v_pk_mul_f32 v[168:169], v[168:169], v[54:55] op_sel_hi:[1,0]
  v_pk_mul_f32 v[170:171], v[170:171], v[54:55] op_sel_hi:[1,0]
  v_pk_mul_f32 v[184:185], v[184:185], v[54:55] op_sel_hi:[1,0]
  v_pk_mul_f32 v[186:187], v[186:187], v[54:55] op_sel_hi:[1,0]
  v_cvt_pk_f16_f32 v168, v168, v169
  v_cvt_pk_f16_f32 v169, v170, v171
  v_cvt_pk_f16_f32 v170, v184, v185
  v_cvt_pk_f16_f32 v171, v186, v187
  buffer_store_dwordx4 v[168:171], v2, s[20:23], s65 offen offset:2048 sc1
  v_pk_mul_f32 v[172:173], v[172:173], v[54:55] op_sel_hi:[1,0]
  v_pk_mul_f32 v[174:175], v[174:175], v[54:55] op_sel_hi:[1,0]
  v_pk_mul_f32 v[188:189], v[188:189], v[54:55] op_sel_hi:[1,0]
  v_pk_mul_f32 v[190:191], v[190:191], v[54:55] op_sel_hi:[1,0]
  v_cvt_pk_f16_f32 v172, v172, v173
  v_cvt_pk_f16_f32 v173, v174, v175
  v_cvt_pk_f16_f32 v174, v188, v189
  v_cvt_pk_f16_f32 v175, v190, v191
  buffer_store_dwordx4 v[172:175], v2, s[20:23], s65 offen offset:3072 sc1
  s_add_u32 s66, s65, 4096
  buffer_store_dword v55, v61, s[20:23], s66 offen sc1
  s_branch L_parallel_sum__linear_kernel_hedgehog__glu_gated_reglu__prompt_kernel_g2_nxt1
L_parallel_sum__linear_kernel_hedgehog__glu_gated_reglu__prompt_kernel_g2_own1:
  v_pk_mov_b32 v[20:21], v[160:161], v[160:161] op_sel:[0,1]
  v_pk_mov_b32 v[22:23], v[162:163], v[162:163] op_sel:[0,1]
  v_pk_mov_b32 v[24:25], v[164:165], v[164:165] op_sel:[0,1]
  v_pk_mov_b32 v[26:27], v[166:167], v[166:167] op_sel:[0,1]
  v_pk_mov_b32 v[28:29], v[168:169], v[168:169] op_sel:[0,1]
  v_pk_mov_b32 v[30:31], v[170:171], v[170:171] op_sel:[0,1]
  v_pk_mov_b32 v[32:33], v[172:173], v[172:173] op_sel:[0,1]
  v_pk_mov_b32 v[34:35], v[174:175], v[174:175] op_sel:[0,1]
  v_pk_mov_b32 v[36:37], v[176:177], v[176:177] op_sel:[0,1]
  v_pk_mov_b32 v[38:39], v[178:179], v[178:179] op_sel:[0,1]
  v_pk_mov_b32 v[40:41], v[180:181], v[180:181] op_sel:[0,1]
  v_pk_mov_b32 v[42:43], v[182:183], v[182:183] op_sel:[0,1]
  v_pk_mov_b32 v[44:45], v[184:185], v[184:185] op_sel:[0,1]
  v_pk_mov_b32 v[46:47], v[186:187], v[186:187] op_sel:[0,1]
  v_pk_mov_b32 v[48:49], v[188:189], v[188:189] op_sel:[0,1]
  v_pk_mov_b32 v[50:51], v[190:191], v[190:191] op_sel:[0,1]
L_parallel_sum__linear_kernel_hedgehog__glu_gated_reglu__prompt_kernel_g2_nxt1:
  s_add_u32 s65, s65, 131072
  s_cmp_eq_u32 s6, 2
  s_cbranch_scc1 L_parallel_sum__linear_kernel_hedgehog__glu_gated_reglu__prompt_kernel_g2_own2
  v_max_f32_e64 v52, |v192|, |v193|
  v_max_f32_e64 v53, |v194|, |v195|
  v_max3_f32 v52, |v196|, |v197|, v52
  v_max3_f32 v53, |v198|, |v199|, v53
  v_max3_f32 v52, |v200|, |v201|, v52
  v_max3_f32 v53, |v202|, |v203|, v53
  v_max3_f32 v52, |v204|, |v205|, v52
  v_max3_f32 v53, |v206|, |v207|, v53
  v_max3_f32 v52, |v208|, |v209|, v52
  v_max3_f32 v53, |v210|, |v211|, v53
  v_max3_f32 v52, |v212|, |v213|, v52
  v_max3_f32 v53, |v214|, |v215|, v53
  v_max3_f32 v52, |v216|, |v217|, v52
  v_max3_f32 v53, |v218|, |v219|, v53
  v_max3_f32 v52, |v220|, |v221|, v52
  v_max3_f32 v53, |v222|, |v223|, v53
  v_max_f32 v52, v52, v53
  v_frexp_exp_i32_f32 v52, v52
  v_max_i32 v52, -100, v52
  v_sub_u32 v53, 15, v52
  v_ldexp_f32 v54, 1.0, v53
  v_subrev_u32 v53, 15, v52
  v_ldexp_f32 v55, 1.0, v53
  v_pk_mul_f32 v[192:193], v[192:193], v[54:55] op_sel_hi:[1,0]
  v_pk_mul_f32 v[194:195], v[194:195], v[54:55] op_sel_hi:[1,0]
  v_pk_mul_f32 v[208:209], v[208:209], v[54:55] op_sel_hi:[1,0]
  v_pk_mul_f32 v[210:211], v[210:211], v[54:55] op_sel_hi:[1,0]
  v_cvt_pk_f16_f32 v192, v192, v193
  v_cvt_pk_f16_f32 v193, v194, v195
  v_cvt_pk_f16_f32 v194, v208, v209
  v_cvt_pk_f16_f32 v195, v210, v211
  buffer_store_dwordx4 v[192:195], v2, s[20:23], s65 offen offset:0 sc1
  v_pk_mul_f32 v[196:197], v[196:197], v[54:55] op_sel_hi:[1,0]
  v_pk_mul_f32 v[198:199], v[198:199], v[54:55] op_sel_hi:[1,0]
  v_pk_mul_f32 v[212:213], v[212:213], v[54:55] op_sel_hi:[1,0]
  v_pk_mul_f32 v[214:215], v[214:215], v[54:55] op_sel_hi:[1,0]
  v_cvt_pk_f16_f32 v196, v196, v197
  v_cvt_pk_f16_f32 v197, v198, v199
  v_cvt_pk_f16_f32 v198, v212, v213
  v_cvt_pk_f16_f32 v199, v214, v215
  buffer_store_dwordx4 v[196:199], v2, s[20:23], s65 offen offset:1024 sc1
  v_pk_mul_f32 v[200:201], v[200:201], v[54:55] op_sel_hi:[1,0]
  v_pk_mul_f32 v[202:203], v[202:203], v[54:55] op_sel_hi:[1,0]
  v_pk_mul_f32 v[216:217], v[216:217], v[54:55] op_sel_hi:[1,0]
  v_pk_mul_f32 v[218:219], v[218:219], v[54:55] op_sel_hi:[1,0]
  v_cvt_pk_f16_f32 v200, v200, v201
  v_cvt_pk_f16_f32 v201, v202, v203
  v_cvt_pk_f16_f32 v202, v216, v217
  v_cvt_pk_f16_f32 v203, v218, v219
  buffer_store_dwordx4 v[200:203], v2, s[20:23], s65 offen offset:2048 sc1
  v_pk_mul_f32 v[204:205], v[204:205], v[54:55] op_sel_hi:[1,0]
  v_pk_mul_f32 v[206:207], v[206:207], v[54:55] op_sel_hi:[1,0]
  v_pk_mul_f32 v[220:221], v[220:221], v[54:55] op_sel_hi:[1,0]
  v_pk_mul_f32 v[222:223], v[222:223], v[54:55] op_sel_hi:[1,0]
  v_cvt_pk_f16_f32 v204, v204, v205
  v_cvt_pk_f16_f32 v205, v206, v207
  v_cvt_pk_f16_f32 v206, v220, v221
  v_cvt_pk_f16_f32 v207, v222, v223
  buffer_store_dwordx4 v[204:207], v2, s[20:23], s65 offen offset:3072 sc1
  s_add_u32 s66, s65, 4096
  buffer_store_dword v55, v61, s[20:23], s66 offen sc1
  s_branch L_parallel_sum__linear_kernel_hedgehog__glu_gated_reglu__prompt_kernel_g2_nxt2
L_parallel_sum__linear_kernel_hedgehog__glu_gated_reglu__prompt_kernel_g2_own2:
  v_pk_mov_b32 v[20:21], v[192:193], v[192:193] op_sel:[0,1]
  v_pk_mov_b32 v[22:23], v[194:195], v[194:195] op_sel:[0,1]
  v_pk_mov_b32 v[24:25], v[196:197], v[196:197] op_sel:[0,1]
  v_pk_mov_b32 v[26:27], v[198:199], v[198:199] op_sel:[0,1]
  v_pk_mov_b32 v[28:29], v[200:201], v[200:201] op_sel:[0,1]
  v_pk_mov_b32 v[30:31], v[202:203], v[202:203] op_sel:[0,1]
  v_pk_mov_b32 v[32:33], v[204:205], v[204:205] op_sel:[0,1]
  v_pk_mov_b32 v[34:35], v[206:207], v[206:207] op_sel:[0,1]
  v_pk_mov_b32 v[36:37], v[208:209], v[208:209] op_sel:[0,1]
  v_pk_mov_b32 v[38:39], v[210:211], v[210:211] op_sel:[0,1]
  v_pk_mov_b32 v[40:41], v[212:213], v[212:213] op_sel:[0,1]
  v_pk_mov_b32 v[42:43], v[214:215], v[214:215] op_sel:[0,1]
  v_pk_mov_b32 v[44:45], v[216:217], v[216:217] op_sel:[0,1]
  v_pk_mov_b32 v[46:47], v[218:219], v[218:219] op_sel:[0,1]
  v_pk_mov_b32 v[48:49], v[220:221], v[220:221] op_sel:[0,1]
  v_pk_mov_b32 v[50:51], v[222:223], v[222:223] op_sel:[0,1]
L_parallel_sum__linear_kernel_hedgehog__glu_gated_reglu__prompt_kernel_g2_nxt2:
  s_add_u32 s65, s65, 131072
  s_cmp_eq_u32 s6, 3
  s_cbranch_scc1 L_parallel_sum__linear_kernel_hedgehog__glu_gated_reglu__prompt_kernel_g2_own3
  v_max_f32_e64 v52, |v224|, |v225|
  v_max_f32_e64 v53, |v226|, |v227|
  v_max3_f32 v52, |v228|, |v229|, v52
  v_max3_f32 v53, |v230|, |v231|, v53
  v_max3_f32 v52, |v232|, |v233|, v52
  v_max3_f32 v53, |v234|, |v235|, v53
  v_max3_f32 v52, |v236|, |v237|, v52
  v_max3_f32 v53, |v238|, |v239|, v53
  v_max3_f32 v52, |v240|, |v241|, v52
  v_max3_f32 v53, |v242|, |v243|, v53
  v_max3_f32 v52, |v244|, |v245|, v52
  v_max3_f32 v53, |v246|, |v247|, v53
  v_max3_f32 v52, |v248|, |v249|, v52
  v_max3_f32 v53, |v250|, |v251|, v53
  v_max3_f32 v52, |v252|, |v253|, v52
  v_max3_f32 v53, |v254|, |v255|, v53
  v_max_f32 v52, v52, v53
  v_frexp_exp_i32_f32 v52, v52
  v_max_i32 v52, -100, v52
  v_sub_u32 v53, 15, v52
  v_ldexp_f32 v54, 1.0, v53
  v_subrev_u32 v53, 15, v52
  v_ldexp_f32 v55, 1.0, v53
  v_pk_mul_f32 v[224:225], v[224:225], v[54:55] op_sel_hi:[1,0]
  v_pk_mul_f32 v[226:227], v[226:227], v[54:55] op_sel_hi:[1,0]
  v_pk_mul_f32 v[240:241], v[240:241], v[54:55] op_sel_hi:[1,0]
  v_pk_mul_f32 v[242:243], v[242:243], v[54:55] op_sel_hi:[1,0]
  v_cvt_pk_f16_f32 v224, v224, v225
  v_cvt_pk_f16_f32 v225, v226, v227
  v_cvt_pk_f16_f32 v226, v240, v241
  v_cvt_pk_f16_f32 v227, v242, v243
  buffer_store_dwordx4 v[224:227], v2, s[20:23], s65 offen offset:0 sc1
  v_pk_mul_f32 v[228:229], v[228:229], v[54:55] op_sel_hi:[1,0]
  v_pk_mul_f32 v[230:231], v[230:231], v[54:55] op_sel_hi:[1,0]
  v_pk_mul_f32 v[244:245], v[244:245], v[54:55] op_sel_hi:[1,0]
  v_pk_mul_f32 v[246:247], v[246:247], v[54:55] op_sel_hi:[1,0]
  v_cvt_pk_f16_f32 v228, v228, v229
  v_cvt_pk_f16_f32 v229, v230, v231
  v_cvt_pk_f16_f32 v230, v244, v245
  v_cvt_pk_f16_f32 v231, v246, v247
  buffer_store_dwordx4 v[228:231], v2, s[20:23], s65 offen offset:1024 sc1
  v_pk_mul_f32 v[232:233], v[232:233], v[54:55] op_sel_hi:[1,0]
  v_pk_mul_f32 v[234:235], v[234:235], v[54:55] op_sel_hi:[1,0]
  v_pk_mul_f32 v[248:249], v[248:249], v[54:55] op_sel_hi:[1,0]
  v_pk_mul_f32 v[250:251], v[250:251], v[54:55] op_sel_hi:[1,0]
  v_cvt_pk_f16_f32 v232, v232, v233
  v_cvt_pk_f16_f32 v233, v234, v235
  v_cvt_pk_f16_f32 v234, v248, v249
  v_cvt_pk_f16_f32 v235, v250, v251
  buffer_store_dwordx4 v[232:235], v2, s[20:23], s65 offen offset:2048 sc1
  v_pk_mul_f32 v[236:237], v[236:237], v[54:55] op_sel_hi:[1,0]
  v_pk_mul_f32 v[238:239], v[238:239], v[54:55] op_sel_hi:[1,0]
  v_pk_mul_f32 v[252:253], v[252:253], v[54:55] op_sel_hi:[1,0]
  v_pk_mul_f32 v[254:255], v[254:255], v[54:55] op_sel_hi:[1,0]
  v_cvt_pk_f16_f32 v236, v236, v237
  v_cvt_pk_f16_f32 v237, v238, v239
  v_cvt_pk_f16_f32 v238, v252, v253
  v_cvt_pk_f16_f32 v239, v254, v255
  buffer_store_dwordx4 v[236:239], v2, s[20:23], s65 offen offset:3072 sc1
  s_add_u32 s66, s65, 4096
  buffer_store_dword v55, v61, s[20:23], s66 offen sc1
  s_branch L_parallel_sum__linear_kernel_hedgehog__glu_gated_reglu__prompt_kernel_g2_nxt3
L_parallel_sum__linear_kernel_hedgehog__glu_gated_reglu__prompt_kernel_g2_own3:
  v_pk_mov_b32 v[20:21], v[224:225], v[224:225] op_sel:[0,1]
  v_pk_mov_b32 v[22:23], v[226:227], v[226:227] op_sel:[0,1]
  v_pk_mov_b32 v[24:25], v[228:229], v[228:229] op_sel:[0,1]
  v_pk_mov_b32 v[26:27], v[230:231], v[230:231] op_sel:[0,1]
  v_pk_mov_b32 v[28:29], v[232:233], v[232:233] op_sel:[0,1]
  v_pk_mov_b32 v[30:31], v[234:235], v[234:235] op_sel:[0,1]
  v_pk_mov_b32 v[32:33], v[236:237], v[236:237] op_sel:[0,1]
  v_pk_mov_b32 v[34:35], v[238:239], v[238:239] op_sel:[0,1]
  v_pk_mov_b32 v[36:37], v[240:241], v[240:241] op_sel:[0,1]
  v_pk_mov_b32 v[38:39], v[242:243], v[242:243] op_sel:[0,1]
  v_pk_mov_b32 v[40:41], v[244:245], v[244:245] op_sel:[0,1]
  v_pk_mov_b32 v[42:43], v[246:247], v[246:247] op_sel:[0,1]
  v_pk_mov_b32 v[44:45], v[248:249], v[248:249] op_sel:[0,1]
  v_pk_mov_b32 v[46:47], v[250:251], v[250:251] op_sel:[0,1]
  v_pk_mov_b32 v[48:49], v[252:253], v[252:253] op_sel:[0,1]
  v_pk_mov_b32 v[50:51], v[254:255], v[254:255] op_sel:[0,1]
L_parallel_sum__linear_kernel_hedgehog__glu_gated_reglu__prompt_kernel_g2_nxt3:
  buffer_load_dwordx2 v[112:113], v58, s[8:11], s29 offen offset:0
  buffer_load_dwordx2 v[114:115], v58, s[8:11], s29 offen offset:32
  s_add_u32 s29, s29, 32768
  buffer_load_dwordx2 v[116:117], v58, s[8:11], s29 offen offset:0
  buffer_load_dwordx2 v[118:119], v58, s[8:11], s29 offen offset:32
  s_add_u32 s29, s29, 32768
  buffer_load_dwordx2 v[120:121], v58, s[8:11], s29 offen offset:0
  buffer_load_dwordx2 v[122:123], v58, s[8:11], s29 offen offset:32
  s_add_u32 s29, s29, 32768
  buffer_load_dwordx2 v[124:125], v58, s[8:11], s29 offen offset:0
  buffer_load_dwordx2 v[126:127], v58, s[8:11], s29 offen offset:32
  s_add_u32 s29, s29, 32768
  s_waitcnt vmcnt(8)
  s_lshl_b32 s66, s64, 2
  s_add_u32 s66, s66, s3
  s_lshl_b32 s66, s66, 7
  s_add_u32 s66, s66, 12288
  v_mov_b32 v58, 1
  v_mov_b32 v59, 0
  s_mov_b64 s[72:73], exec
  s_mov_b64 exec, 1
  buffer_atomic_add v58, v59, s[24:27], s66 offen sc1
  s_mov_b64 exec, s[72:73]
  s_waitcnt vmcnt(1)
  v_lshlrev_b32 v64, 16, v112
  v_and_b32 v65, 0xffff0000, v112
  v_pk_add_f32 v[20:21], v[20:21], v[64:65]
  v_lshlrev_b32 v64, 16, v113
  v_and_b32 v65, 0xffff0000, v113
  v_pk_add_f32 v[22:23], v[22:23], v[64:65]
  v_lshlrev_b32 v64, 16, v114
  v_and_b32 v65, 0xffff0000, v114
  v_pk_add_f32 v[36:37], v[36:37], v[64:65]
  v_lshlrev_b32 v64, 16, v115
  v_and_b32 v65, 0xffff0000, v115
  v_pk_add_f32 v[38:39], v[38:39], v[64:65]
  v_lshlrev_b32 v64, 16, v116
  v_and_b32 v65, 0xffff0000, v116
  v_pk_add_f32 v[24:25], v[24:25], v[64:65]
  v_lshlrev_b32 v64, 16, v117
  v_and_b32 v65, 0xffff0000, v117
  v_pk_add_f32 v[26:27], v[26:27], v[64:65]
  v_lshlrev_b32 v64, 16, v118
  v_and_b32 v65, 0xffff0000, v118
  v_pk_add_f32 v[40:41], v[40:41], v[64:65]
  v_lshlrev_b32 v64, 16, v119
  v_and_b32 v65, 0xffff0000, v119
  v_pk_add_f32 v[42:43], v[42:43], v[64:65]
  v_lshlrev_b32 v64, 16, v120
  v_and_b32 v65, 0xffff0000, v120
  v_pk_add_f32 v[28:29], v[28:29], v[64:65]
  v_lshlrev_b32 v64, 16, v121
  v_and_b32 v65, 0xffff0000, v121
  v_pk_add_f32 v[30:31], v[30:31], v[64:65]
  v_lshlrev_b32 v64, 16, v122
  v_and_b32 v65, 0xffff0000, v122
  v_pk_add_f32 v[44:45], v[44:45], v[64:65]
  v_lshlrev_b32 v64, 16, v123
  v_and_b32 v65, 0xffff0000, v123
  v_pk_add_f32 v[46:47], v[46:47], v[64:65]
  v_lshlrev_b32 v64, 16, v124
  v_and_b32 v65, 0xffff0000, v124
  v_pk_add_f32 v[32:33], v[32:33], v[64:65]
  v_lshlrev_b32 v64, 16, v125
  v_and_b32 v65, 0xffff0000, v125
  v_pk_add_f32 v[34:35], v[34:35], v[64:65]
  v_lshlrev_b32 v64, 16, v126
  v_and_b32 v65, 0xffff0000, v126
  v_pk_add_f32 v[48:49], v[48:49], v[64:65]
  v_lshlrev_b32 v64, 16, v127
  v_and_b32 v65, 0xffff0000, v127
  v_pk_add_f32 v[50:51], v[50:51], v[64:65]
  s_mov_b64 exec, 1
  s_mov_b32 s71, 0
L_parallel_sum__linear_kernel_hedgehog__glu_gated_reglu__prompt_kernel_g2_poll:
  buffer_load_dword v60, v59, s[24:27], s66 offen sc1
  s_waitcnt vmcnt(0)
  v_readfirstlane_b32 s70, v60
  s_add_u32 s71, s71, 1
  s_nop 2
  s_cmp_ge_u32 s70, 4
  s_cbranch_scc1 L_parallel_sum__linear_kernel_hedgehog__glu_gated_reglu__prompt_kernel_g2_poll_ok
  s_cmp_ge_u32 s71, 1048576
  s_cbranch_scc1 L_parallel_sum__linear_kernel_hedgehog__glu_gated_reglu__prompt_kernel_g2_poll_ok
  s_sleep 1
  s_branch L_parallel_sum__linear_kernel_hedgehog__glu_gated_reglu__prompt_kernel_g2_poll
L_parallel_sum__linear_kernel_hedgehog__glu_gated_reglu__prompt_kernel_g2_poll_ok:
  s_mov_b64 exec, s[72:73]
  s_lshl_b32 s65, s64, 2
  s_add_u32 s65, s65, s6
  s_lshl_b32 s65, s65, 4
  s_add_u32 s65, s65, s3
  s_lshl_b32 s65, s65, 13
  s_add_u32 s66, s6, 1
  s_and_b32 s66, s66, 3
  s_lshl_b32 s66, s66, 15
  s_add_u32 s66, s66, s65
  buffer_load_dwordx4 v[128:131], v2, s[20:23], s66 offen offset:0 sc1
  buffer_load_dwordx4 v[132:135], v2, s[20:23], s66 offen offset:1024 sc1
  buffer_load_dwordx4 v[136:139], v2, s[20:23], s66 offen offset:2048 sc1
  buffer_load_dwordx4 v[140:143], v2, s[20:23], s66 offen offset:3072 sc1
  s_add_u32 s66, s66, 4096
  buffer_load_dword v52, v61, s[20:23], s66 offen sc1
  s_add_u32 s66, s6, 2
  s_and_b32 s66, s66, 3
  s_lshl_b32 s66, s66, 15
  s_add_u32 s66, s66, s65
  buffer_load_dwordx4 v[144:147], v2, s[20:23], s66 offen offset:0 sc1
  buffer_load_dwordx4 v[148:151], v2, s[20:23], s66 offen offset:1024 sc1
  buffer_load_dwordx4 v[152:155], v2, s[20:23], s66 offen offset:2048 sc1
  buffer_load_dwordx4 v[156:159], v2, s[20:23], s66 offen offset:3072 sc1
  s_add_u32 s66, s66, 4096
  buffer_load_dword v53, v61, s[20:23], s66 offen sc1
  s_add_u32 s66, s6, 3
  s_and_b32 s66, s66, 3
  s_lshl_b32 s66, s66, 15
  s_add_u32 s66, s66, s65
  buffer_load_dwordx4 v[160:163], v2, s[20:23], s66 offen offset:0 sc1
  buffer_load_dwordx4 v[164:167], v2, s[20:23], s66 offen offset:1024 sc1
  buffer_load_dwordx4 v[168:171], v2, s[20:23], s66 offen offset:2048 sc1
  buffer_load_dwordx4 v[172:175], v2, s[20:23], s66 offen offset:3072 sc1
  s_add_u32 s66, s66, 4096
  buffer_load_dword v54, v61, s[20:23], s66 offen sc1
  s_waitcnt vmcnt(10)
  v_fma_mix_f32 v20, v128, v52, v20 op_sel_hi:[1,0,0]
  v_fma_mix_f32 v21, v128, v52, v21 op_sel:[1,0,0] op_sel_hi:[1,0,0]
  v_fma_mix_f32 v22, v129, v52, v22 op_sel_hi:[1,0,0]
  v_fma_mix_f32 v23, v129, v52, v23 op_sel:[1,0,0] op_sel_hi:[1,0,0]
  v_fma_mix_f32 v36, v130, v52, v36 op_sel_hi:[1,0,0]
  v_fma_mix_f32 v37, v130, v52, v37 op_sel:[1,0,0] op_sel_hi:[1,0,0]
  v_fma_mix_f32 v38, v131, v52, v38 op_sel_hi:[1,0,0]
  v_fma_mix_f32 v39, v131, v52, v39 op_sel:[1,0,0] op_sel_hi:[1,0,0]
  v_fma_mix_f32 v24, v132, v52, v24 op_sel_hi:[1,0,0]
  v_fma_mix_f32 v25, v132, v52, v25 op_sel:[1,0,0] op_sel_hi:[1,0,0]
  v_fma_mix_f32 v26, v133, v52, v26 op_sel_hi:[1,0,0]
  v_fma_mix_f32 v27, v133, v52, v27 op_sel:[1,0,0] op_sel_hi:[1,0,0]
  v_fma_mix_f32 v40, v134, v52, v40 op_sel_hi:[1,0,0]
  v_fma_mix_f32 v41, v134, v52, v41 op_sel:[1,0,0] op_sel_hi:[1,0,0]
  v_fma_mix_f32 v42, v135, v52, v42 op_sel_hi:[1,0,0]
  v_fma_mix_f32 v43, v135, v52, v43 op_sel:[1,0,0] op_sel_hi:[1,0,0]
  v_fma_mix_f32 v28, v136, v52, v28 op_sel_hi:[1,0,0]
  v_fma_mix_f32 v29, v136, v52, v29 op_sel:[1,0,0] op_sel_hi:[1,0,0]
  v_fma_mix_f32 v30, v137, v52, v30 op_sel_hi:[1,0,0]
  v_fma_mix_f32 v31, v137, v52, v31 op_sel:[1,0,0] op_sel_hi:[1,0,0]
  v_fma_mix_f32 v44, v138, v52, v44 op_sel_hi:[1,0,0]
  v_fma_mix_f32 v45, v138, v52, v45 op_sel:[1,0,0] op_sel_hi:[1,0,0]
  v_fma_mix_f32 v46, v139, v52, v46 op_sel_hi:[1,0,0]
  v_fma_mix_f32 v47, v139, v52, v47 op_sel:[1,0,0] op_sel_hi:[1,0,0]
  v_fma_mix_f32 v32, v140, v52, v32 op_sel_hi:[1,0,0]
  v_fma_mix_f32 v33, v140, v52, v33 op_sel:[1,0,0] op_sel_hi:[1,0,0]
  v_fma_mix_f32 v34, v141, v52, v34 op_sel_hi:[1,0,0]
  v_fma_mix_f32 v35, v141, v52, v35 op_sel:[1,0,0] op_sel_hi:[1,0,0]
  v_fma_mix_f32 v48, v142, v52, v48 op_sel_hi:[1,0,0]
  v_fma_mix_f32 v49, v142, v52, v49 op_sel:[1,0,0] op_sel_hi:[1,0,0]
  v_fma_mix_f32 v50, v143, v52, v50 op_sel_hi:[1,0,0]
  v_fma_mix_f32 v51, v143, v52, v51 op_sel:[1,0,0] op_sel_hi:[1,0,0]
  s_waitcnt vmcnt(5)
  v_fma_mix_f32 v20, v144, v53, v20 op_sel_hi:[1,0,0]
  v_fma_mix_f32 v21, v144, v53, v21 op_sel:[1,0,0] op_sel_hi:[1,0,0]
  v_fma_mix_f32 v22, v145, v53, v22 op_sel_hi:[1,0,0]
  v_fma_mix_f32 v23, v145, v53, v23 op_sel:[1,0,0] op_sel_hi:[1,0,0]
  v_fma_mix_f32 v36, v146, v53, v36 op_sel_hi:[1,0,0]
  v_fma_mix_f32 v37, v146, v53, v37 op_sel:[1,0,0] op_sel_hi:[1,0,0]
  v_fma_mix_f32 v38, v147, v53, v38 op_sel_hi:[1,0,0]
  v_fma_mix_f32 v39, v147, v53, v39 op_sel:[1,0,0] op_sel_hi:[1,0,0]
  v_fma_mix_f32 v24, v148, v53, v24 op_sel_hi:[1,0,0]
  v_fma_mix_f32 v25, v148, v53, v25 op_sel:[1,0,0] op_sel_hi:[1,0,0]
  v_fma_mix_f32 v26, v149, v53, v26 op_sel_hi:[1,0,0]
  v_fma_mix_f32 v27, v149, v53, v27 op_sel:[1,0,0] op_sel_hi:[1,0,0]
  v_fma_mix_f32 v40, v150, v53, v40 op_sel_hi:[1,0,0]
  v_fma_mix_f32 v41, v150, v53, v41 op_sel:[1,0,0] op_sel_hi:[1,0,0]
  v_fma_mix_f32 v42, v151, v53, v42 op_sel_hi:[1,0,0]
  v_fma_mix_f32 v43, v151, v53, v43 op_sel:[1,0,0] op_sel_hi:[1,0,0]
  v_fma_mix_f32 v28, v152, v53, v28 op_sel_hi:[1,0,0]
  v_fma_mix_f32 v29, v152, v53, v29 op_sel:[1,0,0] op_sel_hi:[1,0,0]
  v_fma_mix_f32 v30, v153, v53, v30 op_sel_hi:[1,0,0]
  v_fma_mix_f32 v31, v153, v53, v31 op_sel:[1,0,0] op_sel_hi:[1,0,0]
  v_fma_mix_f32 v44, v154, v53, v44 op_sel_hi:[1,0,0]
  v_fma_mix_f32 v45, v154, v53, v45 op_sel:[1,0,0] op_sel_hi:[1,0,0]
  v_fma_mix_f32 v46, v155, v53, v46 op_sel_hi:[1,0,0]
  v_fma_mix_f32 v47, v155, v53, v47 op_sel:[1,0,0] op_sel_hi:[1,0,0]
  v_fma_mix_f32 v32, v156, v53, v32 op_sel_hi:[1,0,0]
  v_fma_mix_f32 v33, v156, v53, v33 op_sel:[1,0,0] op_sel_hi:[1,0,0]
  v_fma_mix_f32 v34, v157, v53, v34 op_sel_hi:[1,0,0]
  v_fma_mix_f32 v35, v157, v53, v35 op_sel:[1,0,0] op_sel_hi:[1,0,0]
  v_fma_mix_f32 v48, v158, v53, v48 op_sel_hi:[1,0,0]
  v_fma_mix_f32 v49, v158, v53, v49 op_sel:[1,0,0] op_sel_hi:[1,0,0]
  v_fma_mix_f32 v50, v159, v53, v50 op_sel_hi:[1,0,0]
  v_fma_mix_f32 v51, v159, v53, v51 op_sel:[1,0,0] op_sel_hi:[1,0,0]
  s_waitcnt vmcnt(0)
  v_fma_mix_f32 v20, v160, v54, v20 op_sel_hi:[1,0,0]
  v_fma_mix_f32 v21, v160, v54, v21 op_sel:[1,0,0] op_sel_hi:[1,0,0]
  v_fma_mix_f32 v22, v161, v54, v22 op_sel_hi:[1,0,0]
  v_fma_mix_f32 v23, v161, v54, v23 op_sel:[1,0,0] op_sel_hi:[1,0,0]
  v_fma_mix_f32 v36, v162, v54, v36 op_sel_hi:[1,0,0]
  v_fma_mix_f32 v37, v162, v54, v37 op_sel:[1,0,0] op_sel_hi:[1,0,0]
  v_fma_mix_f32 v38, v163, v54, v38 op_sel_hi:[1,0,0]
  v_fma_mix_f32 v39, v163, v54, v39 op_sel:[1,0,0] op_sel_hi:[1,0,0]
  v_fma_mix_f32 v24, v164, v54, v24 op_sel_hi:[1,0,0]
  v_fma_mix_f32 v25, v164, v54, v25 op_sel:[1,0,0] op_sel_hi:[1,0,0]
  v_fma_mix_f32 v26, v165, v54, v26 op_sel_hi:[1,0,0]
  v_fma_mix_f32 v27, v165, v54, v27 op_sel:[1,0,0] op_sel_hi:[1,0,0]
  v_fma_mix_f32 v40, v166, v54, v40 op_sel_hi:[1,0,0]
  v_fma_mix_f32 v41, v166, v54, v41 op_sel:[1,0,0] op_sel_hi:[1,0,0]
  v_fma_mix_f32 v42, v167, v54, v42 op_sel_hi:[1,0,0]
  v_fma_mix_f32 v43, v167, v54, v43 op_sel:[1,0,0] op_sel_hi:[1,0,0]
  v_fma_mix_f32 v28, v168, v54, v28 op_sel_hi:[1,0,0]
  v_fma_mix_f32 v29, v168, v54, v29 op_sel:[1,0,0] op_sel_hi:[1,0,0]
  v_fma_mix_f32 v30, v169, v54, v30 op_sel_hi:[1,0,0]
  v_fma_mix_f32 v31, v169, v54, v31 op_sel:[1,0,0] op_sel_hi:[1,0,0]
  v_fma_mix_f32 v44, v170, v54, v44 op_sel_hi:[1,0,0]
  v_fma_mix_f32 v45, v170, v54, v45 op_sel:[1,0,0] op_sel_hi:[1,0,0]
  v_fma_mix_f32 v46, v171, v54, v46 op_sel_hi:[1,0,0]
  v_fma_mix_f32 v47, v171, v54, v47 op_sel:[1,0,0] op_sel_hi:[1,0,0]
  v_fma_mix_f32 v32, v172, v54, v32 op_sel_hi:[1,0,0]
  v_fma_mix_f32 v33, v172, v54, v33 op_sel:[1,0,0] op_sel_hi:[1,0,0]
  v_fma_mix_f32 v34, v173, v54, v34 op_sel_hi:[1,0,0]
  v_fma_mix_f32 v35, v173, v54, v35 op_sel:[1,0,0] op_sel_hi:[1,0,0]
  v_fma_mix_f32 v48, v174, v54, v48 op_sel_hi:[1,0,0]
  v_fma_mix_f32 v49, v174, v54, v49 op_sel:[1,0,0] op_sel_hi:[1,0,0]
  v_fma_mix_f32 v50, v175, v54, v50 op_sel_hi:[1,0,0]
  v_fma_mix_f32 v51, v175, v54, v51 op_sel:[1,0,0] op_sel_hi:[1,0,0]
  v_cvt_pk_bf16_f32 v80, v20, v21
  v_cvt_pk_bf16_f32 v81, v22, v23
  v_cvt_pk_bf16_f32 v82, v36, v37
  v_cvt_pk_bf16_f32 v83, v38, v39
  v_cvt_pk_bf16_f32 v84, v24, v25
  v_cvt_pk_bf16_f32 v85, v26, v27
  v_cvt_pk_bf16_f32 v86, v40, v41
  v_cvt_pk_bf16_f32 v87, v42, v43
  v_cvt_pk_bf16_f32 v88, v28, v29
  v_cvt_pk_bf16_f32 v89, v30, v31
  v_cvt_pk_bf16_f32 v90, v44, v45
  v_cvt_pk_bf16_f32 v91, v46, v47
  v_cvt_pk_bf16_f32 v92, v32, v33
  v_cvt_pk_bf16_f32 v93, v34, v35
  v_cvt_pk_bf16_f32 v94, v48, v49
  v_cvt_pk_bf16_f32 v95, v50, v51
  v_permlane16_swap_b32 v80, v82
  v_permlane16_swap_b32 v81, v83
  v_permlane16_swap_b32 v84, v86
  v_permlane16_swap_b32 v85, v87
  v_permlane16_swap_b32 v88, v90
  v_permlane16_swap_b32 v89, v91
  v_permlane16_swap_b32 v92, v94
  v_permlane16_swap_b32 v93, v95
  buffer_store_dwordx4 v[80:83], v56, s[16:19], s28 offen sc1
  s_add_u32 s28, s28, 32768
  buffer_store_dwordx4 v[84:87], v56, s[16:19], s28 offen sc1
  s_add_u32 s28, s28, 32768
  buffer_store_dwordx4 v[88:91], v56, s[16:19], s28 offen sc1
  s_add_u32 s28, s28, 32768
  buffer_store_dwordx4 v[92:95], v56, s[16:19], s28 offen sc1
  s_add_u32 s28, s28, 32768
L_parallel_sum__linear_kernel_hedgehog__glu_gated_reglu__prompt_kernel_done:
  s_endpgm
.section .rodata,"a"
.p2align 6
.amdhsa_kernel parallel_sum__linear_kernel_hedgehog__glu_gated_reglu__prompt_kernel
  .amdhsa_next_free_vgpr 512
  .amdhsa_next_free_sgpr 102
  .amdhsa_accum_offset 256
  .amdhsa_group_segment_fixed_size 0
  .amdhsa_kernarg_size 88
  .amdhsa_user_sgpr_count 2
  .amdhsa_user_sgpr_kernarg_segment_ptr 1
  .amdhsa_system_sgpr_workgroup_id_x 1
  .amdhsa_float_denorm_mode_32 3
.end_amdhsa_kernel
```
